```python
import torch

def _softmax(x, axis=-1):
    return torch.softmax(x, dim=axis)
def _gelu(x):
    return torch.nn.functional.gelu(x, approximate="tanh")
def _silu(x):
    return torch.nn.functional.silu(x)
def _sigmoid(x):
    return torch.sigmoid(x)
def _layernorm(x, axis=-1, eps=1e-5):
    m = x.mean(dim=axis, keepdim=True)
    v = x.var(dim=axis, keepdim=True, unbiased=False)
    return (x - m) / torch.sqrt(v + eps)
def _scatter_add(tgt, idx, src, axis=0):
    return tgt.clone().index_add_(axis, idx, src)
def _segment_sum(src, seg, n):
    out = torch.zeros((n,) + src.shape[1:], dtype=src.dtype)
    return out.index_add_(0, seg, src)
def _pad(x, pw):
    flat = tuple(v for pair in reversed(pw) for v in pair)
    return torch.nn.functional.pad(x, flat)

kernel_name = 'parallel_sum__linear_kernel_hedgehog__glu_gated_reglu__prompt'

def setup_inputs():

    _w = (lambda a: (lambda t: t.to(torch.bfloat16) if t.is_floating_point() else t)(torch.as_tensor(a)))
    def _A_setup():
        B, S, D, H = 1, 2048, 576, 32
        Dh = D // H
        return {
            "x": _w((lambda *s: torch.randn(*s, dtype=torch.bfloat16) * 0.05)(B, S, D)),
            "wqkv": _w((lambda *s: torch.randn(*s, dtype=torch.bfloat16) * 0.2)(D, 3 * D)),
            "w_phi": _w((lambda *s: torch.randn(*s, dtype=torch.bfloat16) * 0.2)(H, Dh, Dh) * (Dh ** -0.5)),
            "wo": _w((lambda *s: torch.randn(*s, dtype=torch.bfloat16) * 0.05)(D, D)),
        }
    _A_in = _A_setup()

    def _B_setup():
        B, S, D, F = 1, 2048, 576, 4608
        return {
            "x": _w((lambda *s: torch.randn(*s, dtype=torch.bfloat16) * 0.05)(B, S, D)),
            "W_gate": _w((lambda *s: torch.randn(*s, dtype=torch.bfloat16) * 0.4)(D, F) * (2.0 / D) ** 0.5),
            "W_up": _w((lambda *s: torch.randn(*s, dtype=torch.bfloat16) * 0.4)(D, F) * (2.0 / D) ** 0.5),
            "W_down": _w((lambda *s: torch.randn(*s, dtype=torch.bfloat16) * 0.4)(F, D) * (1.0 / F) ** 0.5),
        }
    _B_in = _B_setup()

    return {
        "A_x": _A_in["x"],
        "A_wqkv": _A_in["wqkv"],
        "A_w_phi": _A_in["w_phi"],
        "A_wo": _A_in["wo"],
        "B_x": _B_in["x"],
        "B_W_gate": _B_in["W_gate"],
        "B_W_up": _B_in["W_up"],
        "B_W_down": _B_in["W_down"],
    }

def reference(A_x, A_wqkv, A_w_phi, A_wo, B_x, B_W_gate, B_W_up, B_W_down):
    def _A_ref(x, wqkv, w_phi, wo):
        B, S, D = x.shape
        H = 32; Dh = D // H
        qkv = (lambda x, *d: x.permute(*d))((x @ wqkv).reshape(B, S, 3, H, Dh), 2, 0, 3, 1, 4)
        q, k, v = qkv[0], qkv[1], qkv[2]
        pq = torch.einsum("bhsd,hdf->bhsf", q, w_phi)
        pk = torch.einsum("bhsd,hdf->bhsf", k, w_phi)
        phi_q = torch.concatenate([_softmax(pq, axis=-1), _softmax(-pq, axis=-1)], axis=-1)
        phi_k = torch.concatenate([_softmax(pk, axis=-1), _softmax(-pk, axis=-1)], axis=-1)
        kv = torch.einsum("bhsf,bhsd->bhfd", phi_k, v)
        z  = torch.einsum("bhsf->bhf", phi_k)
        num = torch.einsum("bhqf,bhfd->bhqd", phi_q, kv)
        den = torch.einsum("bhqf,bhf->bhq", phi_q, z)[..., None] + 1e-6
        o = num / den
        return (lambda x, *d: x.permute(*d))(o, 0, 2, 1, 3).reshape(B, S, D) @ wo

    def _B_ref(x, W_gate, W_up, W_down):
        gate = torch.einsum("bsd,df->bsf", x, W_gate)
        up = torch.einsum("bsd,df->bsf", x, W_up)
        gate = gate * (lambda x, dt: x.to(dt))(gate > 0, gate.dtype)
        h = gate * up
        return torch.einsum("bsf,fd->bsd", h, W_down)

    x = A_x
    xn = _layernorm(x, axis=-1)
    return x + _A_ref(xn, A_wqkv, A_w_phi, A_wo) + _B_ref(xn, B_W_gate, B_W_up, B_W_down)
```

```asm
; @launch grid=(256,1,1) block=(256,1,1) lds=163840
.amdgcn_target "amdgcn-amd-amdhsa--gfx950"
.text
.macro MA d,a,b
v_mfma_f32_16x16x32_bf16 v[\d:\d+3], a[\a:\a+3], a[\b:\b+3], v[\d:\d+3]
.endm
.macro MV d,a,b
v_mfma_f32_16x16x32_bf16 v[\d:\d+3], a[\a:\a+3], v[\b:\b+3], v[\d:\d+3]
.endm
.macro RT d,b,o
ds_read_b64_tr_b16 a[\d:\d+1], v\b offset:\o
.endm
.macro WL n
s_waitcnt lgkmcnt(\n)
.endm
.macro CV d,a,b
v_cvt_pk_bf16_f32 v\d, v\a, v\b
.endm
.globl parallel_sum__linear_kernel_hedgehog__glu_gated_reglu__prompt_kernel
.p2align 8
.type parallel_sum__linear_kernel_hedgehog__glu_gated_reglu__prompt_kernel,@function
parallel_sum__linear_kernel_hedgehog__glu_gated_reglu__prompt_kernel:
s_load_dwordx2 s[8:9], s[0:1], 0
s_lshr_b32 s3, s2, 8
s_cbranch_scc1 L_k1_end
s_getpc_b64 s[84:85]
s_bitcmp1_b32 s2, 3
s_cselect_b32 s3, L_att-parallel_sum__linear_kernel_hedgehog__glu_gated_reglu__prompt_kernel, 0
s_lshr_b32 s4, s2, 4
s_lshl_b32 s4, s4, 10
s_add_u32 s3, s3, s4
v_lshrrev_b32 v1, 6, v0
v_lshl_add_u32 v2, v0, 2, s3
global_load_dword v255, v2, s[84:85]
v_readfirstlane_b32 s32, v1
v_and_b32 v0, 63, v0
v_lshrrev_b32 v104, 3, v0
v_lshrrev_b32 v22, 4, v0
v_mul_u32_u24 v104, 1152, v104
v_and_b32 v105, 7, v0
v_xor_b32 v105, v105, v22
v_lshl_add_u32 v104, v105, 4, v104
s_and_b32 s6, s2, 64
v_xor_b32 v104, s6, v104
s_bfe_u32 s35, s2, 0x30003
s_and_b32 s33, s2, 1
s_lshl3_add_u32 s33, s33, s35
s_lshr_b32 s60, s2, 6
s_lshl2_add_u32 s6, s32, s60
s_lshl4_add_u32 s7, s33, s6
s_mulk_i32 s6, 9216
s_mulk_i32 s7, 9216
s_mov_b32 m0, s6
s_mov_b32 s5, 9
s_mov_b32 s10, 0x240000
s_mov_b32 s11, 0x20000
WL 0
buffer_load_dwordx4 v104, s[8:11], s7 offen  lds
s_addk_i32 m0, 1024
s_addk_i32 s7, 128
buffer_load_dwordx4 v104, s[8:11], s7 offen  lds
s_addk_i32 m0, 1024
s_addk_i32 s7, 128
buffer_load_dwordx4 v104, s[8:11], s7 offen  lds
s_addk_i32 m0, 1024
s_addk_i32 s7, 128
buffer_load_dwordx4 v104, s[8:11], s7 offen  lds
s_addk_i32 m0, 1024
s_addk_i32 s7, 128
buffer_load_dwordx4 v104, s[8:11], s7 offen  lds
s_addk_i32 m0, 1024
s_addk_i32 s7, 128
buffer_load_dwordx4 v104, s[8:11], s7 offen  lds
s_addk_i32 m0, 1024
s_addk_i32 s7, 128
buffer_load_dwordx4 v104, s[8:11], s7 offen  lds
s_addk_i32 m0, 1024
s_addk_i32 s7, 128
buffer_load_dwordx4 v104, s[8:11], s7 offen  lds
s_addk_i32 m0, 1024
s_addk_i32 s7, 128
buffer_load_dwordx4 v104, s[8:11], s7 offen  lds
s_load_dwordx8 s[64:71], s[0:1], 0
s_load_dwordx4 s[72:75], s[0:1], 40
s_load_dwordx4 s[76:79], s[0:1], 56
s_load_dwordx4 s[80:83], s[0:1], 72
v_xor_b32 v105, 64, v104
v_and_b32 v23, 15, v0
s_lshl2_add_u32 s4, s33, s32
s_mul_i32 s4, s4, 36864
s_mul_i32 s5, s32, 36864
s_bfe_u32 s34, s2, 0x20001
s_lshr_b32 s3, s2, 6
WL 0
s_mov_b32 s20, s82
s_and_b32 s21, s83, 0xffff
s_mov_b32 s22, 0x10000000
s_mov_b32 s23, 0x20000
s_mov_b32 s24, s80
s_and_b32 s25, s81, 0xffff
s_mov_b32 s26, 0x100
s_mov_b32 s27, 0x20000
s_or_b32 s35, s2, s32
s_cbranch_scc1 L_nonce_done
s_memrealtime s[98:99]
WL 0
v_mov_b32 v2, s98
v_or_b32 v2, 1, v2
buffer_store_dword v2, off, s[24:27], 0 sc1
L_nonce_done:
s_cmp_eq_u32 s3, 0
s_cbranch_scc1 L_att
s_sub_u32 s42, s3, 1
s_mov_b32 s43, s34
s_mul_i32 s34, s43, 3
s_add_u32 s34, s34, s42
s_cmp_ge_u32 s32, 2
s_cselect_b32 s35, s74, s72
s_cselect_b32 s41, s75, s73
s_mov_b32 s12, s35
s_and_b32 s13, s41, 0xffff
s_mov_b32 s14, 0x510000
s_mov_b32 s15, 0x20000
s_lshl_b32 s37, s32, 12
s_mul_i32 s38, s34, 768
s_add_u32 s6, s60, 1
s_and_b32 s6, s6, 3
s_mulk_i32 s6, 9216
s_add_u32 m0, s5, s6
s_add_u32 s7, s4, s6
buffer_load_dwordx4 v105, s[8:11], s7 offen  lds
s_mov_b32 s16, s76
s_and_b32 s17, s77, 0xffff
s_mov_b32 s18, 0x510000
s_mov_b32 s19, 0x20000
s_mov_b32 s28, s70
s_and_b32 s29, s71, 0xffff
s_mov_b32 s30, 0xa2000
s_mov_b32 s31, 0x20000
s_addk_i32 m0, 1024
s_addk_i32 s7, 128
buffer_load_dwordx4 v105, s[8:11], s7 offen  lds
s_mov_b32 s61, s78
s_mov_b32 s62, s79
s_lshl_b32 s98, s43, 6
s_and_b32 s99, s98, 128
s_xor_b32 s99, s99, 128
s_add_u32 s95, s42, 0
s_cmp_ge_u32 s95, 3
s_cselect_b32 s96, 3, 0
s_sub_u32 s95, s95, s96
s_addk_i32 m0, 1024
s_addk_i32 s7, 128
buffer_load_dwordx4 v105, s[8:11], s7 offen  lds
s_mul_i32 s96, s43, 3
s_add_u32 s95, s95, s96
s_mul_i32 s44, s95, 442368
s_mul_i32 s96, s42, 384
s_add_u32 s44, s44, s96
s_add_u32 s53, s44, s99
s_add_u32 s86, s44, s98
s_xor_b32 s56, s86, 64
s_mul_i32 s96, s33, 12
s_addk_i32 m0, 1024
s_addk_i32 s7, 128
buffer_load_dwordx4 v105, s[8:11], s7 offen  lds
s_add_u32 s95, s95, s96
s_lshl_b32 s95, s95, 2
s_add_u32 s95, s95, s32
s_mul_i32 s47, s95, 24576
s_add_u32 s47, s47, 0x1000000
s_add_u32 s95, s42, 1
s_cmp_ge_u32 s95, 3
s_cselect_b32 s96, 3, 0
s_sub_u32 s95, s95, s96
s_addk_i32 m0, 1024
s_addk_i32 s7, 128
buffer_load_dwordx4 v105, s[8:11], s7 offen  lds
s_mul_i32 s96, s43, 3
s_add_u32 s95, s95, s96
s_mul_i32 s45, s95, 442368
s_mul_i32 s96, s42, 384
s_add_u32 s45, s45, s96
s_add_u32 s54, s45, s99
s_add_u32 s87, s45, s98
s_xor_b32 s57, s87, 64
s_addk_i32 m0, 1024
s_addk_i32 s7, 128
buffer_load_dwordx4 v105, s[8:11], s7 offen  lds
s_mul_i32 s96, s33, 12
s_add_u32 s95, s95, s96
s_lshl_b32 s95, s95, 2
s_add_u32 s95, s95, s32
s_mul_i32 s48, s95, 24576
s_add_u32 s48, s48, 0x1000000
s_add_u32 s95, s42, 2
s_cmp_ge_u32 s95, 3
s_cselect_b32 s96, 3, 0
s_sub_u32 s95, s95, s96
s_addk_i32 m0, 1024
s_addk_i32 s7, 128
buffer_load_dwordx4 v105, s[8:11], s7 offen  lds
s_mul_i32 s96, s43, 3
s_add_u32 s95, s95, s96
s_mul_i32 s46, s95, 442368
s_mul_i32 s96, s42, 384
s_add_u32 s46, s46, s96
s_add_u32 s55, s46, s99
s_add_u32 s88, s46, s98
s_xor_b32 s58, s88, 64
s_addk_i32 m0, 1024
s_addk_i32 s7, 128
buffer_load_dwordx4 v105, s[8:11], s7 offen  lds
s_mul_i32 s96, s33, 12
s_add_u32 s95, s95, s96
s_lshl_b32 s95, s95, 2
s_add_u32 s95, s95, s32
s_mul_i32 s49, s95, 24576
s_add_u32 s49, s49, 0x1000000
s_lshl_b32 s95, s33, 2
s_add_u32 s95, s95, s43
s_addk_i32 m0, 1024
s_addk_i32 s7, 128
buffer_load_dwordx4 v105, s[8:11], s7 offen  lds
s_lshl_b32 s52, s95, 7
s_add_u32 s52, s52, 0x2780000
s_lshl_b32 s63, s42, 2
s_add_u32 s63, s63, s52
s_mul_i32 s40, s43, 2359296
s_mul_i32 s39, s42, 12288
s_add_u32 s39, s39, s4
s_add_u32 s40, s40, s39
s_lshl_b32 s50, s32, 11
s_add_u32 s6, s60, 2
s_and_b32 s6, s6, 3
s_mulk_i32 s6, 9216
s_add_u32 m0, s5, s6
s_add_u32 s7, s4, s6
buffer_load_dwordx4 v104, s[8:11], s7 offen  lds
s_lshl_b32 s96, s99, 5
s_add_u32 s51, s40, s96
s_xor_b32 s96, s96, 4096
s_add_u32 s59, s40, s96
s_and_b32 s96, s98, 64
s_xor_b32 s96, s96, 64
s_lshl_b32 s96, s96, 4
s_add_u32 s59, s59, s96
s_addk_i32 m0, 1024
s_addk_i32 s7, 128
buffer_load_dwordx4 v104, s[8:11], s7 offen  lds
s_lshl_b32 s95, s33, 2
s_add_u32 s95, s95, s43
s_lshl_b32 s95, s95, 2
s_add_u32 s95, s95, s32
s_nop 0
s_mul_i32 s83, s95, 10240
s_add_u32 s83, s83, 0x2200000
s_mul_i32 s85, s43, 165888
s_mul_i32 s96, s42, 384
s_add_u32 s85, s85, s96
s_addk_i32 m0, 1024
s_addk_i32 s7, 128
buffer_load_dwordx4 v104, s[8:11], s7 offen  lds
s_lshl_b32 s84, s32, 10
s_lshl_b32 s95, s32, 2
s_add_u32 s95, s95, 0
s_lshr_b32 s96, s95, 1
s_lshl_b32 s78, s96, 2
s_cmp_ge_u32 s96, 5
s_cselect_b32 s96, 52, 0
s_add_u32 s78, s78, s96
s_and_b32 s95, s95, 1
s_addk_i32 m0, 1024
s_addk_i32 s7, 128
buffer_load_dwordx4 v104, s[8:11], s7 offen  lds
s_mul_i32 s95, s95, 36
s_add_u32 s78, s78, s95
s_mul_i32 s78, s78, 1152
s_add_u32 s78, s78, s85
s_lshl_b32 s95, s32, 2
s_add_u32 s95, s95, 1
s_lshr_b32 s96, s95, 1
s_lshl_b32 s79, s96, 2
s_addk_i32 m0, 1024
s_addk_i32 s7, 128
buffer_load_dwordx4 v104, s[8:11], s7 offen  lds
s_cmp_ge_u32 s96, 5
s_cselect_b32 s96, 52, 0
s_add_u32 s79, s79, s96
s_and_b32 s95, s95, 1
s_mul_i32 s95, s95, 36
s_add_u32 s79, s79, s95
s_mul_i32 s79, s79, 1152
s_add_u32 s79, s79, s85
s_lshl_b32 s95, s32, 2
s_add_u32 s95, s95, 2
s_addk_i32 m0, 1024
s_addk_i32 s7, 128
buffer_load_dwordx4 v104, s[8:11], s7 offen  lds
s_lshr_b32 s96, s95, 1
s_lshl_b32 s80, s96, 2
s_cmp_ge_u32 s96, 5
s_cselect_b32 s96, 52, 0
s_add_u32 s80, s80, s96
s_and_b32 s95, s95, 1
s_mul_i32 s95, s95, 36
s_add_u32 s80, s80, s95
s_mul_i32 s80, s80, 1152
s_addk_i32 m0, 1024
s_addk_i32 s7, 128
buffer_load_dwordx4 v104, s[8:11], s7 offen  lds
s_add_u32 s80, s80, s85
s_lshl_b32 s95, s32, 2
s_add_u32 s95, s95, 3
s_lshr_b32 s96, s95, 1
s_lshl_b32 s81, s96, 2
s_cmp_ge_u32 s96, 5
s_cselect_b32 s96, 52, 0
s_add_u32 s81, s81, s96
s_and_b32 s95, s95, 1
s_addk_i32 m0, 1024
s_addk_i32 s7, 128
buffer_load_dwordx4 v104, s[8:11], s7 offen  lds
s_mul_i32 s95, s95, 36
s_add_u32 s81, s81, s95
s_mul_i32 s81, s81, 1152
s_add_u32 s81, s81, s85
s_add_u32 s95, s32, 16
s_lshr_b32 s96, s95, 1
s_lshl_b32 s82, s96, 2
s_cmp_ge_u32 s96, 5
s_cselect_b32 s96, 52, 0
s_add_u32 s82, s82, s96
s_addk_i32 m0, 1024
s_addk_i32 s7, 128
buffer_load_dwordx4 v104, s[8:11], s7 offen  lds
s_and_b32 s95, s95, 1
s_mul_i32 s95, s95, 36
s_add_u32 s82, s82, s95
s_mul_i32 s82, s82, 1152
s_add_u32 s82, s82, s85
v_lshrrev_b32 v28, 3, v0
s_lshl_b32 s96, s32, 5
v_add_u32 v5, s96, v28
s_add_u32 s6, s60, 3
s_and_b32 s6, s6, 3
s_mulk_i32 s6, 9216
s_add_u32 m0, s5, s6
s_add_u32 s7, s4, s6
buffer_load_dwordx4 v105, s[8:11], s7 offen  lds
v_mul_u32_u24 v5, 1152, v5
v_lshlrev_b32 v6, 1, v22
v_and_b32 v7, 7, v0
v_xor_b32_e64 v6, v6, v7
v_lshl_add_u32 v5, v6, 4, v5
v_lshrrev_b32 v28, 2, v0
v_add_u32 v25, s96, v28
v_mul_u32_u24 v25, 1152, v25
v_and_b32 v6, 3, v6
s_addk_i32 m0, 1024
s_addk_i32 s7, 128
s_nop 0
buffer_load_dwordx4 v105, s[8:11], s7 offen  lds
v_lshl_add_u32 v25, v6, 4, v25
v_add_u32 v6, 8192, v5
v_add_u32 v7, 16384, v5
v_add_u32 v8, 24576, v5
v_lshlrev_b32 v21, 4, v0
v_lshlrev_b32 v27, 9, v22
v_add_u32 v28, s32, v0
v_cmp_eq_u32 vcc, 0, v28
s_addk_i32 m0, 1024
s_addk_i32 s7, 128
buffer_load_dwordx4 v105, s[8:11], s7 offen  lds
v_mov_b32 v24, 0x40000000
v_mov_b32 v28, 0
v_cndmask_b32_e64 v24, v24, v28, vcc
v_mul_u32_u24 v28, 5462, v0
v_lshrrev_b32 v28, 16, v28
v_mul_u32_u24 v26, 12, v28
v_sub_u32 v26, v0, v26
s_mul_i32 s96, s32, 12
s_addk_i32 m0, 1024
s_addk_i32 s7, 128
buffer_load_dwordx4 v105, s[8:11], s7 offen  lds
s_and_b32 s95, s33, 7
s_mul_i32 s95, s95, 48
s_add_u32 s96, s96, s95
v_add_u32 v26, s96, v26
v_mul_u32_u24 v26, 1152, v26
v_lshl_add_u32 v26, v28, 7, v26
s_and_b32 s96, s32, 1
s_mul_i32 s96, s96, 36
s_and_b32 s95, s33, 7
s_addk_i32 m0, 1024
s_addk_i32 s7, 128
buffer_load_dwordx4 v105, s[8:11], s7 offen  lds
s_mul_i32 s95, s95, 72
s_add_u32 s96, s96, s95
v_add_u32_e64 v29, s96, v0
v_mul_u32_u24 v29, 9216, v29
v_cmp_gt_u32 vcc, 36, v0
v_mov_b32 v28, 0x40000000
s_nop 0
v_cndmask_b32 v26, v28, v26, vcc
s_addk_i32 m0, 1024
s_addk_i32 s7, 128
buffer_load_dwordx4 v105, s[8:11], s7 offen  lds
v_cndmask_b32_e64 v29, v28, v29, vcc
v_mul_u32_u24 v31, 13108, v0
v_lshrrev_b32 v31, 16, v31
v_mul_u32_u24 v30, 5, v31
v_sub_u32 v30, v0, v30
s_mul_i32 s96, s32, 5
v_add_u32 v30, s96, v30
v_min_u32 v30, 17, v30
s_addk_i32 m0, 1024
s_addk_i32 s7, 128
buffer_load_dwordx4 v105, s[8:11], s7 offen  lds
s_and_b32 s95, s33, 7
s_mul_i32 s95, s95, 18
v_add_u32_e64 v30, s95, v30
v_mul_u32_u24 v30, 1152, v30
v_cmp_gt_u32_e64 vcc, 15, v0
v_lshl_add_u32 v30, v31, 7, v30
s_nop 0
v_cndmask_b32 v30, v28, v30, vcc
v_bfe_u32 v28, v0, 2, 2
s_addk_i32 m0, 1024
s_addk_i32 s7, 128
buffer_load_dwordx4 v105, s[8:11], s7 offen  lds
v_mad_u32_u24 v28, v22, 8, v28
v_lshlrev_b32_e64 v9, 7, v28
v_bfe_u32 v28, v0, 3, 2
v_lshl_add_u32 v9, v28, 5, v9
v_and_b32_e64 v28, 3, v0
v_lshl_add_u32 v9, v28, 3, v9
v_xor_b32 v10, 32, v9
v_xor_b32 v11, 64, v9
s_addk_i32 m0, 1024
s_addk_i32 s7, 128
buffer_load_dwordx4 v105, s[8:11], s7 offen  lds
v_xor_b32 v12, 96, v9
v_add_u32 v13, 0x10000, v9
v_add_u32 v14, 0x10000, v10
v_add_u32 v15, 0x10000, v11
v_add_u32 v16, 0x10000, v12
v_add_u32 v17, 0x20000, v9
v_add_u32 v18, 0x20000, v10
v_add_u32 v19, 0x20000, v11
v_add_u32 v20, 0x20000, v12
v_lshrrev_b32 v28, 3, v0
s_and_b32 s36, s32, 1
s_lshl_b32 s36, s36, 5
v_add_u32 v1, s36, v28
v_mul_u32_u24 v1, 9216, v1
v_and_b32 v2, 2, v28
v_and_b32 v3, 7, v0
v_xor_b32_e64 v2, v2, v3
v_lshl_add_u32 v1, v2, 4, v1
v_xor_b32_e64 v2, 64, v1
v_add_u32 v2, 72704, v2
v_add_u32 v3, 145408, v1
v_add_u32 v4, 145408, v2
s_add_u32 m0, s37, 147456
s_add_u32 s36, s38, 0
s_nop 0
buffer_load_dwordx4 v1, s[12:15], s36 offen offset:0  lds
buffer_load_dwordx4 v2, s[12:15], s36 offen offset:1024  lds
buffer_load_dwordx4 v3, s[12:15], s36 offen offset:2048  lds
buffer_load_dwordx4 v4, s[12:15], s36 offen offset:3072  lds
v_lshrrev_b32_e64 v106, 3, v23
v_mul_u32_u24 v106, 9216, v106
v_and_b32_e64 v107, 7, v23
v_lshl_add_u32 v106, v107, 7, v106
v_lshrrev_b32 v107, 1, v23
v_xor_b32 v107, v107, v22
v_lshl_add_u32 v106, v107, 4, v106
v_add_u32 v106, s5, v106
v_xor_b32 v107, 64, v106
v_mov_b32 v80, 0x3f803f80
v_mov_b32 v81, 0x3f803f80
v_mov_b32 v82, 0x3f803f80
v_mov_b32 v83, 0x3f803f80
v_mov_b32 v72, 0
v_mov_b32 v73, 0
v_mov_b32 v76, 0
v_mov_b32 v77, 0
v_lshrrev_b32 v108, 2, v23
v_cmp_eq_u32 vcc, v108, v22
v_and_b32 v108, 1, v23
v_lshlrev_b32 v108, 4, v108
v_mov_b32 v78, 0x3f80
v_lshlrev_b32 v78, v108, v78
v_cndmask_b32 v78, 0, v78, vcc
v_and_b32 v108, 2, v23
v_cmp_eq_u32 vcc, 0, v108
s_nop 1
v_cndmask_b32 v74, 0, v78, vcc
v_sub_u32 v75, v78, v74
s_waitcnt vmcnt(12)
ds_read_b128 v[112:115], v106 offset:0
ds_read_b128 v[116:119], v106 offset:18432
ds_read_b128 v[120:123], v107 offset:0
ds_read_b128 v[124:127], v107 offset:18432
s_waitcnt vmcnt(11)
s_nop 0
ds_read_b128 v[128:131], v106 offset:1024
ds_read_b128 v[132:135], v106 offset:19456
ds_read_b128 v[136:139], v107 offset:1024
ds_read_b128 v[140:143], v107 offset:19456
WL 4
s_nop 0
v_mfma_f32_16x16x32_bf16 v[64:67], v[80:83], v[112:115], 0
v_mfma_f32_16x16x32_bf16 v[68:71], v[80:83], v[116:119], 0
v_mfma_f32_16x16x32_bf16 v[64:67], v[80:83], v[120:123], v[64:67]
v_mfma_f32_16x16x32_bf16 v[68:71], v[80:83], v[124:127], v[68:71]
s_waitcnt vmcnt(10)
s_nop 0
ds_read_b128 v[144:147], v106 offset:2048
ds_read_b128 v[148:151], v106 offset:20480
ds_read_b128 v[152:155], v107 offset:2048
ds_read_b128 v[156:159], v107 offset:20480
WL 4
s_nop 0
v_mfma_f32_16x16x32_bf16 v[64:67], v[80:83], v[128:131], v[64:67]
v_mfma_f32_16x16x32_bf16 v[68:71], v[80:83], v[132:135], v[68:71]
v_mfma_f32_16x16x32_bf16 v[64:67], v[80:83], v[136:139], v[64:67]
v_mfma_f32_16x16x32_bf16 v[68:71], v[80:83], v[140:143], v[68:71]
s_waitcnt vmcnt(9)
s_nop 0
ds_read_b128 v[160:163], v106 offset:3072
ds_read_b128 v[164:167], v106 offset:21504
ds_read_b128 v[168:171], v107 offset:3072
ds_read_b128 v[172:175], v107 offset:21504
WL 4
s_nop 0
v_mfma_f32_16x16x32_bf16 v[64:67], v[80:83], v[144:147], v[64:67]
v_mfma_f32_16x16x32_bf16 v[68:71], v[80:83], v[148:151], v[68:71]
v_mfma_f32_16x16x32_bf16 v[64:67], v[80:83], v[152:155], v[64:67]
v_mfma_f32_16x16x32_bf16 v[68:71], v[80:83], v[156:159], v[68:71]
s_waitcnt vmcnt(8)
s_nop 0
ds_read_b128 v[176:179], v106 offset:4096
ds_read_b128 v[180:183], v106 offset:22528
ds_read_b128 v[184:187], v107 offset:4096
ds_read_b128 v[188:191], v107 offset:22528
WL 4
s_nop 0
v_mfma_f32_16x16x32_bf16 v[64:67], v[80:83], v[160:163], v[64:67]
v_mfma_f32_16x16x32_bf16 v[68:71], v[80:83], v[164:167], v[68:71]
v_mfma_f32_16x16x32_bf16 v[64:67], v[80:83], v[168:171], v[64:67]
v_mfma_f32_16x16x32_bf16 v[68:71], v[80:83], v[172:175], v[68:71]
s_waitcnt vmcnt(7)
s_nop 0
ds_read_b128 v[192:195], v106 offset:5120
ds_read_b128 v[196:199], v106 offset:23552
ds_read_b128 v[200:203], v107 offset:5120
ds_read_b128 v[204:207], v107 offset:23552
WL 4
s_nop 0
v_mfma_f32_16x16x32_bf16 v[64:67], v[80:83], v[176:179], v[64:67]
v_mfma_f32_16x16x32_bf16 v[68:71], v[80:83], v[180:183], v[68:71]
v_mfma_f32_16x16x32_bf16 v[64:67], v[80:83], v[184:187], v[64:67]
v_mfma_f32_16x16x32_bf16 v[68:71], v[80:83], v[188:191], v[68:71]
s_waitcnt vmcnt(6)
s_nop 0
ds_read_b128 v[208:211], v106 offset:6144
ds_read_b128 v[212:215], v106 offset:24576
ds_read_b128 v[216:219], v107 offset:6144
ds_read_b128 v[220:223], v107 offset:24576
WL 4
s_nop 0
v_mfma_f32_16x16x32_bf16 v[64:67], v[80:83], v[192:195], v[64:67]
v_mfma_f32_16x16x32_bf16 v[68:71], v[80:83], v[196:199], v[68:71]
v_mfma_f32_16x16x32_bf16 v[64:67], v[80:83], v[200:203], v[64:67]
v_mfma_f32_16x16x32_bf16 v[68:71], v[80:83], v[204:207], v[68:71]
s_waitcnt vmcnt(5)
s_nop 0
ds_read_b128 v[224:227], v106 offset:7168
ds_read_b128 v[228:231], v106 offset:25600
ds_read_b128 v[232:235], v107 offset:7168
ds_read_b128 v[236:239], v107 offset:25600
WL 4
s_nop 0
v_mfma_f32_16x16x32_bf16 v[64:67], v[80:83], v[208:211], v[64:67]
v_mfma_f32_16x16x32_bf16 v[68:71], v[80:83], v[212:215], v[68:71]
v_mfma_f32_16x16x32_bf16 v[64:67], v[80:83], v[216:219], v[64:67]
v_mfma_f32_16x16x32_bf16 v[68:71], v[80:83], v[220:223], v[68:71]
s_waitcnt vmcnt(4)
s_nop 0
ds_read_b128 v[240:243], v106 offset:8192
ds_read_b128 v[244:247], v106 offset:26624
ds_read_b128 v[248:251], v107 offset:8192
ds_read_b128 v[252:255], v107 offset:26624
WL 4
s_nop 0
v_mfma_f32_16x16x32_bf16 v[64:67], v[80:83], v[224:227], v[64:67]
v_mfma_f32_16x16x32_bf16 v[68:71], v[80:83], v[228:231], v[68:71]
v_mfma_f32_16x16x32_bf16 v[64:67], v[80:83], v[232:235], v[64:67]
v_mfma_f32_16x16x32_bf16 v[68:71], v[80:83], v[236:239], v[68:71]
WL 0
s_nop 0
v_mfma_f32_16x16x32_bf16 v[64:67], v[80:83], v[240:243], v[64:67]
v_mfma_f32_16x16x32_bf16 v[68:71], v[80:83], v[244:247], v[68:71]
v_mfma_f32_16x16x32_bf16 v[64:67], v[80:83], v[248:251], v[64:67]
v_mfma_f32_16x16x32_bf16 v[68:71], v[80:83], v[252:255], v[68:71]
s_barrier
s_add_u32 m0, s37, 0
s_add_u32 s36, s38, 589824
buffer_load_dwordx4 v1, s[12:15], s36 offen offset:0  lds
buffer_load_dwordx4 v2, s[12:15], s36 offen offset:1024  lds
buffer_load_dwordx4 v3, s[12:15], s36 offen offset:2048  lds
buffer_load_dwordx4 v4, s[12:15], s36 offen offset:3072  lds
s_add_u32 m0, s37, 16384
s_add_u32 s36, s38, 1179648
buffer_load_dwordx4 v1, s[12:15], s36 offen offset:0  lds
buffer_load_dwordx4 v2, s[12:15], s36 offen offset:1024  lds
buffer_load_dwordx4 v3, s[12:15], s36 offen offset:2048  lds
buffer_load_dwordx4 v4, s[12:15], s36 offen offset:3072  lds
buffer_load_dword v31, v29, s[12:15], s38 offen offset:0
s_nop 3
s_mov_b32 s35, 0xbae38e39
v_mul_f32 v78, s35, v64
v_mul_f32_e64 v79, s35, v68
CV 108,78,79
v_lshlrev_b32 v64, 16, v108
v_lshlrev_b32 v65, 16, v108
v_lshlrev_b32 v66, 16, v108
v_lshlrev_b32 v67, 16, v108
v_and_b32 v68, 0xffff0000, v108
v_and_b32 v69, 0xffff0000, v108
v_and_b32 v70, 0xffff0000, v108
v_and_b32 v71, 0xffff0000, v108
s_nop 1
s_nop 0
v_mfma_f32_16x16x32_bf16 v[32:35], v[74:77], v[112:115], v[64:67]
v_mfma_f32_16x16x32_bf16 v[36:39], v[72:75], v[112:115], v[64:67]
v_mfma_f32_16x16x32_bf16 v[40:43], v[74:77], v[116:119], v[68:71]
v_mfma_f32_16x16x32_bf16 v[44:47], v[72:75], v[116:119], v[68:71]
v_mfma_f32_16x16x32_bf16 v[48:51], v[74:77], v[120:123], v[64:67]
s_nop 3
s_nop 0
CV 112,32,33
CV 113,34,35
v_mfma_f32_16x16x32_bf16 v[52:55], v[72:75], v[120:123], v[64:67]
CV 114,36,37
CV 115,38,39
v_mfma_f32_16x16x32_bf16 v[56:59], v[74:77], v[124:127], v[68:71]
CV 116,40,41
CV 117,42,43
v_mfma_f32_16x16x32_bf16 v[60:63], v[72:75], v[124:127], v[68:71]
CV 118,44,45
CV 119,46,47
v_mfma_f32_16x16x32_bf16 v[32:35], v[74:77], v[128:131], v[64:67]
CV 120,48,49
CV 121,50,51
v_mfma_f32_16x16x32_bf16 v[36:39], v[72:75], v[128:131], v[64:67]
CV 122,52,53
CV 123,54,55
v_mfma_f32_16x16x32_bf16 v[40:43], v[74:77], v[132:135], v[68:71]
CV 124,56,57
CV 125,58,59
v_mfma_f32_16x16x32_bf16 v[44:47], v[72:75], v[132:135], v[68:71]
CV 126,60,61
CV 127,62,63
v_mfma_f32_16x16x32_bf16 v[48:51], v[74:77], v[136:139], v[64:67]
CV 128,32,33
CV 129,34,35
v_mfma_f32_16x16x32_bf16 v[52:55], v[72:75], v[136:139], v[64:67]
CV 130,36,37
CV 131,38,39
v_mfma_f32_16x16x32_bf16 v[56:59], v[74:77], v[140:143], v[68:71]
CV 132,40,41
CV 133,42,43
v_mfma_f32_16x16x32_bf16 v[60:63], v[72:75], v[140:143], v[68:71]
CV 134,44,45
CV 135,46,47
v_mfma_f32_16x16x32_bf16 v[32:35], v[74:77], v[144:147], v[64:67]
CV 136,48,49
CV 137,50,51
v_mfma_f32_16x16x32_bf16 v[36:39], v[72:75], v[144:147], v[64:67]
CV 138,52,53
CV 139,54,55
v_mfma_f32_16x16x32_bf16 v[40:43], v[74:77], v[148:151], v[68:71]
CV 140,56,57
CV 141,58,59
v_mfma_f32_16x16x32_bf16 v[44:47], v[72:75], v[148:151], v[68:71]
CV 142,60,61
CV 143,62,63
v_mfma_f32_16x16x32_bf16 v[48:51], v[74:77], v[152:155], v[64:67]
CV 144,32,33
CV 145,34,35
v_mfma_f32_16x16x32_bf16 v[52:55], v[72:75], v[152:155], v[64:67]
CV 146,36,37
CV 147,38,39
v_mfma_f32_16x16x32_bf16 v[56:59], v[74:77], v[156:159], v[68:71]
CV 148,40,41
CV 149,42,43
v_mfma_f32_16x16x32_bf16 v[60:63], v[72:75], v[156:159], v[68:71]
CV 150,44,45
CV 151,46,47
v_mfma_f32_16x16x32_bf16 v[32:35], v[74:77], v[160:163], v[64:67]
CV 152,48,49
CV 153,50,51
v_mfma_f32_16x16x32_bf16 v[36:39], v[72:75], v[160:163], v[64:67]
CV 154,52,53
CV 155,54,55
v_mfma_f32_16x16x32_bf16 v[40:43], v[74:77], v[164:167], v[68:71]
CV 156,56,57
CV 157,58,59
v_mfma_f32_16x16x32_bf16 v[44:47], v[72:75], v[164:167], v[68:71]
CV 158,60,61
CV 159,62,63
v_mfma_f32_16x16x32_bf16 v[48:51], v[74:77], v[168:171], v[64:67]
CV 160,32,33
CV 161,34,35
v_mfma_f32_16x16x32_bf16 v[52:55], v[72:75], v[168:171], v[64:67]
CV 162,36,37
CV 163,38,39
v_mfma_f32_16x16x32_bf16 v[56:59], v[74:77], v[172:175], v[68:71]
CV 164,40,41
CV 165,42,43
v_mfma_f32_16x16x32_bf16 v[60:63], v[72:75], v[172:175], v[68:71]
CV 166,44,45
CV 167,46,47
v_mfma_f32_16x16x32_bf16 v[32:35], v[74:77], v[176:179], v[64:67]
CV 168,48,49
CV 169,50,51
v_mfma_f32_16x16x32_bf16 v[36:39], v[72:75], v[176:179], v[64:67]
CV 170,52,53
CV 171,54,55
v_mfma_f32_16x16x32_bf16 v[40:43], v[74:77], v[180:183], v[68:71]
CV 172,56,57
CV 173,58,59
v_mfma_f32_16x16x32_bf16 v[44:47], v[72:75], v[180:183], v[68:71]
CV 174,60,61
CV 175,62,63
v_mfma_f32_16x16x32_bf16 v[48:51], v[74:77], v[184:187], v[64:67]
CV 176,32,33
CV 177,34,35
v_mfma_f32_16x16x32_bf16 v[52:55], v[72:75], v[184:187], v[64:67]
CV 178,36,37
CV 179,38,39
v_mfma_f32_16x16x32_bf16 v[56:59], v[74:77], v[188:191], v[68:71]
CV 180,40,41
CV 181,42,43
v_mfma_f32_16x16x32_bf16 v[60:63], v[72:75], v[188:191], v[68:71]
CV 182,44,45
CV 183,46,47
v_mfma_f32_16x16x32_bf16 v[32:35], v[74:77], v[192:195], v[64:67]
CV 184,48,49
CV 185,50,51
v_mfma_f32_16x16x32_bf16 v[36:39], v[72:75], v[192:195], v[64:67]
CV 186,52,53
CV 187,54,55
v_mfma_f32_16x16x32_bf16 v[40:43], v[74:77], v[196:199], v[68:71]
CV 188,56,57
CV 189,58,59
v_mfma_f32_16x16x32_bf16 v[44:47], v[72:75], v[196:199], v[68:71]
CV 190,60,61
CV 191,62,63
v_mfma_f32_16x16x32_bf16 v[48:51], v[74:77], v[200:203], v[64:67]
CV 192,32,33
CV 193,34,35
v_mfma_f32_16x16x32_bf16 v[52:55], v[72:75], v[200:203], v[64:67]
CV 194,36,37
CV 195,38,39
v_mfma_f32_16x16x32_bf16 v[56:59], v[74:77], v[204:207], v[68:71]
CV 196,40,41
CV 197,42,43
v_mfma_f32_16x16x32_bf16 v[60:63], v[72:75], v[204:207], v[68:71]
CV 198,44,45
CV 199,46,47
v_mfma_f32_16x16x32_bf16 v[32:35], v[74:77], v[208:211], v[64:67]
CV 200,48,49
CV 201,50,51
v_mfma_f32_16x16x32_bf16 v[36:39], v[72:75], v[208:211], v[64:67]
CV 202,52,53
CV 203,54,55
v_mfma_f32_16x16x32_bf16 v[40:43], v[74:77], v[212:215], v[68:71]
CV 204,56,57
CV 205,58,59
v_mfma_f32_16x16x32_bf16 v[44:47], v[72:75], v[212:215], v[68:71]
CV 206,60,61
CV 207,62,63
v_mfma_f32_16x16x32_bf16 v[48:51], v[74:77], v[216:219], v[64:67]
CV 208,32,33
CV 209,34,35
v_mfma_f32_16x16x32_bf16 v[52:55], v[72:75], v[216:219], v[64:67]
CV 210,36,37
CV 211,38,39
v_mfma_f32_16x16x32_bf16 v[56:59], v[74:77], v[220:223], v[68:71]
CV 212,40,41
CV 213,42,43
v_mfma_f32_16x16x32_bf16 v[60:63], v[72:75], v[220:223], v[68:71]
CV 214,44,45
CV 215,46,47
v_mfma_f32_16x16x32_bf16 v[32:35], v[74:77], v[224:227], v[64:67]
CV 216,48,49
CV 217,50,51
v_mfma_f32_16x16x32_bf16 v[36:39], v[72:75], v[224:227], v[64:67]
CV 218,52,53
CV 219,54,55
v_mfma_f32_16x16x32_bf16 v[40:43], v[74:77], v[228:231], v[68:71]
CV 220,56,57
CV 221,58,59
v_mfma_f32_16x16x32_bf16 v[44:47], v[72:75], v[228:231], v[68:71]
CV 222,60,61
CV 223,62,63
v_mfma_f32_16x16x32_bf16 v[48:51], v[74:77], v[232:235], v[64:67]
CV 224,32,33
CV 225,34,35
v_mfma_f32_16x16x32_bf16 v[52:55], v[72:75], v[232:235], v[64:67]
CV 226,36,37
CV 227,38,39
v_mfma_f32_16x16x32_bf16 v[56:59], v[74:77], v[236:239], v[68:71]
CV 228,40,41
CV 229,42,43
v_mfma_f32_16x16x32_bf16 v[60:63], v[72:75], v[236:239], v[68:71]
CV 230,44,45
CV 231,46,47
v_mfma_f32_16x16x32_bf16 v[32:35], v[74:77], v[240:243], v[64:67]
CV 232,48,49
CV 233,50,51
v_mfma_f32_16x16x32_bf16 v[36:39], v[72:75], v[240:243], v[64:67]
CV 234,52,53
CV 235,54,55
v_mfma_f32_16x16x32_bf16 v[40:43], v[74:77], v[244:247], v[68:71]
CV 236,56,57
CV 237,58,59
v_mfma_f32_16x16x32_bf16 v[44:47], v[72:75], v[244:247], v[68:71]
CV 238,60,61
CV 239,62,63
v_mfma_f32_16x16x32_bf16 v[48:51], v[74:77], v[248:251], v[64:67]
CV 240,32,33
CV 241,34,35
v_mfma_f32_16x16x32_bf16 v[52:55], v[72:75], v[248:251], v[64:67]
CV 242,36,37
CV 243,38,39
v_mfma_f32_16x16x32_bf16 v[56:59], v[74:77], v[252:255], v[68:71]
CV 244,40,41
CV 245,42,43
v_mfma_f32_16x16x32_bf16 v[60:63], v[72:75], v[252:255], v[68:71]
CV 246,44,45
CV 247,46,47
s_nop 3
s_nop 0
CV 248,48,49
CV 249,50,51
CV 250,52,53
CV 251,54,55
s_nop 3
s_nop 0
CV 252,56,57
CV 253,58,59
CV 254,60,61
CV 255,62,63
s_nop 3
s_lshr_b32 s101, s2, 3
s_sub_u32 s101, s101, 8
s_lshl_b32 s101, s101, 2
s_add_u32 s101, s101, s32
s_lshl_b32 s101, s101, 6
s_add_u32 s101, s101, 9216
s_waitcnt vmcnt(5)
s_barrier
RT 144,17,16384
RT 146,17,16896
RT 148,17,24576
RT 150,17,25088
RT 152,18,16384
RT 154,18,16896
RT 156,18,24576
RT 158,18,25088
RT 160,19,16384
RT 162,19,16896
RT 164,19,24576
RT 166,19,25088
RT 168,20,16384
RT 170,20,16896
WL 6
s_nop 0
v_mfma_f32_16x16x32_bf16 v[32:35], a[144:147], v[112:115], 0
RT 172,20,24576
RT 174,20,25088
v_mfma_f32_16x16x32_bf16 v[36:39], a[144:147], v[116:119], 0
s_add_u32 m0, s37, 32768
s_add_u32 s36, s38, 1769472
v_mfma_f32_16x16x32_bf16 v[44:47], a[148:151], v[116:119], 0
RT 144,17,20480
RT 146,17,20992
v_mfma_f32_16x16x32_bf16 v[40:43], a[148:151], v[112:115], 0
buffer_load_dwordx4 v1, s[12:15], s36 offen offset:0  lds
v_mfma_f32_16x16x32_bf16 v[48:51], a[152:155], v[112:115], 0
RT 148,17,28672
RT 150,17,29184
v_mfma_f32_16x16x32_bf16 v[52:55], a[152:155], v[116:119], 0
v_accvgpr_write_b32 a0, v112
v_accvgpr_write_b32 a1, v113
v_mfma_f32_16x16x32_bf16 v[60:63], a[156:159], v[116:119], 0
RT 152,18,20480
RT 154,18,20992
v_mfma_f32_16x16x32_bf16 v[56:59], a[156:159], v[112:115], 0
WL 6
s_nop 0
v_accvgpr_write_b32 a2, v114
v_mfma_f32_16x16x32_bf16 v[64:67], a[160:163], v[112:115], 0
RT 156,18,28672
RT 158,18,29184
v_mfma_f32_16x16x32_bf16 v[68:71], a[160:163], v[116:119], 0
buffer_load_dwordx4 v2, s[12:15], s36 offen offset:1024  lds
v_mfma_f32_16x16x32_bf16 v[76:79], a[164:167], v[116:119], 0
RT 160,19,20480
RT 162,19,20992
v_mfma_f32_16x16x32_bf16 v[72:75], a[164:167], v[112:115], 0
v_accvgpr_write_b32 a3, v115
v_accvgpr_write_b32 a4, v116
v_mfma_f32_16x16x32_bf16 v[80:83], a[168:171], v[112:115], 0
RT 164,19,28672
RT 166,19,29184
v_mfma_f32_16x16x32_bf16 v[84:87], a[168:171], v[116:119], 0
buffer_load_dwordx4 v3, s[12:15], s36 offen offset:2048  lds
v_mfma_f32_16x16x32_bf16 v[92:95], a[172:175], v[116:119], 0
RT 168,20,20480
RT 170,20,20992
v_mfma_f32_16x16x32_bf16 v[88:91], a[172:175], v[112:115], 0
WL 6
s_nop 0
v_accvgpr_write_b32 a5, v117
MV 32,144,120
RT 172,20,28672
RT 174,20,29184
MV 36,144,124
buffer_load_dwordx4 v4, s[12:15], s36 offen offset:3072  lds
MV 44,148,124
RT 144,9,0
RT 146,9,512
MV 40,148,120
s_add_u32 m0, s37, 49152
s_add_u32 s36, s38, 2359296
MV 48,152,120
RT 148,9,8192
RT 150,9,8704
MV 52,152,124
buffer_load_dwordx4 v1, s[12:15], s36 offen offset:0  lds
MV 60,156,124
RT 152,10,0
RT 154,10,512
MV 56,156,120
WL 6
s_nop 0
v_accvgpr_write_b32 a6, v118
MV 64,160,120
RT 156,10,8192
RT 158,10,8704
MV 68,160,124
buffer_load_dwordx4 v2, s[12:15], s36 offen offset:1024  lds
MV 76,164,124
RT 160,11,0
RT 162,11,512
MV 72,164,120
v_accvgpr_write_b32 a7, v119
v_accvgpr_write_b32 a8, v120
MV 80,168,120
RT 164,11,8192
RT 166,11,8704
MV 84,168,124
buffer_load_dwordx4 v3, s[12:15], s36 offen offset:2048  lds
MV 92,172,124
RT 168,12,0
RT 170,12,512
MV 88,172,120
WL 6
s_nop 0
v_accvgpr_write_b32 a9, v121
MV 32,144,128
RT 172,12,8192
RT 174,12,8704
MV 36,144,132
buffer_load_dwordx4 v4, s[12:15], s36 offen offset:3072  lds
MV 44,148,132
RT 144,9,4096
RT 146,9,4608
MV 40,148,128
s_add_u32 m0, s37, 65536
s_add_u32 s36, s38, 2949120
MV 48,152,128
RT 148,9,12288
RT 150,9,12800
MV 52,152,132
buffer_load_dwordx4 v1, s[12:15], s36 offen offset:0  lds
MV 60,156,132
RT 152,10,4096
RT 154,10,4608
MV 56,156,128
WL 6
s_nop 0
v_accvgpr_write_b32 a10, v122
MV 64,160,128
RT 156,10,12288
RT 158,10,12800
MV 68,160,132
s_getpc_b64 s[6:7]
s_nop 0
s_load_dword s5, s[6:7], s101
MV 76,164,132
RT 160,11,4096
RT 162,11,4608
MV 72,164,128
buffer_load_dwordx4 v2, s[12:15], s36 offen offset:1024  lds
MV 80,168,128
RT 164,11,12288
RT 166,11,12800
MV 84,168,132
v_accvgpr_write_b32 a11, v123
v_accvgpr_write_b32 a12, v124
MV 92,172,132
RT 168,12,4096
RT 170,12,4608
MV 88,172,128
WL 6
s_nop 0
v_accvgpr_write_b32 a13, v125
MV 32,144,136
RT 172,12,12288
RT 174,12,12800
MV 36,144,140
s_waitcnt vmcnt(6)
s_barrier
MV 44,148,140
RT 144,9,16384
RT 146,9,16896
MV 40,148,136
buffer_load_dwordx4 v3, s[12:15], s36 offen offset:2048  lds
MV 48,152,136
RT 148,9,24576
RT 150,9,25088
MV 52,152,140
v_accvgpr_write_b32 a14, v126
v_accvgpr_write_b32 a15, v127
MV 60,156,140
RT 152,10,16384
RT 154,10,16896
MV 56,156,136
WL 6
s_nop 0
v_accvgpr_write_b32 a16, v128
MV 64,160,136
RT 156,10,24576
RT 158,10,25088
MV 68,160,140
buffer_load_dwordx4 v4, s[12:15], s36 offen offset:3072  lds
MV 76,164,140
RT 160,11,16384
RT 162,11,16896
MV 72,164,136
s_add_u32 m0, s37, 81920
s_add_u32 s36, s38, 3538944
MV 80,168,136
RT 164,11,24576
RT 166,11,25088
MV 84,168,140
buffer_load_dwordx4 v1, s[12:15], s36 offen offset:0  lds
MV 92,172,140
RT 168,12,16384
RT 170,12,16896
MV 88,172,136
WL 6
s_nop 0
v_accvgpr_write_b32 a17, v129
MV 32,144,144
RT 172,12,24576
RT 174,12,25088
MV 36,144,148
buffer_load_dwordx4 v2, s[12:15], s36 offen offset:1024  lds
MV 44,148,148
RT 144,9,20480
RT 146,9,20992
MV 40,148,144
v_accvgpr_write_b32 a18, v130
v_accvgpr_write_b32 a19, v131
v_accvgpr_write_b32 a20, v132
MV 48,152,144
RT 148,9,28672
RT 150,9,29184
MV 52,152,148
buffer_load_dwordx4 v3, s[12:15], s36 offen offset:2048  lds
MV 60,156,148
RT 152,10,20480
RT 154,10,20992
MV 56,156,144
WL 6
s_nop 0
v_accvgpr_write_b32 a21, v133
v_accvgpr_write_b32 a22, v134
MV 64,160,144
RT 156,10,28672
RT 158,10,29184
MV 68,160,148
buffer_load_dwordx4 v4, s[12:15], s36 offen offset:3072  lds
MV 76,164,148
RT 160,11,20480
RT 162,11,20992
MV 72,164,144
s_add_u32 m0, s37, 98304
s_add_u32 s36, s38, 4128768
MV 80,168,144
RT 164,11,28672
RT 166,11,29184
MV 84,168,148
buffer_load_dwordx4 v1, s[12:15], s36 offen offset:0  lds
MV 92,172,148
RT 168,12,20480
RT 170,12,20992
MV 88,172,144
WL 6
s_nop 0
v_accvgpr_write_b32 a23, v135
v_accvgpr_write_b32 a24, v136
MV 32,144,152
RT 172,12,28672
RT 174,12,29184
MV 36,144,156
buffer_load_dwordx4 v2, s[12:15], s36 offen offset:1024  lds
MV 44,148,156
RT 144,9,32768
RT 146,9,33280
MV 40,148,152
v_accvgpr_write_b32 a25, v137
v_accvgpr_write_b32 a26, v138
v_accvgpr_write_b32 a27, v139
MV 48,152,152
RT 148,9,40960
RT 150,9,41472
MV 52,152,156
buffer_load_dwordx4 v3, s[12:15], s36 offen offset:2048  lds
MV 60,156,156
RT 152,10,32768
RT 154,10,33280
MV 56,156,152
WL 6
s_nop 0
v_accvgpr_write_b32 a28, v140
v_accvgpr_write_b32 a29, v141
MV 64,160,152
RT 156,10,40960
RT 158,10,41472
MV 68,160,156
buffer_load_dwordx4 v4, s[12:15], s36 offen offset:3072  lds
MV 76,164,156
RT 160,11,32768
RT 162,11,33280
MV 72,164,152
s_add_u32 m0, s37, 114688
s_add_u32 s36, s38, 4718592
MV 80,168,152
RT 164,11,40960
RT 166,11,41472
MV 84,168,156
buffer_load_dwordx4 v1, s[12:15], s36 offen offset:0  lds
MV 92,172,156
RT 168,12,32768
RT 170,12,33280
MV 88,172,152
WL 6
s_nop 0
v_accvgpr_write_b32 a30, v142
v_accvgpr_write_b32 a31, v143
MV 32,144,160
RT 172,12,40960
RT 174,12,41472
MV 36,144,164
buffer_load_dwordx4 v2, s[12:15], s36 offen offset:1024  lds
MV 44,148,164
RT 144,9,36864
RT 146,9,37376
MV 40,148,160
v_accvgpr_write_b32 a32, v144
v_accvgpr_write_b32 a33, v145
v_accvgpr_write_b32 a34, v146
MV 48,152,160
RT 148,9,45056
RT 150,9,45568
MV 52,152,164
buffer_load_dwordx4 v3, s[12:15], s36 offen offset:2048  lds
MV 60,156,164
RT 152,10,36864
RT 154,10,37376
MV 56,156,160
WL 6
s_nop 0
v_accvgpr_write_b32 a35, v147
v_accvgpr_write_b32 a36, v148
MV 64,160,160
RT 156,10,45056
RT 158,10,45568
MV 68,160,164
buffer_load_dwordx4 v4, s[12:15], s36 offen offset:3072  lds
MV 76,164,164
RT 160,11,36864
RT 162,11,37376
MV 72,164,160
s_add_u32 m0, s37, 131072
s_add_u32 s36, s38, 128
MV 80,168,160
RT 164,11,45056
RT 166,11,45568
MV 84,168,164
buffer_load_dwordx4 v1, s[12:15], s36 offen offset:0  lds
MV 92,172,164
RT 168,12,36864
RT 170,12,37376
MV 88,172,160
WL 6
s_nop 0
v_accvgpr_write_b32 a37, v149
v_accvgpr_write_b32 a38, v150
MV 32,144,168
RT 172,12,45056
RT 174,12,45568
MV 36,144,172
s_waitcnt vmcnt(13)
s_barrier
MV 44,148,172
RT 144,9,49152
RT 146,9,49664
MV 40,148,168
buffer_load_dwordx4 v2, s[12:15], s36 offen offset:1024  lds
MV 48,152,168
RT 148,9,57344
RT 150,9,57856
MV 52,152,172
v_accvgpr_write_b32 a39, v151
v_accvgpr_write_b32 a40, v152
v_accvgpr_write_b32 a41, v153
MV 60,156,172
RT 152,10,49152
RT 154,10,49664
MV 56,156,168
WL 6
s_nop 0
v_accvgpr_write_b32 a42, v154
v_accvgpr_write_b32 a43, v155
MV 64,160,168
RT 156,10,57344
RT 158,10,57856
MV 68,160,172
buffer_load_dwordx4 v3, s[12:15], s36 offen offset:2048  lds
MV 76,164,172
RT 160,11,49152
RT 162,11,49664
MV 72,164,168
v_accvgpr_write_b32 a44, v156
v_accvgpr_write_b32 a45, v157
v_accvgpr_write_b32 a46, v158
MV 80,168,168
RT 164,11,57344
RT 166,11,57856
MV 84,168,172
buffer_load_dwordx4 v4, s[12:15], s36 offen offset:3072  lds
MV 92,172,172
RT 168,12,49152
RT 170,12,49664
MV 88,172,168
WL 6
s_nop 0
s_add_u32 m0, s37, 147456
s_add_u32 s36, s38, 589952
MV 32,144,176
RT 172,12,57344
RT 174,12,57856
MV 36,144,180
buffer_load_dwordx4 v1, s[12:15], s36 offen offset:0  lds
MV 44,148,180
RT 144,9,53248
RT 146,9,53760
MV 40,148,176
v_accvgpr_write_b32 a47, v159
v_accvgpr_write_b32 a48, v160
v_accvgpr_write_b32 a49, v161
MV 48,152,176
RT 148,9,61440
RT 150,9,61952
MV 52,152,180
buffer_load_dwordx4 v2, s[12:15], s36 offen offset:1024  lds
MV 60,156,180
RT 152,10,53248
RT 154,10,53760
MV 56,156,176
WL 6
s_nop 0
v_accvgpr_write_b32 a50, v162
v_accvgpr_write_b32 a51, v163
MV 64,160,176
RT 156,10,61440
RT 158,10,61952
MV 68,160,180
buffer_load_dwordx4 v3, s[12:15], s36 offen offset:2048  lds
MV 76,164,180
RT 160,11,53248
RT 162,11,53760
MV 72,164,176
v_accvgpr_write_b32 a52, v164
v_accvgpr_write_b32 a53, v165
v_accvgpr_write_b32 a54, v166
MV 80,168,176
RT 164,11,61440
RT 166,11,61952
MV 84,168,180
buffer_load_dword v31, v29, s[12:15], s38 offen offset:256
MV 92,172,180
RT 168,12,53248
RT 170,12,53760
MV 88,172,176
WL 6
s_nop 0
v_accvgpr_write_b32 a55, v167
v_accvgpr_write_b32 a56, v168
MV 32,144,184
RT 172,12,61440
RT 174,12,61952
MV 36,144,188
buffer_load_dword v31, v29, s[12:15], s38 offen offset:128
MV 44,148,188
RT 144,13,0
RT 146,13,512
MV 40,148,184
v_accvgpr_write_b32 a57, v169
v_accvgpr_write_b32 a58, v170
v_accvgpr_write_b32 a59, v171
MV 48,152,184
RT 148,13,8192
RT 150,13,8704
MV 52,152,188
v_accvgpr_write_b32 a60, v172
v_accvgpr_write_b32 a61, v173
v_accvgpr_write_b32 a62, v174
MV 60,156,188
RT 152,14,0
RT 154,14,512
MV 56,156,184
WL 6
s_nop 0
v_accvgpr_write_b32 a63, v175
v_accvgpr_write_b32 a64, v176
MV 64,160,184
RT 156,14,8192
RT 158,14,8704
MV 68,160,188
v_accvgpr_write_b32 a65, v177
v_accvgpr_write_b32 a66, v178
v_accvgpr_write_b32 a67, v179
MV 76,164,188
RT 160,15,0
RT 162,15,512
MV 72,164,184
v_accvgpr_write_b32 a68, v180
v_accvgpr_write_b32 a69, v181
v_accvgpr_write_b32 a70, v182
MV 80,168,184
RT 164,15,8192
RT 166,15,8704
MV 84,168,188
v_accvgpr_write_b32 a71, v183
v_accvgpr_write_b32 a72, v184
v_accvgpr_write_b32 a73, v185
MV 92,172,188
RT 168,16,0
RT 170,16,512
MV 88,172,184
WL 6
s_nop 0
v_accvgpr_write_b32 a74, v186
v_accvgpr_write_b32 a75, v187
MV 32,144,192
RT 172,16,8192
RT 174,16,8704
MV 36,144,196
v_accvgpr_write_b32 a76, v188
v_accvgpr_write_b32 a77, v189
v_accvgpr_write_b32 a78, v190
MV 44,148,196
RT 144,13,4096
RT 146,13,4608
MV 40,148,192
v_accvgpr_write_b32 a79, v191
v_accvgpr_write_b32 a80, v192
v_accvgpr_write_b32 a81, v193
MV 48,152,192
RT 148,13,12288
RT 150,13,12800
MV 52,152,196
v_accvgpr_write_b32 a82, v194
v_accvgpr_write_b32 a83, v195
v_accvgpr_write_b32 a84, v196
MV 60,156,196
RT 152,14,4096
RT 154,14,4608
MV 56,156,192
WL 6
s_nop 0
v_accvgpr_write_b32 a85, v197
v_accvgpr_write_b32 a86, v198
MV 64,160,192
RT 156,14,12288
RT 158,14,12800
MV 68,160,196
v_accvgpr_write_b32 a87, v199
v_accvgpr_write_b32 a88, v200
v_accvgpr_write_b32 a89, v201
MV 76,164,196
RT 160,15,4096
RT 162,15,4608
MV 72,164,192
v_accvgpr_write_b32 a90, v202
v_accvgpr_write_b32 a91, v203
v_accvgpr_write_b32 a92, v204
MV 80,168,192
RT 164,15,12288
RT 166,15,12800
MV 84,168,196
v_accvgpr_write_b32 a93, v205
v_accvgpr_write_b32 a94, v206
v_accvgpr_write_b32 a95, v207
MV 92,172,196
RT 168,16,4096
RT 170,16,4608
MV 88,172,192
WL 6
s_nop 0
v_accvgpr_write_b32 a96, v208
v_accvgpr_write_b32 a97, v209
MV 32,144,200
RT 172,16,12288
RT 174,16,12800
MV 36,144,204
s_waitcnt vmcnt(13)
s_barrier
MV 44,148,204
RT 144,13,16384
RT 146,13,16896
MV 40,148,200
v_accvgpr_write_b32 a98, v210
v_accvgpr_write_b32 a99, v211
v_accvgpr_write_b32 a100, v212
MV 48,152,200
RT 148,13,24576
RT 150,13,25088
MV 52,152,204
v_accvgpr_write_b32 a101, v213
v_accvgpr_write_b32 a102, v214
v_accvgpr_write_b32 a103, v215
MV 60,156,204
RT 152,14,16384
RT 154,14,16896
MV 56,156,200
WL 6
s_nop 0
v_accvgpr_write_b32 a104, v216
v_accvgpr_write_b32 a105, v217
MV 64,160,200
RT 156,14,24576
RT 158,14,25088
MV 68,160,204
v_accvgpr_write_b32 a106, v218
v_accvgpr_write_b32 a107, v219
v_accvgpr_write_b32 a108, v220
MV 76,164,204
RT 160,15,16384
RT 162,15,16896
MV 72,164,200
v_accvgpr_write_b32 a109, v221
v_accvgpr_write_b32 a110, v222
v_accvgpr_write_b32 a111, v223
MV 80,168,200
RT 164,15,24576
RT 166,15,25088
MV 84,168,204
v_accvgpr_write_b32 a112, v224
v_accvgpr_write_b32 a113, v225
v_accvgpr_write_b32 a114, v226
MV 92,172,204
RT 168,16,16384
RT 170,16,16896
MV 88,172,200
WL 6
s_nop 0
v_accvgpr_write_b32 a115, v227
v_accvgpr_write_b32 a116, v228
MV 32,144,208
RT 172,16,24576
RT 174,16,25088
MV 36,144,212
v_accvgpr_write_b32 a117, v229
v_accvgpr_write_b32 a118, v230
v_accvgpr_write_b32 a119, v231
MV 44,148,212
RT 144,13,20480
RT 146,13,20992
MV 40,148,208
v_accvgpr_write_b32 a120, v232
v_accvgpr_write_b32 a121, v233
v_accvgpr_write_b32 a122, v234
MV 48,152,208
RT 148,13,28672
RT 150,13,29184
MV 52,152,212
v_accvgpr_write_b32 a123, v235
v_accvgpr_write_b32 a124, v236
v_accvgpr_write_b32 a125, v237
MV 60,156,212
RT 152,14,20480
RT 154,14,20992
MV 56,156,208
WL 6
s_nop 0
v_accvgpr_write_b32 a126, v238
v_accvgpr_write_b32 a127, v239
MV 64,160,208
RT 156,14,28672
RT 158,14,29184
MV 68,160,212
v_accvgpr_write_b32 a128, v240
v_accvgpr_write_b32 a129, v241
v_accvgpr_write_b32 a130, v242
MV 76,164,212
RT 160,15,20480
RT 162,15,20992
MV 72,164,208
v_accvgpr_write_b32 a131, v243
v_accvgpr_write_b32 a132, v244
v_accvgpr_write_b32 a133, v245
MV 80,168,208
RT 164,15,28672
RT 166,15,29184
MV 84,168,212
v_accvgpr_write_b32 a134, v246
v_accvgpr_write_b32 a135, v247
v_accvgpr_write_b32 a136, v248
MV 92,172,212
RT 168,16,20480
RT 170,16,20992
MV 88,172,208
WL 6
s_nop 0
v_accvgpr_write_b32 a137, v249
v_accvgpr_write_b32 a138, v250
MV 32,144,216
RT 172,16,28672
RT 174,16,29184
MV 36,144,220
v_accvgpr_write_b32 a139, v251
v_accvgpr_write_b32 a140, v252
v_accvgpr_write_b32 a141, v253
MV 44,148,220
RT 144,13,32768
RT 146,13,33280
MV 40,148,216
v_accvgpr_write_b32 a142, v254
v_accvgpr_write_b32 a143, v255
v_add_u32 v22, 17408, v25
MV 48,152,216
RT 148,13,40960
RT 150,13,41472
MV 52,152,220
MV 60,156,220
RT 152,14,32768
RT 154,14,33280
MV 56,156,216
WL 6
s_nop 0
MV 64,160,216
RT 156,14,40960
RT 158,14,41472
MV 68,160,220
MV 76,164,220
RT 160,15,32768
RT 162,15,33280
MV 72,164,216
MV 80,168,216
RT 164,15,40960
RT 166,15,41472
MV 84,168,220
buffer_load_dwordx4 v4, s[12:15], s36 offen offset:3072  lds
MV 92,172,220
RT 168,16,32768
RT 170,16,33280
MV 88,172,216
WL 6
s_add_u32 m0, s37, 0
s_add_u32 s36, s38, 1179776
MV 32,144,224
RT 172,16,40960
RT 174,16,41472
MV 36,144,228
buffer_load_dwordx4 v1, s[12:15], s36 offen offset:0  lds
MV 44,148,228
RT 144,13,36864
RT 146,13,37376
MV 40,148,224
MV 48,152,224
RT 148,13,45056
RT 150,13,45568
MV 52,152,228
buffer_load_dwordx4 v2, s[12:15], s36 offen offset:1024  lds
MV 60,156,228
RT 152,14,36864
RT 154,14,37376
MV 56,156,224
WL 6
s_nop 0
MV 64,160,224
RT 156,14,45056
RT 158,14,45568
MV 68,160,228
buffer_load_dwordx4 v3, s[12:15], s36 offen offset:2048  lds
MV 76,164,228
RT 160,15,36864
RT 162,15,37376
MV 72,164,224
MV 80,168,224
RT 164,15,45056
RT 166,15,45568
MV 84,168,228
buffer_load_dwordx4 v4, s[12:15], s36 offen offset:3072  lds
MV 92,172,228
RT 168,16,36864
RT 170,16,37376
MV 88,172,224
WL 6
s_nop 0
s_add_u32 m0, s37, 16384
s_add_u32 s36, s38, 1769600
MV 32,144,232
RT 172,16,45056
RT 174,16,45568
MV 36,144,236
s_waitcnt vmcnt(10)
s_barrier
MV 44,148,236
RT 144,13,49152
RT 146,13,49664
MV 40,148,232
buffer_load_dwordx4 v1, s[12:15], s36 offen offset:0  lds
MV 48,152,232
RT 148,13,57344
RT 150,13,57856
MV 52,152,236
MV 60,156,236
RT 152,14,49152
RT 154,14,49664
MV 56,156,232
WL 6
s_nop 0
MV 64,160,232
RT 156,14,57344
RT 158,14,57856
MV 68,160,236
buffer_load_dwordx4 v2, s[12:15], s36 offen offset:1024  lds
MV 76,164,236
RT 160,15,49152
RT 162,15,49664
MV 72,164,232
MV 80,168,232
RT 164,15,57344
RT 166,15,57856
MV 84,168,236
buffer_load_dwordx4 v3, s[12:15], s36 offen offset:2048  lds
MV 92,172,236
RT 168,16,49152
RT 170,16,49664
MV 88,172,232
WL 6
s_nop 0
MV 32,144,240
RT 172,16,57344
RT 174,16,57856
MV 36,144,244
buffer_load_dwordx4 v4, s[12:15], s36 offen offset:3072  lds
MV 44,148,244
RT 144,13,53248
RT 146,13,53760
MV 40,148,240
s_add_u32 m0, s37, 32768
s_add_u32 s36, s38, 2359424
MV 48,152,240
RT 148,13,61440
RT 150,13,61952
MV 52,152,244
buffer_load_dwordx4 v1, s[12:15], s36 offen offset:0  lds
MV 60,156,244
RT 152,14,53248
RT 154,14,53760
MV 56,156,240
WL 6
s_nop 0
MV 64,160,240
RT 156,14,61440
RT 158,14,61952
MV 68,160,244
buffer_load_dwordx4 v2, s[12:15], s36 offen offset:1024  lds
MV 76,164,244
RT 160,15,53248
RT 162,15,53760
MV 72,164,240
MV 80,168,240
RT 164,15,61440
RT 166,15,61952
MV 84,168,244
buffer_load_dwordx4 v3, s[12:15], s36 offen offset:2048  lds
MV 92,172,244
RT 168,16,53248
RT 170,16,53760
MV 88,172,240
WL 6
s_nop 0
MV 32,144,248
RT 172,16,61440
RT 174,16,61952
MV 36,144,252
buffer_load_dwordx4 v4, s[12:15], s36 offen offset:3072  lds
MV 44,148,252
RT 144,17,0
RT 146,17,512
MV 40,148,248
s_add_u32 m0, s37, 49152
s_add_u32 s36, s38, 2949248
MV 48,152,248
RT 148,17,8192
RT 150,17,8704
MV 52,152,252
buffer_load_dwordx4 v1, s[12:15], s36 offen offset:0  lds
MV 60,156,252
RT 152,18,0
RT 154,18,512
MV 56,156,248
WL 6
s_nop 0
MV 64,160,248
RT 156,18,8192
RT 158,18,8704
MV 68,160,252
buffer_load_dwordx4 v2, s[12:15], s36 offen offset:1024  lds
MV 76,164,252
RT 160,19,0
RT 162,19,512
MV 72,164,248
MV 80,168,248
RT 164,19,8192
RT 166,19,8704
MV 84,168,252
buffer_load_dwordx4 v3, s[12:15], s36 offen offset:2048  lds
MV 92,172,252
RT 168,20,0
RT 170,20,512
MV 88,172,248
WL 6
s_nop 0
v_mfma_f32_16x16x32_bf16 v[96:99], a[144:147], a[0:3], 0
RT 172,20,8192
RT 174,20,8704
v_mfma_f32_16x16x32_bf16 v[100:103], a[144:147], a[4:7], 0
buffer_load_dwordx4 v4, s[12:15], s36 offen offset:3072  lds
v_mfma_f32_16x16x32_bf16 v[108:111], a[148:151], a[4:7], 0
RT 144,17,4096
RT 146,17,4608
v_mfma_f32_16x16x32_bf16 v[104:107], a[148:151], a[0:3], 0
s_getpc_b64 s[6:7]
s_nop 0
s_load_dword s5, s[6:7], s101
v_mfma_f32_16x16x32_bf16 v[112:115], a[152:155], a[0:3], 0
RT 148,17,12288
RT 150,17,12800
v_mfma_f32_16x16x32_bf16 v[116:119], a[152:155], a[4:7], 0
s_add_u32 m0, s37, 65536
s_add_u32 s36, s38, 3539072
v_mfma_f32_16x16x32_bf16 v[124:127], a[156:159], a[4:7], 0
RT 152,18,4096
RT 154,18,4608
v_mfma_f32_16x16x32_bf16 v[120:123], a[156:159], a[0:3], 0
WL 6
v_max_f32 v32, 0, v32
v_mfma_f32_16x16x32_bf16 v[128:131], a[160:163], a[0:3], 0
RT 156,18,12288
RT 158,18,12800
v_mfma_f32_16x16x32_bf16 v[132:135], a[160:163], a[4:7], 0
buffer_load_dword v31, v29, s[12:15], s38 offen offset:384
v_mfma_f32_16x16x32_bf16 v[140:143], a[164:167], a[4:7], 0
RT 160,19,4096
RT 162,19,4608
v_mfma_f32_16x16x32_bf16 v[136:139], a[164:167], a[0:3], 0
v_max_f32 v33, 0, v33
v_mul_f32 v32, v32, v40
v_mfma_f32_16x16x32_bf16 v[144:147], a[168:171], a[0:3], 0
RT 164,19,12288
RT 166,19,12800
v_mfma_f32_16x16x32_bf16 v[148:151], a[168:171], a[4:7], 0
v_mul_f32_e64 v33, v33, v41
CV 160,32,33
v_mfma_f32_16x16x32_bf16 v[156:159], a[172:175], a[4:7], 0
RT 168,20,4096
RT 170,20,4608
v_mfma_f32_16x16x32_bf16 v[152:155], a[172:175], a[0:3], 0
WL 6
v_max_f32 v34, 0, v34
MA 96,144,8
RT 172,20,12288
RT 174,20,12800
MA 100,144,12
s_waitcnt vmcnt(13)
s_barrier
MA 108,148,12
RT 144,17,16384
RT 146,17,16896
MA 104,148,8
v_max_f32 v35, 0, v35
v_mul_f32 v34, v34, v42
MA 112,152,8
RT 148,17,24576
RT 150,17,25088
MA 116,152,12
v_mul_f32_e64 v35, v35, v43
CV 161,34,35
MA 124,156,12
RT 152,18,16384
RT 154,18,16896
MA 120,156,8
WL 6
v_max_f32 v36, 0, v36
MA 128,160,8
RT 156,18,24576
RT 158,18,25088
MA 132,160,12
v_max_f32_e64 v37, 0, v37
MA 140,164,12
RT 160,19,16384
RT 162,19,16896
MA 136,164,8
v_mul_f32 v36, v36, v44
v_mul_f32 v37, v37, v45
MA 144,168,8
RT 164,19,24576
RT 166,19,25088
MA 148,168,12
CV 164,36,37
MA 156,172,12
RT 168,20,16384
RT 170,20,16896
MA 152,172,8
WL 6
v_max_f32 v38, 0, v38
MA 96,144,16
RT 172,20,24576
RT 174,20,25088
MA 100,144,20
v_max_f32_e64 v39, 0, v39
MA 108,148,20
RT 144,17,20480
RT 146,17,20992
MA 104,148,16
v_mul_f32_e64 v38, v38, v46
MA 112,152,16
RT 148,17,28672
RT 150,17,29184
MA 116,152,20
v_mul_f32_e64 v39, v39, v47
CV 165,38,39
MA 124,156,20
RT 152,18,20480
RT 154,18,20992
MA 120,156,16
WL 6
v_max_f32 v48, 0, v48
MA 128,160,16
RT 156,18,28672
RT 158,18,29184
MA 132,160,20
v_max_f32_e64 v49, 0, v49
MA 140,164,20
RT 160,19,20480
RT 162,19,20992
MA 136,164,16
v_mul_f32_e64 v48, v48, v56
MA 144,168,16
RT 164,19,28672
RT 166,19,29184
MA 148,168,20
v_mul_f32_e64 v49, v49, v57
MA 156,172,20
RT 168,20,20480
RT 170,20,20992
MA 152,172,16
WL 6
s_nop 0
CV 162,48,49
MA 96,144,24
RT 172,20,28672
RT 174,20,29184
MA 100,144,28
v_max_f32 v50, 0, v50
v_max_f32 v51, 0, v51
MA 108,148,28
RT 144,9,0
RT 146,9,512
MA 104,148,24
v_mul_f32_e64 v50, v50, v58
MA 112,152,24
RT 148,9,8192
RT 150,9,8704
MA 116,152,28
v_mul_f32_e64 v51, v51, v59
MA 124,156,28
RT 152,10,0
RT 154,10,512
MA 120,156,24
WL 6
s_nop 0
CV 163,50,51
MA 128,160,24
RT 156,10,8192
RT 158,10,8704
MA 132,160,28
v_max_f32 v52, 0, v52
v_max_f32 v53, 0, v53
MA 140,164,28
RT 160,11,0
RT 162,11,512
MA 136,164,24
v_mul_f32_e64 v52, v52, v60
MA 144,168,24
RT 164,11,8192
RT 166,11,8704
MA 148,168,28
v_mul_f32_e64 v53, v53, v61
MA 156,172,28
RT 168,12,0
RT 170,12,512
MA 152,172,24
WL 6
s_nop 0
CV 166,52,53
MA 96,144,32
RT 172,12,8192
RT 174,12,8704
MA 100,144,36
v_max_f32_e64 v54, 0, v54
MA 108,148,36
RT 144,9,4096
RT 146,9,4608
MA 104,148,32
v_max_f32 v55, 0, v55
v_mul_f32 v54, v54, v62
MA 112,152,32
RT 148,9,12288
RT 150,9,12800
MA 116,152,36
v_mul_f32_e64 v55, v55, v63
MA 124,156,36
RT 152,10,4096
RT 154,10,4608
MA 120,156,32
WL 6
s_nop 0
CV 167,54,55
MA 128,160,32
RT 156,10,12288
RT 158,10,12800
MA 132,160,36
v_max_f32_e64 v64, 0, v64
MA 140,164,36
RT 160,11,4096
RT 162,11,4608
MA 136,164,32
v_max_f32_e64 v65, 0, v65
MA 144,168,32
RT 164,11,12288
RT 166,11,12800
MA 148,168,36
v_mul_f32_e64 v64, v64, v72
MA 156,172,36
RT 168,12,4096
RT 170,12,4608
MA 152,172,32
WL 6
v_mul_f32 v65, v65, v73
MA 96,144,40
RT 172,12,12288
RT 174,12,12800
MA 100,144,44
s_waitcnt vmcnt(5)
s_barrier
MA 108,148,44
RT 144,9,16384
RT 146,9,16896
MA 104,148,40
CV 168,64,65
v_max_f32_e64 v66, 0, v66
MA 112,152,40
RT 148,9,24576
RT 150,9,25088
MA 116,152,44
v_max_f32 v67, 0, v67
v_mul_f32 v66, v66, v74
MA 124,156,44
RT 152,10,16384
RT 154,10,16896
MA 120,156,40
WL 6
v_mul_f32 v67, v67, v75
MA 128,160,40
RT 156,10,24576
RT 158,10,25088
MA 132,160,44
buffer_load_dwordx4 v1, s[12:15], s36 offen offset:0  lds
MA 140,164,44
RT 160,11,16384
RT 162,11,16896
MA 136,164,40
CV 169,66,67
v_max_f32_e64 v68, 0, v68
MA 144,168,40
RT 164,11,24576
RT 166,11,25088
MA 148,168,44
buffer_load_dwordx4 v2, s[12:15], s36 offen offset:1024  lds
MA 156,172,44
RT 168,12,16384
RT 170,12,16896
MA 152,172,40
WL 6
v_max_f32 v69, 0, v69
MA 96,144,48
RT 172,12,24576
RT 174,12,25088
MA 100,144,52
buffer_load_dwordx4 v3, s[12:15], s36 offen offset:2048  lds
MA 108,148,52
RT 144,9,20480
RT 146,9,20992
MA 104,148,48
v_mul_f32 v68, v68, v76
v_mul_f32 v69, v69, v77
MA 112,152,48
RT 148,9,28672
RT 150,9,29184
MA 116,152,52
buffer_load_dwordx4 v4, s[12:15], s36 offen offset:3072  lds
MA 124,156,52
RT 152,10,20480
RT 154,10,20992
MA 120,156,48
WL 6
s_nop 0
s_add_u32 m0, s37, 81920
s_add_u32 s36, s38, 4128896
MA 128,160,48
RT 156,10,28672
RT 158,10,29184
MA 132,160,52
buffer_load_dwordx4 v1, s[12:15], s36 offen offset:0  lds
MA 140,164,52
RT 160,11,20480
RT 162,11,20992
MA 136,164,48
CV 172,68,69
v_max_f32_e64 v70, 0, v70
MA 144,168,48
RT 164,11,28672
RT 166,11,29184
MA 148,168,52
buffer_load_dwordx4 v2, s[12:15], s36 offen offset:1024  lds
MA 156,172,52
RT 168,12,20480
RT 170,12,20992
MA 152,172,48
WL 6
v_max_f32 v71, 0, v71
MA 96,144,56
RT 172,12,28672
RT 174,12,29184
MA 100,144,60
buffer_load_dwordx4 v3, s[12:15], s36 offen offset:2048  lds
MA 108,148,60
RT 144,9,32768
RT 146,9,33280
MA 104,148,56
v_mul_f32 v70, v70, v78
v_mul_f32 v71, v71, v79
MA 112,152,56
RT 148,9,40960
RT 150,9,41472
MA 116,152,60
buffer_load_dwordx4 v4, s[12:15], s36 offen offset:3072  lds
MA 124,156,60
RT 152,10,32768
RT 154,10,33280
MA 120,156,56
WL 6
s_nop 0
s_add_u32 m0, s37, 98304
s_add_u32 s36, s38, 4718720
MA 128,160,56
RT 156,10,40960
RT 158,10,41472
MA 132,160,60
buffer_load_dwordx4 v1, s[12:15], s36 offen offset:0  lds
MA 140,164,60
RT 160,11,32768
RT 162,11,33280
MA 136,164,56
CV 173,70,71
v_max_f32_e64 v80, 0, v80
MA 144,168,56
RT 164,11,40960
RT 166,11,41472
MA 148,168,60
buffer_load_dwordx4 v2, s[12:15], s36 offen offset:1024  lds
MA 156,172,60
RT 168,12,32768
RT 170,12,33280
MA 152,172,56
WL 6
v_max_f32 v81, 0, v81
MA 96,144,64
RT 172,12,40960
RT 174,12,41472
MA 100,144,68
buffer_load_dwordx4 v3, s[12:15], s36 offen offset:2048  lds
MA 108,148,68
RT 144,9,36864
RT 146,9,37376
MA 104,148,64
v_mul_f32 v80, v80, v88
v_mul_f32 v81, v81, v89
MA 112,152,64
RT 148,9,45056
RT 150,9,45568
MA 116,152,68
buffer_load_dwordx4 v4, s[12:15], s36 offen offset:3072  lds
MA 124,156,68
RT 152,10,36864
RT 154,10,37376
MA 120,156,64
WL 6
s_nop 0
s_add_u32 m0, s37, 114688
s_add_u32 s36, s38, 256
MA 128,160,64
RT 156,10,45056
RT 158,10,45568
MA 132,160,68
buffer_load_dwordx4 v1, s[12:15], s36 offen offset:0  lds
MA 140,164,68
RT 160,11,36864
RT 162,11,37376
MA 136,164,64
CV 170,80,81
v_max_f32_e64 v82, 0, v82
MA 144,168,64
RT 164,11,45056
RT 166,11,45568
MA 148,168,68
buffer_load_dwordx4 v2, s[12:15], s36 offen offset:1024  lds
MA 156,172,68
RT 168,12,36864
RT 170,12,37376
MA 152,172,64
WL 6
v_max_f32 v83, 0, v83
MA 96,144,72
RT 172,12,45056
RT 174,12,45568
MA 100,144,76
s_waitcnt vmcnt(10)
s_barrier
MA 108,148,76
RT 144,9,49152
RT 146,9,49664
MA 104,148,72
buffer_load_dwordx4 v3, s[12:15], s36 offen offset:2048  lds
MA 112,152,72
RT 148,9,57344
RT 150,9,57856
MA 116,152,76
v_mul_f32 v82, v82, v90
v_mul_f32 v83, v83, v91
MA 124,156,76
RT 152,10,49152
RT 154,10,49664
MA 120,156,72
WL 6
s_nop 0
CV 171,82,83
MA 128,160,72
RT 156,10,57344
RT 158,10,57856
MA 132,160,76
buffer_load_dwordx4 v4, s[12:15], s36 offen offset:3072  lds
MA 140,164,76
RT 160,11,49152
RT 162,11,49664
MA 136,164,72
s_add_u32 m0, s37, 131072
s_add_u32 s36, s38, 590080
MA 144,168,72
RT 164,11,57344
RT 166,11,57856
MA 148,168,76
buffer_load_dwordx4 v1, s[12:15], s36 offen offset:0  lds
MA 156,172,76
RT 168,12,49152
RT 170,12,49664
MA 152,172,72
WL 6
v_max_f32 v84, 0, v84
MA 96,144,80
RT 172,12,57344
RT 174,12,57856
MA 100,144,84
buffer_load_dwordx4 v2, s[12:15], s36 offen offset:1024  lds
MA 108,148,84
RT 144,9,53248
RT 146,9,53760
MA 104,148,80
v_max_f32 v85, 0, v85
v_mul_f32 v84, v84, v92
MA 112,152,80
RT 148,9,61440
RT 150,9,61952
MA 116,152,84
buffer_load_dwordx4 v3, s[12:15], s36 offen offset:2048  lds
MA 124,156,84
RT 152,10,53248
RT 154,10,53760
MA 120,156,80
WL 6
v_mul_f32 v85, v85, v93
MA 128,160,80
RT 156,10,61440
RT 158,10,61952
MA 132,160,84
buffer_load_dwordx4 v4, s[12:15], s36 offen offset:3072  lds
MA 140,164,84
RT 160,11,53248
RT 162,11,53760
MA 136,164,80
s_add_u32 m0, s37, 147456
s_add_u32 s36, s38, 1179904
MA 144,168,80
RT 164,11,61440
RT 166,11,61952
MA 148,168,84
buffer_load_dwordx4 v1, s[12:15], s36 offen offset:0  lds
MA 156,172,84
RT 168,12,53248
RT 170,12,53760
MA 152,172,80
WL 6
s_nop 0
CV 174,84,85
MA 96,144,88
RT 172,12,61440
RT 174,12,61952
MA 100,144,92
buffer_load_dwordx4 v2, s[12:15], s36 offen offset:1024  lds
MA 108,148,92
RT 144,13,0
RT 146,13,512
MA 104,148,88
v_max_f32 v86, 0, v86
v_max_f32 v87, 0, v87
MA 112,152,88
RT 148,13,8192
RT 150,13,8704
MA 116,152,92
buffer_load_dwordx4 v3, s[12:15], s36 offen offset:2048  lds
MA 124,156,92
RT 152,14,0
RT 154,14,512
MA 120,156,88
WL 6
v_mul_f32 v86, v86, v94
MA 128,160,88
RT 156,14,8192
RT 158,14,8704
MA 132,160,92
buffer_load_dwordx4 v4, s[12:15], s36 offen offset:3072  lds
MA 140,164,92
RT 160,15,0
RT 162,15,512
MA 136,164,88
s_add_u32 m0, s37, 0
s_nop 0
s_add_u32 s36, s38, 1769728
MA 144,168,88
RT 164,15,8192
RT 166,15,8704
MA 148,168,92
buffer_load_dwordx4 v1, s[12:15], s36 offen offset:0  lds
MA 156,172,92
RT 168,16,0
RT 170,16,512
MA 152,172,88
WL 6
v_mul_f32 v87, v87, v95
MA 96,144,96
RT 172,16,8192
RT 174,16,8704
MA 100,144,100
buffer_load_dwordx4 v2, s[12:15], s36 offen offset:1024  lds
MA 108,148,100
RT 144,13,4096
RT 146,13,4608
MA 104,148,96
CV 175,86,87
s_add_u32 s41, s47, 0
s_nop 0
MA 112,152,96
RT 148,13,12288
RT 150,13,12800
MA 116,152,100
buffer_load_dwordx4 v3, s[12:15], s36 offen offset:2048  lds
MA 124,156,100
RT 152,14,4096
RT 154,14,4608
MA 120,156,96
WL 6
s_nop 0
MA 128,160,96
RT 156,14,12288
RT 158,14,12800
MA 132,160,100
buffer_load_dwordx4 v4, s[12:15], s36 offen offset:3072  lds
MA 140,164,100
RT 160,15,4096
RT 162,15,4608
MA 136,164,96
s_add_u32 m0, s37, 16384
s_add_u32 s36, s38, 2359552
MA 144,168,96
RT 164,15,12288
RT 166,15,12800
MA 148,168,100
buffer_load_dwordx4 v1, s[12:15], s36 offen offset:0  lds
MA 156,172,100
RT 168,16,4096
RT 170,16,4608
MA 152,172,96
WL 6
s_nop 0
buffer_store_dwordx4 v[160:163], v21, s[20:23], s41 offen offset:0 sc1
MA 96,144,104
RT 172,16,12288
RT 174,16,12800
MA 100,144,108
s_waitcnt vmcnt(18)
s_barrier
MA 108,148,108
RT 144,13,16384
RT 146,13,16896
MA 104,148,104
buffer_load_dwordx4 v2, s[12:15], s36 offen offset:1024  lds
MA 112,152,104
RT 148,13,24576
RT 150,13,25088
MA 116,152,108
buffer_store_dwordx4 v[164:167], v21, s[20:23], s41 offen offset:1024 sc1
MA 124,156,108
RT 152,14,16384
RT 154,14,16896
MA 120,156,104
WL 6
s_nop 0
buffer_store_dwordx4 v[168:171], v21, s[20:23], s41 offen offset:2048 sc1
MA 128,160,104
RT 156,14,24576
RT 158,14,25088
MA 132,160,108
buffer_load_dwordx4 v3, s[12:15], s36 offen offset:2048  lds
MA 140,164,108
RT 160,15,16384
RT 162,15,16896
MA 136,164,104
buffer_store_dwordx4 v[172:175], v21, s[20:23], s41 offen offset:3072 sc1
s_lshl_b32 s96, s32, 6
s_nop 0
MA 144,168,104
RT 164,15,24576
RT 166,15,25088
MA 148,168,108
buffer_load_dwordx4 v4, s[12:15], s36 offen offset:3072  lds
MA 156,172,108
RT 168,16,16384
RT 170,16,16896
MA 152,172,104
WL 6
s_nop 0
s_add_u32 m0, s37, 32768
s_add_u32 s36, s38, 2949376
MA 96,144,112
RT 172,16,24576
RT 174,16,25088
MA 100,144,116
buffer_load_dwordx4 v1, s[12:15], s36 offen offset:0  lds
MA 108,148,116
RT 144,13,20480
RT 146,13,20992
MA 104,148,112
v_add_u32 v28, s96, v0
v_cmp_gt_u32 vcc, 16, v28
MA 112,152,112
RT 148,13,28672
RT 150,13,29184
MA 116,152,116
buffer_load_dwordx4 v2, s[12:15], s36 offen offset:1024  lds
MA 124,156,116
RT 152,14,20480
RT 154,14,20992
MA 120,156,112
WL 6
v_lshlrev_b32 v23, 2, v0
MA 128,160,112
RT 156,14,28672
RT 158,14,29184
MA 132,160,116
buffer_load_dwordx4 v3, s[12:15], s36 offen offset:2048  lds
MA 140,164,116
RT 160,15,20480
RT 162,15,20992
MA 136,164,112
v_mov_b32 v28, 0x40000000
v_cndmask_b32 v23, v28, v23, vcc
MA 144,168,112
RT 164,15,28672
RT 166,15,29184
MA 148,168,116
buffer_load_dwordx4 v4, s[12:15], s36 offen offset:3072  lds
MA 156,172,116
RT 168,16,20480
RT 170,16,20992
MA 152,172,112
WL 6
s_nop 0
s_add_u32 m0, s37, 49152
s_add_u32 s36, s38, 3539200
MA 96,144,120
RT 172,16,28672
RT 174,16,29184
MA 100,144,124
buffer_load_dwordx4 v1, s[12:15], s36 offen offset:0  lds
MA 108,148,124
RT 144,13,32768
RT 146,13,33280
MA 104,148,120
MA 112,152,120
RT 148,13,40960
RT 150,13,41472
MA 116,152,124
MA 124,156,124
RT 152,14,32768
RT 154,14,33280
MA 120,156,120
WL 6
s_nop 0
MA 128,160,120
RT 156,14,40960
RT 158,14,41472
MA 132,160,124
buffer_load_dwordx4 v2, s[12:15], s36 offen offset:1024  lds
MA 140,164,124
RT 160,15,32768
RT 162,15,33280
MA 136,164,120
MA 144,168,120
RT 164,15,40960
RT 166,15,41472
MA 148,168,124
s_getpc_b64 s[6:7]
s_nop 0
s_load_dword s5, s[6:7], s101
MA 156,172,124
RT 168,16,32768
RT 170,16,33280
MA 152,172,120
WL 6
s_nop 0
MA 96,144,128
RT 172,16,40960
RT 174,16,41472
MA 100,144,132
buffer_load_dwordx4 v3, s[12:15], s36 offen offset:2048  lds
MA 108,148,132
RT 144,13,36864
RT 146,13,37376
MA 104,148,128
MA 112,152,128
RT 148,13,45056
RT 150,13,45568
MA 116,152,132
MA 124,156,132
RT 152,14,36864
RT 154,14,37376
MA 120,156,128
WL 6
s_nop 0
MA 128,160,128
RT 156,14,45056
RT 158,14,45568
MA 132,160,132
buffer_load_dwordx4 v4, s[12:15], s36 offen offset:3072  lds
MA 140,164,132
RT 160,15,36864
RT 162,15,37376
MA 136,164,128
MA 144,168,128
RT 164,15,45056
RT 166,15,45568
MA 148,168,132
MA 156,172,132
RT 168,16,36864
RT 170,16,37376
MA 152,172,128
WL 6
s_nop 0
MA 96,144,136
RT 172,16,45056
RT 174,16,45568
MA 100,144,140
s_waitcnt vmcnt(24)
s_barrier
MA 108,148,140
RT 144,13,49152
RT 146,13,49664
MA 104,148,136
s_add_u32 m0, s37, 65536
s_add_u32 s36, s38, 4129024
MA 112,152,136
RT 148,13,57344
RT 150,13,57856
MA 116,152,140
buffer_load_dwordx4 v1, s[12:15], s36 offen offset:0  lds
MA 124,156,140
RT 152,14,49152
RT 154,14,49664
MA 120,156,136
WL 6
s_nop 0
MA 128,160,136
RT 156,14,57344
RT 158,14,57856
MA 132,160,140
buffer_load_dwordx4 v2, s[12:15], s36 offen offset:1024  lds
MA 140,164,140
RT 160,15,49152
RT 162,15,49664
MA 136,164,136
MA 144,168,136
RT 164,15,57344
RT 166,15,57856
MA 148,168,140
buffer_load_dwordx4 v3, s[12:15], s36 offen offset:2048  lds
MA 156,172,140
RT 168,16,49152
RT 170,16,49664
MA 152,172,136
WL 6
s_nop 0
v_mfma_f32_16x16x32_bf16 v[32:35], a[144:147], a[0:3], 0
RT 172,16,57344
RT 174,16,57856
v_mfma_f32_16x16x32_bf16 v[36:39], a[144:147], a[4:7], 0
buffer_load_dwordx4 v4, s[12:15], s36 offen offset:3072  lds
v_mfma_f32_16x16x32_bf16 v[44:47], a[148:151], a[4:7], 0
RT 144,13,53248
RT 146,13,53760
v_mfma_f32_16x16x32_bf16 v[40:43], a[148:151], a[0:3], 0
s_add_u32 m0, s37, 81920
s_add_u32 s36, s38, 4718848
v_mfma_f32_16x16x32_bf16 v[48:51], a[152:155], a[0:3], 0
RT 148,13,61440
RT 150,13,61952
v_mfma_f32_16x16x32_bf16 v[52:55], a[152:155], a[4:7], 0
buffer_load_dwordx4 v1, s[12:15], s36 offen offset:0  lds
v_mfma_f32_16x16x32_bf16 v[60:63], a[156:159], a[4:7], 0
RT 152,14,53248
RT 154,14,53760
v_mfma_f32_16x16x32_bf16 v[56:59], a[156:159], a[0:3], 0
WL 6
v_max_f32 v96, 0, v96
v_mfma_f32_16x16x32_bf16 v[64:67], a[160:163], a[0:3], 0
RT 156,14,61440
RT 158,14,61952
v_mfma_f32_16x16x32_bf16 v[68:71], a[160:163], a[4:7], 0
buffer_load_dword v31, v29, s[12:15], s38 offen offset:512
v_mfma_f32_16x16x32_bf16 v[76:79], a[164:167], a[4:7], 0
RT 160,15,53248
RT 162,15,53760
v_mfma_f32_16x16x32_bf16 v[72:75], a[164:167], a[0:3], 0
v_max_f32 v97, 0, v97
v_mul_f32 v96, v96, v104
v_mfma_f32_16x16x32_bf16 v[80:83], a[168:171], a[0:3], 0
RT 164,15,61440
RT 166,15,61952
v_mfma_f32_16x16x32_bf16 v[84:87], a[168:171], a[4:7], 0
v_mul_f32_e64 v97, v97, v105
CV 176,96,97
v_mfma_f32_16x16x32_bf16 v[92:95], a[172:175], a[4:7], 0
RT 168,16,53248
RT 170,16,53760
v_mfma_f32_16x16x32_bf16 v[88:91], a[172:175], a[0:3], 0
WL 6
v_max_f32 v98, 0, v98
MA 32,144,8
RT 172,16,61440
RT 174,16,61952
MA 36,144,12
v_max_f32 v99, 0, v99
v_mul_f32 v98, v98, v106
MA 44,148,12
RT 144,17,0
RT 146,17,512
MA 40,148,8
v_mul_f32_e64 v99, v99, v107
MA 48,152,8
RT 148,17,8192
RT 150,17,8704
MA 52,152,12
CV 177,98,99
MA 60,156,12
RT 152,18,0
RT 154,18,512
MA 56,156,8
WL 6
v_max_f32 v100, 0, v100
MA 64,160,8
RT 156,18,8192
RT 158,18,8704
MA 68,160,12
v_max_f32_e64 v101, 0, v101
MA 76,164,12
RT 160,19,0
RT 162,19,512
MA 72,164,8
v_mul_f32 v100, v100, v108
v_mul_f32 v101, v101, v109
MA 80,168,8
RT 164,19,8192
RT 166,19,8704
MA 84,168,12
CV 180,100,101
MA 92,172,12
RT 168,20,0
RT 170,20,512
MA 88,172,8
WL 6
v_max_f32 v102, 0, v102
MA 32,144,16
RT 172,20,8192
RT 174,20,8704
MA 36,144,20
v_max_f32_e64 v103, 0, v103
MA 44,148,20
RT 144,17,4096
RT 146,17,4608
MA 40,148,16
v_mul_f32_e64 v102, v102, v110
MA 48,152,16
RT 148,17,12288
RT 150,17,12800
MA 52,152,20
v_mul_f32_e64 v103, v103, v111
CV 181,102,103
MA 60,156,20
RT 152,18,4096
RT 154,18,4608
MA 56,156,16
WL 6
v_max_f32 v112, 0, v112
MA 64,160,16
RT 156,18,12288
RT 158,18,12800
MA 68,160,20
v_max_f32_e64 v113, 0, v113
MA 76,164,20
RT 160,19,4096
RT 162,19,4608
MA 72,164,16
v_mul_f32_e64 v112, v112, v120
MA 80,168,16
RT 164,19,12288
RT 166,19,12800
MA 84,168,20
v_mul_f32_e64 v113, v113, v121
MA 92,172,20
RT 168,20,4096
RT 170,20,4608
MA 88,172,16
WL 6
s_nop 0
CV 178,112,113
MA 32,144,24
RT 172,20,12288
RT 174,20,12800
MA 36,144,28
s_waitcnt vmcnt(22)
s_barrier
MA 44,148,28
RT 144,17,16384
RT 146,17,16896
MA 40,148,24
v_max_f32 v114, 0, v114
v_max_f32 v115, 0, v115
MA 48,152,24
RT 148,17,24576
RT 150,17,25088
MA 52,152,28
v_mul_f32 v114, v114, v122
v_mul_f32 v115, v115, v123
MA 60,156,28
RT 152,18,16384
RT 154,18,16896
MA 56,156,24
WL 6
s_nop 0
CV 179,114,115
MA 64,160,24
RT 156,18,24576
RT 158,18,25088
MA 68,160,28
v_max_f32 v116, 0, v116
v_max_f32 v117, 0, v117
MA 76,164,28
RT 160,19,16384
RT 162,19,16896
MA 72,164,24
v_mul_f32_e64 v116, v116, v124
MA 80,168,24
RT 164,19,24576
RT 166,19,25088
MA 84,168,28
v_mul_f32_e64 v117, v117, v125
MA 92,172,28
RT 168,20,16384
RT 170,20,16896
MA 88,172,24
WL 6
s_nop 0
CV 182,116,117
MA 32,144,32
RT 172,20,24576
RT 174,20,25088
MA 36,144,36
v_max_f32_e64 v118, 0, v118
MA 44,148,36
RT 144,17,20480
RT 146,17,20992
MA 40,148,32
v_max_f32 v119, 0, v119
v_mul_f32 v118, v118, v126
MA 48,152,32
RT 148,17,28672
RT 150,17,29184
MA 52,152,36
v_mul_f32_e64 v119, v119, v127
MA 60,156,36
RT 152,18,20480
RT 154,18,20992
MA 56,156,32
WL 6
s_nop 0
CV 183,118,119
MA 64,160,32
RT 156,18,28672
RT 158,18,29184
MA 68,160,36
v_max_f32_e64 v128, 0, v128
MA 76,164,36
RT 160,19,20480
RT 162,19,20992
MA 72,164,32
v_max_f32_e64 v129, 0, v129
MA 80,168,32
RT 164,19,28672
RT 166,19,29184
MA 84,168,36
v_mul_f32_e64 v128, v128, v136
MA 92,172,36
RT 168,20,20480
RT 170,20,20992
MA 88,172,32
WL 6
v_mul_f32 v129, v129, v137
MA 32,144,40
RT 172,20,28672
RT 174,20,29184
MA 36,144,44
CV 184,128,129
v_max_f32_e64 v130, 0, v130
MA 44,148,44
RT 144,9,0
RT 146,9,512
MA 40,148,40
v_max_f32_e64 v131, 0, v131
MA 48,152,40
RT 148,9,8192
RT 150,9,8704
MA 52,152,44
v_mul_f32_e64 v130, v130, v138
MA 60,156,44
RT 152,10,0
RT 154,10,512
MA 56,156,40
WL 6
v_mul_f32 v131, v131, v139
MA 64,160,40
RT 156,10,8192
RT 158,10,8704
MA 68,160,44
buffer_load_dwordx4 v2, s[12:15], s36 offen offset:1024  lds
MA 76,164,44
RT 160,11,0
RT 162,11,512
MA 72,164,40
CV 185,130,131
v_max_f32_e64 v132, 0, v132
MA 80,168,40
RT 164,11,8192
RT 166,11,8704
MA 84,168,44
buffer_load_dwordx4 v3, s[12:15], s36 offen offset:2048  lds
MA 92,172,44
RT 168,12,0
RT 170,12,512
MA 88,172,40
WL 6
v_max_f32 v133, 0, v133
MA 32,144,48
RT 172,12,8192
RT 174,12,8704
MA 36,144,52
buffer_load_dwordx4 v4, s[12:15], s36 offen offset:3072  lds
MA 44,148,52
RT 144,9,4096
RT 146,9,4608
MA 40,148,48
s_add_u32 m0, s37, 98304
s_add_u32 s36, s38, 384
MA 48,152,48
RT 148,9,12288
RT 150,9,12800
MA 52,152,52
buffer_load_dwordx4 v1, s[12:15], s36 offen offset:0  lds
MA 60,156,52
RT 152,10,4096
RT 154,10,4608
MA 56,156,48
WL 6
v_mul_f32 v132, v132, v140
MA 64,160,48
RT 156,10,12288
RT 158,10,12800
MA 68,160,52
buffer_load_dwordx4 v2, s[12:15], s36 offen offset:1024  lds
MA 76,164,52
RT 160,11,4096
RT 162,11,4608
MA 72,164,48
v_mul_f32_e64 v133, v133, v141
CV 188,132,133
MA 80,168,48
RT 164,11,12288
RT 166,11,12800
MA 84,168,52
buffer_load_dwordx4 v3, s[12:15], s36 offen offset:2048  lds
MA 92,172,52
RT 168,12,4096
RT 170,12,4608
MA 88,172,48
WL 6
v_max_f32 v134, 0, v134
MA 32,144,56
RT 172,12,12288
RT 174,12,12800
MA 36,144,60
s_waitcnt vmcnt(16)
s_barrier
MA 44,148,60
RT 144,9,16384
RT 146,9,16896
MA 40,148,56
buffer_load_dwordx4 v4, s[12:15], s36 offen offset:3072  lds
MA 48,152,56
RT 148,9,24576
RT 150,9,25088
MA 52,152,60
s_add_u32 m0, s37, 114688
s_add_u32 s36, s38, 590208
MA 60,156,60
RT 152,10,16384
RT 154,10,16896
MA 56,156,56
WL 6
v_max_f32 v135, 0, v135
MA 64,160,56
RT 156,10,24576
RT 158,10,25088
MA 68,160,60
buffer_load_dwordx4 v1, s[12:15], s36 offen offset:0  lds
MA 76,164,60
RT 160,11,16384
RT 162,11,16896
MA 72,164,56
v_mul_f32 v134, v134, v142
v_mul_f32 v135, v135, v143
MA 80,168,56
RT 164,11,24576
RT 166,11,25088
MA 84,168,60
buffer_load_dwordx4 v2, s[12:15], s36 offen offset:1024  lds
MA 92,172,60
RT 168,12,16384
RT 170,12,16896
MA 88,172,56
WL 6
s_nop 0
CV 189,134,135
MA 32,144,64
RT 172,12,24576
RT 174,12,25088
MA 36,144,68
buffer_load_dwordx4 v3, s[12:15], s36 offen offset:2048  lds
MA 44,148,68
RT 144,9,20480
RT 146,9,20992
MA 40,148,64
v_max_f32 v144, 0, v144
v_max_f32 v145, 0, v145
MA 48,152,64
RT 148,9,28672
RT 150,9,29184
MA 52,152,68
buffer_load_dwordx4 v4, s[12:15], s36 offen offset:3072  lds
MA 60,156,68
RT 152,10,20480
RT 154,10,20992
MA 56,156,64
WL 6
s_nop 0
s_add_u32 m0, s37, 131072
s_add_u32 s36, s38, 1180032
MA 64,160,64
RT 156,10,28672
RT 158,10,29184
MA 68,160,68
buffer_load_dwordx4 v1, s[12:15], s36 offen offset:0  lds
MA 76,164,68
RT 160,11,20480
RT 162,11,20992
MA 72,164,64
v_mul_f32 v144, v144, v152
v_mul_f32 v145, v145, v153
MA 80,168,64
RT 164,11,28672
RT 166,11,29184
MA 84,168,68
buffer_load_dwordx4 v2, s[12:15], s36 offen offset:1024  lds
MA 92,172,68
RT 168,12,20480
RT 170,12,20992
MA 88,172,64
WL 6
s_nop 0
CV 186,144,145
MA 32,144,72
RT 172,12,28672
RT 174,12,29184
MA 36,144,76
buffer_load_dwordx4 v3, s[12:15], s36 offen offset:2048  lds
MA 44,148,76
RT 144,9,32768
RT 146,9,33280
MA 40,148,72
v_max_f32 v146, 0, v146
v_max_f32 v147, 0, v147
MA 48,152,72
RT 148,9,40960
RT 150,9,41472
MA 52,152,76
buffer_load_dwordx4 v4, s[12:15], s36 offen offset:3072  lds
MA 60,156,76
RT 152,10,32768
RT 154,10,33280
MA 56,156,72
WL 6
s_nop 0
s_add_u32 m0, s37, 147456
s_add_u32 s36, s38, 1769856
MA 64,160,72
RT 156,10,40960
RT 158,10,41472
MA 68,160,76
buffer_load_dwordx4 v1, s[12:15], s36 offen offset:0  lds
MA 76,164,76
RT 160,11,32768
RT 162,11,33280
MA 72,164,72
v_mul_f32 v146, v146, v154
v_mul_f32 v147, v147, v155
MA 80,168,72
RT 164,11,40960
RT 166,11,41472
MA 84,168,76
CV 187,146,147
v_max_f32_e64 v148, 0, v148
MA 92,172,76
RT 168,12,32768
RT 170,12,33280
MA 88,172,72
WL 6
v_max_f32 v149, 0, v149
MA 32,144,80
RT 172,12,40960
RT 174,12,41472
MA 36,144,84
buffer_load_dwordx4 v2, s[12:15], s36 offen offset:1024  lds
MA 44,148,84
RT 144,9,36864
RT 146,9,37376
MA 40,148,80
v_mul_f32 v148, v148, v156
v_mul_f32 v149, v149, v157
MA 48,152,80
RT 148,9,45056
RT 150,9,45568
MA 52,152,84
CV 190,148,149
v_max_f32_e64 v150, 0, v150
MA 60,156,84
RT 152,10,36864
RT 154,10,37376
MA 56,156,80
WL 6
v_max_f32 v151, 0, v151
MA 64,160,80
RT 156,10,45056
RT 158,10,45568
MA 68,160,84
buffer_load_dwordx4 v3, s[12:15], s36 offen offset:2048  lds
MA 76,164,84
RT 160,11,36864
RT 162,11,37376
MA 72,164,80
v_mul_f32 v150, v150, v158
v_mul_f32 v151, v151, v159
MA 80,168,80
RT 164,11,45056
RT 166,11,45568
MA 84,168,84
CV 191,150,151
s_add_u32 s41, s47, 4096
MA 92,172,84
RT 168,12,36864
RT 170,12,37376
MA 88,172,80
WL 6
s_nop 0
MA 32,144,88
RT 172,12,45056
RT 174,12,45568
MA 36,144,92
s_waitcnt vmcnt(20)
s_barrier
MA 44,148,92
RT 144,9,49152
RT 146,9,49664
MA 40,148,88
buffer_load_dwordx4 v4, s[12:15], s36 offen offset:3072  lds
MA 48,152,88
RT 148,9,57344
RT 150,9,57856
MA 52,152,92
s_add_u32 m0, s37, 0
s_nop 0
s_add_u32 s36, s38, 2359680
MA 60,156,92
RT 152,10,49152
RT 154,10,49664
MA 56,156,88
WL 6
s_nop 0
MA 64,160,88
RT 156,10,57344
RT 158,10,57856
MA 68,160,92
buffer_load_dwordx4 v1, s[12:15], s36 offen offset:0  lds
MA 76,164,92
RT 160,11,49152
RT 162,11,49664
MA 72,164,88
buffer_store_dwordx4 v[176:179], v21, s[20:23], s41 offen offset:0 sc1
MA 80,168,88
RT 164,11,57344
RT 166,11,57856
MA 84,168,92
buffer_load_dwordx4 v2, s[12:15], s36 offen offset:1024  lds
MA 92,172,92
RT 168,12,49152
RT 170,12,49664
MA 88,172,88
WL 6
s_nop 0
MA 32,144,96
RT 172,12,57344
RT 174,12,57856
MA 36,144,100
buffer_load_dwordx4 v3, s[12:15], s36 offen offset:2048  lds
MA 44,148,100
RT 144,9,53248
RT 146,9,53760
MA 40,148,96
buffer_store_dwordx4 v[180:183], v21, s[20:23], s41 offen offset:1024 sc1
MA 48,152,96
RT 148,9,61440
RT 150,9,61952
MA 52,152,100
buffer_load_dwordx4 v4, s[12:15], s36 offen offset:3072  lds
MA 60,156,100
RT 152,10,53248
RT 154,10,53760
MA 56,156,96
WL 6
s_nop 0
s_add_u32 m0, s37, 16384
s_add_u32 s36, s38, 2949504
MA 64,160,96
RT 156,10,61440
RT 158,10,61952
MA 68,160,100
buffer_load_dword v28, v23, s[24:27], 0 offen sc1
MA 76,164,100
RT 160,11,53248
RT 162,11,53760
MA 72,164,96
buffer_load_dwordx4 v1, s[12:15], s36 offen offset:0  lds
MA 80,168,96
RT 164,11,61440
RT 166,11,61952
MA 84,168,100
buffer_store_dwordx4 v[184:187], v21, s[20:23], s41 offen offset:2048 sc1
MA 92,172,100
RT 168,12,53248
RT 170,12,53760
MA 88,172,96
WL 6
s_nop 0
MA 32,144,104
RT 172,12,61440
RT 174,12,61952
MA 36,144,108
buffer_load_dwordx4 v2, s[12:15], s36 offen offset:1024  lds
MA 44,148,108
RT 144,13,0
RT 146,13,512
MA 40,148,104
buffer_store_dwordx4 v[188:191], v21, s[20:23], s41 offen offset:3072 sc1
MA 48,152,104
RT 148,13,8192
RT 150,13,8704
MA 52,152,108
MA 60,156,108
RT 152,14,0
RT 154,14,512
MA 56,156,104
WL 6
s_nop 0
MA 64,160,104
RT 156,14,8192
RT 158,14,8704
MA 68,160,108
s_getpc_b64 s[6:7]
s_nop 0
s_load_dword s5, s[6:7], s101
MA 76,164,108
RT 160,15,0
RT 162,15,512
MA 72,164,104
buffer_load_dwordx4 v3, s[12:15], s36 offen offset:2048  lds
MA 80,168,104
RT 164,15,8192
RT 166,15,8704
MA 84,168,108
MA 92,172,108
RT 168,16,0
RT 170,16,512
MA 88,172,104
WL 6
s_nop 0
MA 32,144,112
RT 172,16,8192
RT 174,16,8704
MA 36,144,116
buffer_load_dwordx4 v4, s[12:15], s36 offen offset:3072  lds
MA 44,148,116
RT 144,13,4096
RT 146,13,4608
MA 40,148,112
MA 48,152,112
RT 148,13,12288
RT 150,13,12800
MA 52,152,116
MA 60,156,116
RT 152,14,4096
RT 154,14,4608
MA 56,156,112
WL 6
s_nop 0
MA 64,160,112
RT 156,14,12288
RT 158,14,12800
MA 68,160,116
MA 76,164,116
RT 160,15,4096
RT 162,15,4608
MA 72,164,112
MA 80,168,112
RT 164,15,12288
RT 166,15,12800
MA 84,168,116
MA 92,172,116
RT 168,16,4096
RT 170,16,4608
MA 88,172,112
WL 6
s_nop 0
MA 32,144,120
RT 172,16,12288
RT 174,16,12800
MA 36,144,124
s_cmp_lg_u32 s32, 0
s_cbranch_scc1 L_polld_2
s_mov_b32 s89, 0x20000
s_waitcnt vmcnt(6)
s_branch L_pollc_3
L_poll_1:
buffer_load_dword v28, v23, s[24:27], 0 offen sc1
s_waitcnt vmcnt(0)
L_pollc_3:
v_readfirstlane_b32 s97, v28
s_sub_u32 s89, s89, 1
s_cmp_lg_u32 s97, 0
s_cbranch_scc1 L_polld_2
s_sleep 4
s_cmp_lg_u32 s89, 0
s_cbranch_scc1 L_poll_1
L_polld_2:
s_waitcnt vmcnt(25)
s_barrier
MA 44,148,124
RT 144,13,16384
RT 146,13,16896
MA 40,148,120
s_add_u32 m0, s37, 32768
s_add_u32 s36, s38, 3539328
MA 48,152,120
RT 148,13,24576
RT 150,13,25088
MA 52,152,124
buffer_load_dwordx4 v1, s[12:15], s36 offen offset:0  lds
MA 60,156,124
RT 152,14,16384
RT 154,14,16896
MA 56,156,120
WL 6
s_nop 0
MA 64,160,120
RT 156,14,24576
RT 158,14,25088
MA 68,160,124
buffer_load_dwordx4 v2, s[12:15], s36 offen offset:1024  lds
MA 76,164,124
RT 160,15,16384
RT 162,15,16896
MA 72,164,120
MA 80,168,120
RT 164,15,24576
RT 166,15,25088
MA 84,168,124
buffer_load_dwordx4 v3, s[12:15], s36 offen offset:2048  lds
MA 92,172,124
RT 168,16,16384
RT 170,16,16896
MA 88,172,120
WL 6
s_nop 0
MA 32,144,128
RT 172,16,24576
RT 174,16,25088
MA 36,144,132
buffer_load_dwordx4 v4, s[12:15], s36 offen offset:3072  lds
MA 44,148,132
RT 144,13,20480
RT 146,13,20992
MA 40,148,128
s_add_u32 m0, s37, 49152
s_add_u32 s36, s38, 4129152
MA 48,152,128
RT 148,13,28672
RT 150,13,29184
MA 52,152,132
buffer_load_dwordx4 v1, s[12:15], s36 offen offset:0  lds
MA 60,156,132
RT 152,14,20480
RT 154,14,20992
MA 56,156,128
WL 6
s_nop 0
MA 64,160,128
RT 156,14,28672
RT 158,14,29184
MA 68,160,132
MA 76,164,132
RT 160,15,20480
RT 162,15,20992
MA 72,164,128
buffer_load_dwordx4 v2, s[12:15], s36 offen offset:1024  lds
MA 80,168,128
RT 164,15,28672
RT 166,15,29184
MA 84,168,132
MA 92,172,132
RT 168,16,20480
RT 170,16,20992
MA 88,172,128
WL 6
s_nop 0
MA 32,144,136
RT 172,16,28672
RT 174,16,29184
MA 36,144,140
buffer_load_dwordx4 v3, s[12:15], s36 offen offset:2048  lds
MA 44,148,140
RT 144,13,32768
RT 146,13,33280
MA 40,148,136
MA 48,152,136
RT 148,13,40960
RT 150,13,41472
MA 52,152,140
MA 60,156,140
RT 152,14,32768
RT 154,14,33280
MA 56,156,136
WL 6
s_nop 0
MA 64,160,136
RT 156,14,40960
RT 158,14,41472
MA 68,160,140
buffer_load_dwordx4 v4, s[12:15], s36 offen offset:3072  lds
MA 76,164,140
RT 160,15,32768
RT 162,15,33280
MA 72,164,136
MA 80,168,136
RT 164,15,40960
RT 166,15,41472
MA 84,168,140
MA 92,172,140
RT 168,16,32768
RT 170,16,33280
MA 88,172,136
WL 6
s_nop 0
v_mfma_f32_16x16x32_bf16 v[96:99], a[144:147], a[0:3], 0
RT 172,16,40960
RT 174,16,41472
v_mfma_f32_16x16x32_bf16 v[100:103], a[144:147], a[4:7], 0
v_mfma_f32_16x16x32_bf16 v[108:111], a[148:151], a[4:7], 0
RT 144,13,36864
RT 146,13,37376
v_mfma_f32_16x16x32_bf16 v[104:107], a[148:151], a[0:3], 0
v_mfma_f32_16x16x32_bf16 v[112:115], a[152:155], a[0:3], 0
RT 148,13,45056
RT 150,13,45568
v_mfma_f32_16x16x32_bf16 v[116:119], a[152:155], a[4:7], 0
v_mfma_f32_16x16x32_bf16 v[124:127], a[156:159], a[4:7], 0
RT 152,14,36864
RT 154,14,37376
v_mfma_f32_16x16x32_bf16 v[120:123], a[156:159], a[0:3], 0
WL 6
v_max_f32 v32, 0, v32
v_mfma_f32_16x16x32_bf16 v[128:131], a[160:163], a[0:3], 0
RT 156,14,45056
RT 158,14,45568
v_mfma_f32_16x16x32_bf16 v[132:135], a[160:163], a[4:7], 0
buffer_load_dword v31, v29, s[12:15], s38 offen offset:640
v_mfma_f32_16x16x32_bf16 v[140:143], a[164:167], a[4:7], 0
RT 160,15,36864
RT 162,15,37376
v_mfma_f32_16x16x32_bf16 v[136:139], a[164:167], a[0:3], 0
v_max_f32 v33, 0, v33
v_mul_f32 v32, v32, v40
v_mfma_f32_16x16x32_bf16 v[144:147], a[168:171], a[0:3], 0
RT 164,15,45056
RT 166,15,45568
v_mfma_f32_16x16x32_bf16 v[148:151], a[168:171], a[4:7], 0
v_mul_f32_e64 v33, v33, v41
CV 192,32,33
v_mfma_f32_16x16x32_bf16 v[156:159], a[172:175], a[4:7], 0
RT 168,16,36864
RT 170,16,37376
v_mfma_f32_16x16x32_bf16 v[152:155], a[172:175], a[0:3], 0
WL 6
v_max_f32 v34, 0, v34
MA 96,144,8
RT 172,16,45056
RT 174,16,45568
MA 100,144,12
s_waitcnt vmcnt(26)
s_barrier
MA 108,148,12
RT 144,13,49152
RT 146,13,49664
MA 104,148,8
s_add_u32 m0, s37, 65536
s_add_u32 s36, s38, 4718976
MA 112,152,8
RT 148,13,57344
RT 150,13,57856
MA 116,152,12
v_max_f32 v35, 0, v35
v_mul_f32 v34, v34, v42
MA 124,156,12
RT 152,14,49152
RT 154,14,49664
MA 120,156,8
WL 6
v_mul_f32 v35, v35, v43
MA 128,160,8
RT 156,14,57344
RT 158,14,57856
MA 132,160,12
CV 193,34,35
v_max_f32_e64 v36, 0, v36
MA 140,164,12
RT 160,15,49152
RT 162,15,49664
MA 136,164,8
v_max_f32 v37, 0, v37
v_mul_f32 v36, v36, v44
MA 144,168,8
RT 164,15,57344
RT 166,15,57856
MA 148,168,12
v_mul_f32_e64 v37, v37, v45
CV 196,36,37
MA 156,172,12
RT 168,16,49152
RT 170,16,49664
MA 152,172,8
WL 6
v_max_f32 v38, 0, v38
MA 96,144,16
RT 172,16,57344
RT 174,16,57856
MA 100,144,20
v_max_f32_e64 v39, 0, v39
MA 108,148,20
RT 144,13,53248
RT 146,13,53760
MA 104,148,16
v_mul_f32_e64 v38, v38, v46
MA 112,152,16
RT 148,13,61440
RT 150,13,61952
MA 116,152,20
v_mul_f32_e64 v39, v39, v47
CV 197,38,39
MA 124,156,20
RT 152,14,53248
RT 154,14,53760
MA 120,156,16
WL 6
v_max_f32 v48, 0, v48
MA 128,160,16
RT 156,14,61440
RT 158,14,61952
MA 132,160,20
v_max_f32_e64 v49, 0, v49
MA 140,164,20
RT 160,15,53248
RT 162,15,53760
MA 136,164,16
v_mul_f32_e64 v48, v48, v56
MA 144,168,16
RT 164,15,61440
RT 166,15,61952
MA 148,168,20
v_mul_f32_e64 v49, v49, v57
MA 156,172,20
RT 168,16,53248
RT 170,16,53760
MA 152,172,16
WL 6
s_nop 0
CV 194,48,49
MA 96,144,24
RT 172,16,61440
RT 174,16,61952
MA 100,144,28
v_max_f32 v50, 0, v50
v_max_f32 v51, 0, v51
MA 108,148,28
RT 144,17,0
RT 146,17,512
MA 104,148,24
v_mul_f32_e64 v50, v50, v58
MA 112,152,24
RT 148,17,8192
RT 150,17,8704
MA 116,152,28
v_mul_f32_e64 v51, v51, v59
MA 124,156,28
RT 152,18,0
RT 154,18,512
MA 120,156,24
WL 6
s_nop 0
CV 195,50,51
MA 128,160,24
RT 156,18,8192
RT 158,18,8704
MA 132,160,28
v_max_f32 v52, 0, v52
v_max_f32 v53, 0, v53
MA 140,164,28
RT 160,19,0
RT 162,19,512
MA 136,164,24
v_mul_f32_e64 v52, v52, v60
MA 144,168,24
RT 164,19,8192
RT 166,19,8704
MA 148,168,28
v_mul_f32_e64 v53, v53, v61
MA 156,172,28
RT 168,20,0
RT 170,20,512
MA 152,172,24
WL 6
s_nop 0
CV 198,52,53
MA 96,144,32
RT 172,20,8192
RT 174,20,8704
MA 100,144,36
v_max_f32_e64 v54, 0, v54
MA 108,148,36
RT 144,17,4096
RT 146,17,4608
MA 104,148,32
v_max_f32 v55, 0, v55
v_mul_f32 v54, v54, v62
MA 112,152,32
RT 148,17,12288
RT 150,17,12800
MA 116,152,36
v_mul_f32_e64 v55, v55, v63
MA 124,156,36
RT 152,18,4096
RT 154,18,4608
MA 120,156,32
WL 6
s_nop 0
CV 199,54,55
MA 128,160,32
RT 156,18,12288
RT 158,18,12800
MA 132,160,36
v_max_f32_e64 v64, 0, v64
MA 140,164,36
RT 160,19,4096
RT 162,19,4608
MA 136,164,32
v_max_f32_e64 v65, 0, v65
MA 144,168,32
RT 164,19,12288
RT 166,19,12800
MA 148,168,36
v_mul_f32_e64 v64, v64, v72
MA 156,172,36
RT 168,20,4096
RT 170,20,4608
MA 152,172,32
WL 6
v_mul_f32 v65, v65, v73
MA 96,144,40
RT 172,20,12288
RT 174,20,12800
MA 100,144,44
s_waitcnt vmcnt(11)
s_waitcnt vmcnt(16)
s_barrier
v_mov_b32 v28, s97
buffer_store_dword v28, v24, s[20:23], s63 offen offset:0 sc1
MA 108,148,44
RT 144,17,16384
RT 146,17,16896
MA 104,148,40
CV 200,64,65
v_max_f32_e64 v66, 0, v66
MA 112,152,40
RT 148,17,24576
RT 150,17,25088
MA 116,152,44
v_max_f32 v67, 0, v67
v_mul_f32 v66, v66, v74
MA 124,156,44
RT 152,18,16384
RT 154,18,16896
MA 120,156,40
WL 6
v_mul_f32 v67, v67, v75
MA 128,160,40
RT 156,18,24576
RT 158,18,25088
MA 132,160,44
buffer_load_dwordx4 v1, s[12:15], s36 offen offset:0  lds
MA 140,164,44
RT 160,19,16384
RT 162,19,16896
MA 136,164,40
CV 201,66,67
v_max_f32_e64 v68, 0, v68
MA 144,168,40
RT 164,19,24576
RT 166,19,25088
MA 148,168,44
buffer_load_dwordx4 v2, s[12:15], s36 offen offset:1024  lds
MA 156,172,44
RT 168,20,16384
RT 170,20,16896
MA 152,172,40
WL 6
v_max_f32 v69, 0, v69
MA 96,144,48
RT 172,20,24576
RT 174,20,25088
MA 100,144,52
buffer_load_dwordx4 v3, s[12:15], s36 offen offset:2048  lds
MA 108,148,52
RT 144,17,20480
RT 146,17,20992
MA 104,148,48
v_mul_f32 v68, v68, v76
v_mul_f32 v69, v69, v77
MA 112,152,48
RT 148,17,28672
RT 150,17,29184
MA 116,152,52
buffer_load_dwordx4 v4, s[12:15], s36 offen offset:3072  lds
MA 124,156,52
RT 152,18,20480
RT 154,18,20992
MA 120,156,48
WL 6
s_nop 0
s_add_u32 m0, s37, 81920
s_add_u32 s36, s38, 512
MA 128,160,48
RT 156,18,28672
RT 158,18,29184
MA 132,160,52
buffer_load_dwordx4 v1, s[12:15], s36 offen offset:0  lds
MA 140,164,52
RT 160,19,20480
RT 162,19,20992
MA 136,164,48
CV 204,68,69
v_max_f32_e64 v70, 0, v70
MA 144,168,48
RT 164,19,28672
RT 166,19,29184
MA 148,168,52
buffer_load_dwordx4 v2, s[12:15], s36 offen offset:1024  lds
MA 156,172,52
RT 168,20,20480
RT 170,20,20992
MA 152,172,48
WL 6
v_max_f32 v71, 0, v71
MA 96,144,56
RT 172,20,28672
RT 174,20,29184
MA 100,144,60
buffer_load_dwordx4 v3, s[12:15], s36 offen offset:2048  lds
MA 108,148,60
RT 144,9,0
RT 146,9,512
MA 104,148,56
v_mul_f32 v70, v70, v78
v_mul_f32 v71, v71, v79
MA 112,152,56
RT 148,9,8192
RT 150,9,8704
MA 116,152,60
buffer_load_dwordx4 v4, s[12:15], s36 offen offset:3072  lds
MA 124,156,60
RT 152,10,0
RT 154,10,512
MA 120,156,56
WL 6
s_nop 0
s_add_u32 m0, s37, 98304
s_add_u32 s36, s38, 590336
MA 128,160,56
RT 156,10,8192
RT 158,10,8704
MA 132,160,60
buffer_load_dwordx4 v1, s[12:15], s36 offen offset:0  lds
MA 140,164,60
RT 160,11,0
RT 162,11,512
MA 136,164,56
CV 205,70,71
v_max_f32_e64 v80, 0, v80
MA 144,168,56
RT 164,11,8192
RT 166,11,8704
MA 148,168,60
buffer_load_dwordx4 v2, s[12:15], s36 offen offset:1024  lds
MA 156,172,60
RT 168,12,0
RT 170,12,512
MA 152,172,56
WL 6
v_max_f32 v81, 0, v81
MA 96,144,64
RT 172,12,8192
RT 174,12,8704
MA 100,144,68
buffer_load_dwordx4 v3, s[12:15], s36 offen offset:2048  lds
MA 108,148,68
RT 144,9,4096
RT 146,9,4608
MA 104,148,64
v_mul_f32 v80, v80, v88
v_mul_f32 v81, v81, v89
MA 112,152,64
RT 148,9,12288
RT 150,9,12800
MA 116,152,68
buffer_load_dwordx4 v4, s[12:15], s36 offen offset:3072  lds
MA 124,156,68
RT 152,10,4096
RT 154,10,4608
MA 120,156,64
WL 6
s_nop 0
s_add_u32 m0, s37, 114688
s_add_u32 s36, s38, 1180160
MA 128,160,64
RT 156,10,12288
RT 158,10,12800
MA 132,160,68
buffer_load_dwordx4 v1, s[12:15], s36 offen offset:0  lds
MA 140,164,68
RT 160,11,4096
RT 162,11,4608
MA 136,164,64
CV 202,80,81
v_max_f32_e64 v82, 0, v82
MA 144,168,64
RT 164,11,12288
RT 166,11,12800
MA 148,168,68
v_max_f32 v83, 0, v83
v_mul_f32 v82, v82, v90
MA 156,172,68
RT 168,12,4096
RT 170,12,4608
MA 152,172,64
WL 6
v_mul_f32 v83, v83, v91
MA 96,144,72
RT 172,12,12288
RT 174,12,12800
MA 100,144,76
s_waitcnt vmcnt(19)
s_barrier
MA 108,148,76
RT 144,9,16384
RT 146,9,16896
MA 104,148,72
buffer_load_dwordx4 v2, s[12:15], s36 offen offset:1024  lds
MA 112,152,72
RT 148,9,24576
RT 150,9,25088
MA 116,152,76
CV 203,82,83
v_max_f32_e64 v84, 0, v84
MA 124,156,76
RT 152,10,16384
RT 154,10,16896
MA 120,156,72
WL 6
v_max_f32 v85, 0, v85
MA 128,160,72
RT 156,10,24576
RT 158,10,25088
MA 132,160,76
buffer_load_dwordx4 v3, s[12:15], s36 offen offset:2048  lds
MA 140,164,76
RT 160,11,16384
RT 162,11,16896
MA 136,164,72
v_mul_f32 v84, v84, v92
v_mul_f32 v85, v85, v93
MA 144,168,72
RT 164,11,24576
RT 166,11,25088
MA 148,168,76
buffer_load_dword v31, v26, s[16:19], s44 offen
MA 156,172,76
RT 168,12,16384
RT 170,12,16896
MA 152,172,72
WL 6
s_nop 0
CV 206,84,85
MA 96,144,80
RT 172,12,24576
RT 174,12,25088
MA 100,144,84
v_max_f32 v86, 0, v86
v_max_f32 v87, 0, v87
MA 108,148,84
RT 144,9,20480
RT 146,9,20992
MA 104,148,80
v_mul_f32 v86, v86, v94
v_mul_f32 v87, v87, v95
MA 112,152,80
RT 148,9,28672
RT 150,9,29184
MA 116,152,84
CV 207,86,87
s_add_u32 s41, s47, 8192
MA 124,156,84
RT 152,10,20480
RT 154,10,20992
MA 120,156,80
WL 6
s_nop 0
MA 128,160,80
RT 156,10,28672
RT 158,10,29184
MA 132,160,84
buffer_store_dwordx4 v[192:195], v21, s[20:23], s41 offen offset:0 sc1
MA 140,164,84
RT 160,11,20480
RT 162,11,20992
MA 136,164,80
buffer_store_dwordx4 v[196:199], v21, s[20:23], s41 offen offset:1024 sc1
MA 144,168,80
RT 164,11,28672
RT 166,11,29184
MA 148,168,84
buffer_load_dword v28, v23, s[20:23], s52 offen sc1
MA 156,172,84
RT 168,12,20480
RT 170,12,20992
MA 152,172,80
WL 6
s_nop 0
MA 96,144,88
RT 172,12,28672
RT 174,12,29184
MA 100,144,92
s_getpc_b64 s[6:7]
s_nop 0
s_load_dword s5, s[6:7], s101
MA 108,148,92
RT 144,9,32768
RT 146,9,33280
MA 104,148,88
buffer_store_dwordx4 v[200:203], v21, s[20:23], s41 offen offset:2048 sc1
MA 112,152,88
RT 148,9,40960
RT 150,9,41472
MA 116,152,92
buffer_store_dwordx4 v[204:207], v21, s[20:23], s41 offen offset:3072 sc1
MA 124,156,92
RT 152,10,32768
RT 154,10,33280
MA 120,156,88
WL 6
s_nop 0
MA 128,160,88
RT 156,10,40960
RT 158,10,41472
MA 132,160,92
MA 140,164,92
RT 160,11,32768
RT 162,11,33280
MA 136,164,88
MA 144,168,88
RT 164,11,40960
RT 166,11,41472
MA 148,168,92
MA 156,172,92
RT 168,12,32768
RT 170,12,33280
MA 152,172,88
WL 6
s_nop 0
MA 96,144,96
RT 172,12,40960
RT 174,12,41472
MA 100,144,100
MA 108,148,100
RT 144,9,36864
RT 146,9,37376
MA 104,148,96
MA 112,152,96
RT 148,9,45056
RT 150,9,45568
MA 116,152,100
MA 124,156,100
RT 152,10,36864
RT 154,10,37376
MA 120,156,96
WL 6
s_nop 0
MA 128,160,96
RT 156,10,45056
RT 158,10,45568
MA 132,160,100
MA 140,164,100
RT 160,11,36864
RT 162,11,37376
MA 136,164,96
MA 144,168,96
RT 164,11,45056
RT 166,11,45568
MA 148,168,100
MA 156,172,100
RT 168,12,36864
RT 170,12,37376
MA 152,172,96
WL 6
s_nop 0
MA 96,144,104
RT 172,12,45056
RT 174,12,45568
MA 100,144,108
s_waitcnt vmcnt(17)
s_barrier
MA 108,148,108
RT 144,9,49152
RT 146,9,49664
MA 104,148,104
MA 112,152,104
RT 148,9,57344
RT 150,9,57856
MA 116,152,108
MA 124,156,108
RT 152,10,49152
RT 154,10,49664
MA 120,156,104
WL 6
s_nop 0
MA 128,160,104
RT 156,10,57344
RT 158,10,57856
MA 132,160,108
MA 140,164,108
RT 160,11,49152
RT 162,11,49664
MA 136,164,104
MA 144,168,104
RT 164,11,57344
RT 166,11,57856
MA 148,168,108
MA 156,172,108
RT 168,12,49152
RT 170,12,49664
MA 152,172,104
WL 6
s_nop 0
MA 96,144,112
RT 172,12,57344
RT 174,12,57856
MA 100,144,116
MA 108,148,116
RT 144,9,53248
RT 146,9,53760
MA 104,148,112
MA 112,152,112
RT 148,9,61440
RT 150,9,61952
MA 116,152,116
MA 124,156,116
RT 152,10,53248
RT 154,10,53760
MA 120,156,112
WL 6
s_nop 0
MA 128,160,112
RT 156,10,61440
RT 158,10,61952
MA 132,160,116
MA 140,164,116
RT 160,11,53248
RT 162,11,53760
MA 136,164,112
MA 144,168,112
RT 164,11,61440
RT 166,11,61952
MA 148,168,116
buffer_load_dwordx4 v4, s[12:15], s36 offen offset:3072  lds
MA 156,172,116
RT 168,12,53248
RT 170,12,53760
MA 152,172,112
WL 6
s_nop 0
s_add_u32 m0, s37, 131072
s_add_u32 s36, s38, 1769984
MA 96,144,120
RT 172,12,61440
RT 174,12,61952
MA 100,144,124
buffer_load_dwordx4 v1, s[12:15], s36 offen offset:0  lds
MA 108,148,124
RT 144,13,0
RT 146,13,512
MA 104,148,120
MA 112,152,120
RT 148,13,8192
RT 150,13,8704
MA 116,152,124
buffer_load_dwordx4 v2, s[12:15], s36 offen offset:1024  lds
MA 124,156,124
RT 152,14,0
RT 154,14,512
MA 120,156,120
WL 6
s_nop 0
MA 128,160,120
RT 156,14,8192
RT 158,14,8704
MA 132,160,124
buffer_load_dwordx4 v3, s[12:15], s36 offen offset:2048  lds
MA 140,164,124
RT 160,15,0
RT 162,15,512
MA 136,164,120
MA 144,168,120
RT 164,15,8192
RT 166,15,8704
MA 148,168,124
buffer_load_dwordx4 v4, s[12:15], s36 offen offset:3072  lds
MA 156,172,124
RT 168,16,0
RT 170,16,512
MA 152,172,120
WL 6
s_nop 0
s_add_u32 m0, s37, 147456
s_add_u32 s36, s38, 2359808
MA 96,144,128
RT 172,16,8192
RT 174,16,8704
MA 100,144,132
buffer_load_dwordx4 v1, s[12:15], s36 offen offset:0  lds
MA 108,148,132
RT 144,13,4096
RT 146,13,4608
MA 104,148,128
MA 112,152,128
RT 148,13,12288
RT 150,13,12800
MA 116,152,132
buffer_load_dwordx4 v2, s[12:15], s36 offen offset:1024  lds
MA 124,156,132
RT 152,14,4096
RT 154,14,4608
MA 120,156,128
WL 6
s_nop 0
MA 128,160,128
RT 156,14,12288
RT 158,14,12800
MA 132,160,132
buffer_load_dwordx4 v3, s[12:15], s36 offen offset:2048  lds
MA 140,164,132
RT 160,15,4096
RT 162,15,4608
MA 136,164,128
MA 144,168,128
RT 164,15,12288
RT 166,15,12800
MA 148,168,132
buffer_load_dwordx4 v4, s[12:15], s36 offen offset:3072  lds
MA 156,172,132
RT 168,16,4096
RT 170,16,4608
MA 152,172,128
WL 6
s_add_u32 m0, s37, 0
s_add_u32 s36, s38, 2949632
MA 96,144,136
RT 172,16,12288
RT 174,16,12800
MA 100,144,140
s_cmp_lg_u32 s32, 0
s_cbranch_scc1 L_polld_5
s_mov_b32 s89, 0x20000
s_waitcnt vmcnt(11)
s_branch L_pollc_6
L_poll_4:
buffer_load_dword v28, v23, s[20:23], s52 offen sc1
s_waitcnt vmcnt(0)
L_pollc_6:
v_cmp_eq_u32 s[98:99], s97, v28
s_sub_u32 s89, s89, 1
s_and_b32 s98, s98, 0x7
s_cmp_eq_u32 s98, 0x7
s_cbranch_scc1 L_polld_5
s_sleep 4
s_cmp_lg_u32 s89, 0
s_cbranch_scc1 L_poll_4
L_polld_5:
s_waitcnt vmcnt(18)
s_barrier
MA 108,148,140
RT 144,13,16384
RT 146,13,16896
MA 104,148,136
s_add_u32 s35, s48, 0
s_nop 0
MA 112,152,136
RT 148,13,24576
RT 150,13,25088
MA 116,152,140
buffer_load_dwordx4 v1, s[12:15], s36 offen offset:0  lds
MA 124,156,140
RT 152,14,16384
RT 154,14,16896
MA 120,156,136
WL 6
s_nop 0
MA 128,160,136
RT 156,14,24576
RT 158,14,25088
MA 132,160,140
buffer_load_dwordx4 v2, s[12:15], s36 offen offset:1024  lds
MA 140,164,140
RT 160,15,16384
RT 162,15,16896
MA 136,164,136
MA 144,168,136
RT 164,15,24576
RT 166,15,25088
MA 148,168,140
buffer_load_dwordx4 v3, s[12:15], s36 offen offset:2048  lds
MA 156,172,140
RT 168,16,16384
RT 170,16,16896
MA 152,172,136
WL 6
s_nop 0
v_mfma_f32_16x16x32_bf16 v[32:35], a[144:147], a[0:3], 0
RT 172,16,24576
RT 174,16,25088
v_mfma_f32_16x16x32_bf16 v[36:39], a[144:147], a[4:7], 0
buffer_load_dwordx4 v4, s[12:15], s36 offen offset:3072  lds
v_mfma_f32_16x16x32_bf16 v[44:47], a[148:151], a[4:7], 0
RT 144,13,20480
RT 146,13,20992
v_mfma_f32_16x16x32_bf16 v[40:43], a[148:151], a[0:3], 0
s_add_u32 m0, s37, 16384
s_add_u32 s36, s38, 3539456
v_mfma_f32_16x16x32_bf16 v[48:51], a[152:155], a[0:3], 0
RT 148,13,28672
RT 150,13,29184
v_mfma_f32_16x16x32_bf16 v[52:55], a[152:155], a[4:7], 0
buffer_load_dwordx4 v1, s[12:15], s36 offen offset:0  lds
v_mfma_f32_16x16x32_bf16 v[60:63], a[156:159], a[4:7], 0
RT 152,14,20480
RT 154,14,20992
v_mfma_f32_16x16x32_bf16 v[56:59], a[156:159], a[0:3], 0
WL 6
v_max_f32 v96, 0, v96
v_mfma_f32_16x16x32_bf16 v[64:67], a[160:163], a[0:3], 0
RT 156,14,28672
RT 158,14,29184
v_mfma_f32_16x16x32_bf16 v[68:71], a[160:163], a[4:7], 0
buffer_load_dwordx4 a[176:179], v21, s[20:23], s35 offen offset:0 sc1
v_mfma_f32_16x16x32_bf16 v[76:79], a[164:167], a[4:7], 0
RT 160,15,20480
RT 162,15,20992
v_mfma_f32_16x16x32_bf16 v[72:75], a[164:167], a[0:3], 0
buffer_load_dwordx4 v2, s[12:15], s36 offen offset:1024  lds
v_mfma_f32_16x16x32_bf16 v[80:83], a[168:171], a[0:3], 0
RT 164,15,28672
RT 166,15,29184
v_mfma_f32_16x16x32_bf16 v[84:87], a[168:171], a[4:7], 0
v_max_f32 v97, 0, v97
v_mul_f32 v96, v96, v104
v_mfma_f32_16x16x32_bf16 v[92:95], a[172:175], a[4:7], 0
RT 168,16,20480
RT 170,16,20992
v_mfma_f32_16x16x32_bf16 v[88:91], a[172:175], a[0:3], 0
WL 6
v_mul_f32 v97, v97, v105
MA 32,144,8
RT 172,16,28672
RT 174,16,29184
MA 36,144,12
buffer_load_dwordx4 v3, s[12:15], s36 offen offset:2048  lds
MA 44,148,12
RT 144,13,32768
RT 146,13,33280
MA 40,148,8
CV 208,96,97
v_max_f32_e64 v98, 0, v98
MA 48,152,8
RT 148,13,40960
RT 150,13,41472
MA 52,152,12
buffer_load_dwordx4 v4, s[12:15], s36 offen offset:3072  lds
MA 60,156,12
RT 152,14,32768
RT 154,14,33280
MA 56,156,8
WL 6
s_nop 0
s_add_u32 m0, s37, 32768
s_add_u32 s36, s38, 4129280
MA 64,160,8
RT 156,14,40960
RT 158,14,41472
MA 68,160,12
buffer_load_dwordx4 v1, s[12:15], s36 offen offset:0  lds
MA 76,164,12
RT 160,15,32768
RT 162,15,33280
MA 72,164,8
buffer_load_dwordx4 a[180:183], v21, s[20:23], s35 offen offset:1024 sc1
MA 80,168,8
RT 164,15,40960
RT 166,15,41472
MA 84,168,12
buffer_load_dwordx4 v2, s[12:15], s36 offen offset:1024  lds
MA 92,172,12
RT 168,16,32768
RT 170,16,33280
MA 88,172,8
WL 6
v_max_f32 v99, 0, v99
MA 32,144,16
RT 172,16,40960
RT 174,16,41472
MA 36,144,20
buffer_load_dwordx4 v3, s[12:15], s36 offen offset:2048  lds
MA 44,148,20
RT 144,13,36864
RT 146,13,37376
MA 40,148,16
v_mul_f32 v98, v98, v106
v_mul_f32 v99, v99, v107
MA 48,152,16
RT 148,13,45056
RT 150,13,45568
MA 52,152,20
buffer_load_dwordx4 v4, s[12:15], s36 offen offset:3072  lds
MA 60,156,20
RT 152,14,36864
RT 154,14,37376
MA 56,156,16
WL 6
s_nop 0
s_add_u32 m0, s37, 49152
s_add_u32 s36, s38, 4719104
MA 64,160,16
RT 156,14,45056
RT 158,14,45568
MA 68,160,20
buffer_load_dwordx4 v1, s[12:15], s36 offen offset:0  lds
MA 76,164,20
RT 160,15,36864
RT 162,15,37376
MA 72,164,16
CV 209,98,99
v_max_f32_e64 v100, 0, v100
MA 80,168,16
RT 164,15,45056
RT 166,15,45568
MA 84,168,20
v_max_f32 v101, 0, v101
v_mul_f32 v100, v100, v108
MA 92,172,20
RT 168,16,36864
RT 170,16,37376
MA 88,172,16
WL 6
v_mul_f32 v101, v101, v109
MA 32,144,24
RT 172,16,45056
RT 174,16,45568
MA 36,144,28
s_waitcnt vmcnt(19)
s_barrier
MA 44,148,28
RT 144,13,49152
RT 146,13,49664
MA 40,148,24
buffer_load_dwordx4 a[184:187], v21, s[20:23], s35 offen offset:2048 sc1
MA 48,152,24
RT 148,13,57344
RT 150,13,57856
MA 52,152,28
buffer_load_dwordx4 v2, s[12:15], s36 offen offset:1024  lds
MA 60,156,28
RT 152,14,49152
RT 154,14,49664
MA 56,156,24
WL 6
s_nop 0
CV 212,100,101
MA 64,160,24
RT 156,14,57344
RT 158,14,57856
MA 68,160,28
buffer_load_dwordx4 v3, s[12:15], s36 offen offset:2048  lds
MA 76,164,28
RT 160,15,49152
RT 162,15,49664
MA 72,164,24
v_max_f32 v102, 0, v102
v_max_f32 v103, 0, v103
MA 80,168,24
RT 164,15,57344
RT 166,15,57856
MA 84,168,28
buffer_load_dwordx4 v4, s[12:15], s36 offen offset:3072  lds
MA 92,172,28
RT 168,16,49152
RT 170,16,49664
MA 88,172,24
WL 6
s_nop 0
s_add_u32 m0, s37, 65536
s_add_u32 s36, s38, 640
MA 32,144,32
RT 172,16,57344
RT 174,16,57856
MA 36,144,36
buffer_load_dwordx4 v1, s[12:15], s36 offen offset:0  lds
MA 44,148,36
RT 144,13,53248
RT 146,13,53760
MA 40,148,32
buffer_load_dwordx4 a[188:191], v21, s[20:23], s35 offen offset:3072 sc1
MA 48,152,32
RT 148,13,61440
RT 150,13,61952
MA 52,152,36
buffer_load_dwordx4 v2, s[12:15], s36 offen offset:1024  lds
MA 60,156,36
RT 152,14,53248
RT 154,14,53760
MA 56,156,32
WL 6
v_mul_f32 v102, v102, v110
MA 64,160,32
RT 156,14,61440
RT 158,14,61952
MA 68,160,36
buffer_load_dwordx4 v3, s[12:15], s36 offen offset:2048  lds
MA 76,164,36
RT 160,15,53248
RT 162,15,53760
MA 72,164,32
v_mul_f32_e64 v103, v103, v111
CV 213,102,103
MA 80,168,32
RT 164,15,61440
RT 166,15,61952
MA 84,168,36
buffer_load_dwordx4 v4, s[12:15], s36 offen offset:3072  lds
MA 92,172,36
RT 168,16,53248
RT 170,16,53760
MA 88,172,32
WL 6
s_nop 0
s_add_u32 m0, s37, 81920
s_add_u32 s36, s38, 590464
MA 32,144,40
RT 172,16,61440
RT 174,16,61952
MA 36,144,44
buffer_load_dwordx4 v1, s[12:15], s36 offen offset:0  lds
MA 44,148,44
RT 144,17,0
RT 146,17,512
MA 40,148,40
v_max_f32 v112, 0, v112
v_max_f32 v113, 0, v113
MA 48,152,40
RT 148,17,8192
RT 150,17,8704
MA 52,152,44
v_mul_f32 v112, v112, v120
v_mul_f32 v113, v113, v121
MA 60,156,44
RT 152,18,0
RT 154,18,512
MA 56,156,40
WL 6
s_nop 0
CV 210,112,113
MA 64,160,40
RT 156,18,8192
RT 158,18,8704
MA 68,160,44
s_add_u32 s35, s48, 4096
MA 76,164,44
RT 160,19,0
RT 162,19,512
MA 72,164,40
buffer_load_dwordx4 v2, s[12:15], s36 offen offset:1024  lds
MA 80,168,40
RT 164,19,8192
RT 166,19,8704
MA 84,168,44
v_max_f32 v114, 0, v114
v_max_f32 v115, 0, v115
MA 92,172,44
RT 168,20,0
RT 170,20,512
MA 88,172,40
WL 6
v_mul_f32 v114, v114, v122
MA 32,144,48
RT 172,20,8192
RT 174,20,8704
MA 36,144,52
buffer_load_dwordx4 v3, s[12:15], s36 offen offset:2048  lds
MA 44,148,52
RT 144,17,4096
RT 146,17,4608
MA 40,148,48
v_mul_f32_e64 v115, v115, v123
CV 211,114,115
MA 48,152,48
RT 148,17,12288
RT 150,17,12800
MA 52,152,52
v_max_f32 v116, 0, v116
v_max_f32 v117, 0, v117
MA 60,156,52
RT 152,18,4096
RT 154,18,4608
MA 56,156,48
WL 6
v_mul_f32 v116, v116, v124
MA 64,160,48
RT 156,18,12288
RT 158,18,12800
MA 68,160,52
buffer_load_dwordx4 v4, s[12:15], s36 offen offset:3072  lds
MA 76,164,52
RT 160,19,4096
RT 162,19,4608
MA 72,164,48
buffer_load_dwordx4 a[192:195], v21, s[20:23], s35 offen offset:0 sc1
MA 80,168,48
RT 164,19,12288
RT 166,19,12800
MA 84,168,52
v_mul_f32_e64 v117, v117, v125
CV 214,116,117
MA 92,172,52
RT 168,20,4096
RT 170,20,4608
MA 88,172,48
WL 6
v_max_f32 v118, 0, v118
MA 32,144,56
RT 172,20,12288
RT 174,20,12800
MA 36,144,60
s_waitcnt vmcnt(25)
s_barrier
MA 44,148,60
RT 144,17,16384
RT 146,17,16896
MA 40,148,56
s_add_u32 m0, s37, 98304
s_add_u32 s36, s38, 1180288
MA 48,152,56
RT 148,17,24576
RT 150,17,25088
MA 52,152,60
buffer_load_dwordx4 v1, s[12:15], s36 offen offset:0  lds
MA 60,156,60
RT 152,18,16384
RT 154,18,16896
MA 56,156,56
WL 6
v_max_f32 v119, 0, v119
MA 64,160,56
RT 156,18,24576
RT 158,18,25088
MA 68,160,60
buffer_load_dwordx4 v2, s[12:15], s36 offen offset:1024  lds
MA 76,164,60
RT 160,19,16384
RT 162,19,16896
MA 72,164,56
v_mul_f32 v118, v118, v126
v_mul_f32 v119, v119, v127
MA 80,168,56
RT 164,19,24576
RT 166,19,25088
MA 84,168,60
buffer_load_dwordx4 v3, s[12:15], s36 offen offset:2048  lds
MA 92,172,60
RT 168,20,16384
RT 170,20,16896
MA 88,172,56
WL 6
s_nop 0
CV 215,118,119
MA 32,144,64
RT 172,20,24576
RT 174,20,25088
MA 36,144,68
buffer_load_dwordx4 a[196:199], v21, s[20:23], s35 offen offset:1024 sc1
MA 44,148,68
RT 144,17,20480
RT 146,17,20992
MA 40,148,64
buffer_load_dwordx4 v4, s[12:15], s36 offen offset:3072  lds
MA 48,152,64
RT 148,17,28672
RT 150,17,29184
MA 52,152,68
s_add_u32 m0, s37, 114688
s_add_u32 s36, s38, 1770112
MA 60,156,68
RT 152,18,20480
RT 154,18,20992
MA 56,156,64
WL 6
v_max_f32 v128, 0, v128
v_max_f32_e64 v129, 0, v129
MA 64,160,64
RT 156,18,28672
RT 158,18,29184
MA 68,160,68
buffer_load_dwordx4 v1, s[12:15], s36 offen offset:0  lds
MA 76,164,68
RT 160,19,20480
RT 162,19,20992
MA 72,164,64
s_getpc_b64 s[6:7]
s_nop 0
s_load_dword s5, s[6:7], s101
MA 80,168,64
RT 164,19,28672
RT 166,19,29184
MA 84,168,68
v_mul_f32 v128, v128, v136
v_mul_f32 v129, v129, v137
CV 216,128,129
MA 92,172,68
RT 168,20,20480
RT 170,20,20992
MA 88,172,64
WL 6
v_max_f32 v130, 0, v130
v_max_f32_e64 v131, 0, v131
MA 32,144,72
RT 172,20,28672
RT 174,20,29184
MA 36,144,76
buffer_load_dwordx4 v2, s[12:15], s36 offen offset:1024  lds
MA 44,148,76
RT 144,9,0
RT 146,9,512
MA 40,148,72
buffer_load_dwordx4 a[200:203], v21, s[20:23], s35 offen offset:2048 sc1
MA 48,152,72
RT 148,9,8192
RT 150,9,8704
MA 52,152,76
v_mul_f32 v130, v130, v138
v_mul_f32 v131, v131, v139
CV 217,130,131
MA 60,156,76
RT 152,10,0
RT 154,10,512
MA 56,156,72
WL 6
v_max_f32 v132, 0, v132
v_max_f32_e64 v133, 0, v133
MA 64,160,72
RT 156,10,8192
RT 158,10,8704
MA 68,160,76
buffer_load_dwordx4 v3, s[12:15], s36 offen offset:2048  lds
MA 76,164,76
RT 160,11,0
RT 162,11,512
MA 72,164,72
v_mul_f32 v132, v132, v140
v_mul_f32 v133, v133, v141
CV 220,132,133
MA 80,168,72
RT 164,11,8192
RT 166,11,8704
MA 84,168,76
v_max_f32 v134, 0, v134
v_max_f32 v135, 0, v135
MA 92,172,76
RT 168,12,0
RT 170,12,512
MA 88,172,72
WL 6
v_mul_f32 v134, v134, v142
MA 32,144,80
RT 172,12,8192
RT 174,12,8704
MA 36,144,84
buffer_load_dwordx4 v4, s[12:15], s36 offen offset:3072  lds
MA 44,148,84
RT 144,9,4096
RT 146,9,4608
MA 40,148,80
v_mul_f32_e64 v135, v135, v143
CV 221,134,135
MA 48,152,80
RT 148,9,12288
RT 150,9,12800
MA 52,152,84
v_max_f32 v144, 0, v144
v_max_f32 v145, 0, v145
MA 60,156,84
RT 152,10,4096
RT 154,10,4608
MA 56,156,80
WL 6
v_mul_f32 v144, v144, v152
MA 64,160,80
RT 156,10,12288
RT 158,10,12800
MA 68,160,84
buffer_load_dwordx4 a[204:207], v21, s[20:23], s35 offen offset:3072 sc1
MA 76,164,84
RT 160,11,4096
RT 162,11,4608
MA 72,164,80
v_mul_f32_e64 v145, v145, v153
CV 218,144,145
MA 80,168,80
RT 164,11,12288
RT 166,11,12800
MA 84,168,84
v_max_f32 v146, 0, v146
v_max_f32 v147, 0, v147
MA 92,172,84
RT 168,12,4096
RT 170,12,4608
MA 88,172,80
WL 6
v_mul_f32 v146, v146, v154
MA 32,144,88
RT 172,12,12288
RT 174,12,12800
MA 36,144,92
s_waitcnt vmcnt(26)
s_barrier
MA 44,148,92
RT 144,9,16384
RT 146,9,16896
MA 40,148,88
s_add_u32 m0, s37, 131072
s_add_u32 s36, s38, 2359936
MA 48,152,88
RT 148,9,24576
RT 150,9,25088
MA 52,152,92
buffer_load_dwordx4 v1, s[12:15], s36 offen offset:0  lds
MA 60,156,92
RT 152,10,16384
RT 154,10,16896
MA 56,156,88
WL 6
v_mul_f32 v147, v147, v155
CV 219,146,147
MA 64,160,88
RT 156,10,24576
RT 158,10,25088
MA 68,160,92
buffer_load_dwordx4 v2, s[12:15], s36 offen offset:1024  lds
MA 76,164,92
RT 160,11,16384
RT 162,11,16896
MA 72,164,88
v_max_f32 v148, 0, v148
v_max_f32 v149, 0, v149
v_mul_f32_e64 v148, v148, v156
MA 80,168,88
RT 164,11,24576
RT 166,11,25088
MA 84,168,92
buffer_load_dwordx4 v3, s[12:15], s36 offen offset:2048  lds
MA 92,172,92
RT 168,12,16384
RT 170,12,16896
MA 88,172,88
WL 6
v_mul_f32 v149, v149, v157
CV 222,148,149
MA 32,144,96
RT 172,12,24576
RT 174,12,25088
MA 36,144,100
buffer_load_dwordx4 v4, s[12:15], s36 offen offset:3072  lds
MA 44,148,100
RT 144,9,20480
RT 146,9,20992
MA 40,148,96
s_add_u32 m0, s37, 147456
s_add_u32 s36, s38, 2949760
MA 48,152,96
RT 148,9,28672
RT 150,9,29184
MA 52,152,100
buffer_load_dwordx4 v1, s[12:15], s36 offen offset:0  lds
MA 60,156,100
RT 152,10,20480
RT 154,10,20992
MA 56,156,96
WL 6
v_max_f32 v150, 0, v150
v_max_f32_e64 v151, 0, v151
MA 64,160,96
RT 156,10,28672
RT 158,10,29184
MA 68,160,100
v_mul_f32 v150, v150, v158
v_mul_f32 v151, v151, v159
CV 223,150,151
MA 76,164,100
RT 160,11,20480
RT 162,11,20992
MA 72,164,96
buffer_load_dwordx4 v2, s[12:15], s36 offen offset:1024  lds
MA 80,168,96
RT 164,11,28672
RT 166,11,29184
MA 84,168,100
s_add_u32 s41, s47, 12288
buffer_store_dwordx4 v[208:211], v21, s[20:23], s41 offen offset:0 sc1
MA 92,172,100
RT 168,12,20480
RT 170,12,20992
MA 88,172,96
WL 6
s_nop 0
buffer_store_dwordx4 v[212:215], v21, s[20:23], s41 offen offset:1024 sc1
MA 32,144,104
RT 172,12,28672
RT 174,12,29184
MA 36,144,108
buffer_load_dwordx4 v3, s[12:15], s36 offen offset:2048  lds
MA 44,148,108
RT 144,9,32768
RT 146,9,33280
MA 40,148,104
buffer_store_dwordx4 v[216:219], v21, s[20:23], s41 offen offset:2048 sc1
MA 48,152,104
RT 148,9,40960
RT 150,9,41472
MA 52,152,108
buffer_store_dwordx4 v[220:223], v21, s[20:23], s41 offen offset:3072 sc1
MA 60,156,108
RT 152,10,32768
RT 154,10,33280
MA 56,156,104
WL 6
s_nop 0
MA 64,160,104
RT 156,10,40960
RT 158,10,41472
MA 68,160,108
buffer_load_dwordx4 v4, s[12:15], s36 offen offset:3072  lds
MA 76,164,108
RT 160,11,32768
RT 162,11,33280
MA 72,164,104
MA 80,168,104
RT 164,11,40960
RT 166,11,41472
MA 84,168,108
MA 92,172,108
RT 168,12,32768
RT 170,12,33280
MA 88,172,104
WL 6
s_nop 0
MA 32,144,112
RT 172,12,40960
RT 174,12,41472
MA 36,144,116
MA 44,148,116
RT 144,9,36864
RT 146,9,37376
MA 40,148,112
MA 48,152,112
RT 148,9,45056
RT 150,9,45568
MA 52,152,116
buffer_load_dword v31, v26, s[16:19], s45 offen
MA 60,156,116
RT 152,10,36864
RT 154,10,37376
MA 56,156,112
WL 6
s_nop 0
MA 64,160,112
RT 156,10,45056
RT 158,10,45568
MA 68,160,116
MA 76,164,116
RT 160,11,36864
RT 162,11,37376
MA 72,164,112
MA 80,168,112
RT 164,11,45056
RT 166,11,45568
MA 84,168,116
MA 92,172,116
RT 168,12,36864
RT 170,12,37376
MA 88,172,112
WL 6
s_nop 0
MA 32,144,120
RT 172,12,45056
RT 174,12,45568
MA 36,144,124
s_waitcnt vmcnt(29)
s_barrier
MA 44,148,124
RT 144,9,49152
RT 146,9,49664
MA 40,148,120
s_add_u32 m0, s37, 0
s_nop 0
s_add_u32 s36, s38, 3539584
MA 48,152,120
RT 148,9,57344
RT 150,9,57856
MA 52,152,124
MA 60,156,124
RT 152,10,49152
RT 154,10,49664
MA 56,156,120
WL 6
s_nop 0
MA 64,160,120
RT 156,10,57344
RT 158,10,57856
MA 68,160,124
MA 76,164,124
RT 160,11,49152
RT 162,11,49664
MA 72,164,120
MA 80,168,120
RT 164,11,57344
RT 166,11,57856
MA 84,168,124
MA 92,172,124
RT 168,12,49152
RT 170,12,49664
MA 88,172,120
WL 6
s_nop 0
MA 32,144,128
RT 172,12,57344
RT 174,12,57856
MA 36,144,132
MA 44,148,132
RT 144,9,53248
RT 146,9,53760
MA 40,148,128
MA 48,152,128
RT 148,9,61440
RT 150,9,61952
MA 52,152,132
MA 60,156,132
RT 152,10,53248
RT 154,10,53760
MA 56,156,128
WL 6
s_nop 0
MA 64,160,128
RT 156,10,61440
RT 158,10,61952
MA 68,160,132
MA 76,164,132
RT 160,11,53248
RT 162,11,53760
MA 72,164,128
MA 80,168,128
RT 164,11,61440
RT 166,11,61952
MA 84,168,132
MA 92,172,132
RT 168,12,53248
RT 170,12,53760
MA 88,172,128
WL 6
s_nop 0
MA 32,144,136
RT 172,12,61440
RT 174,12,61952
MA 36,144,140
MA 44,148,140
RT 144,13,0
RT 146,13,512
MA 40,148,136
MA 48,152,136
RT 148,13,8192
RT 150,13,8704
MA 52,152,140
MA 60,156,140
RT 152,14,0
RT 154,14,512
MA 56,156,136
WL 6
s_nop 0
MA 64,160,136
RT 156,14,8192
RT 158,14,8704
MA 68,160,140
MA 76,164,140
RT 160,15,0
RT 162,15,512
MA 72,164,136
MA 80,168,136
RT 164,15,8192
RT 166,15,8704
MA 84,168,140
MA 92,172,140
RT 168,16,0
RT 170,16,512
MA 88,172,136
WL 6
s_nop 0
v_mfma_f32_16x16x32_bf16 v[96:99], a[144:147], a[0:3], 0
RT 172,16,8192
RT 174,16,8704
v_mfma_f32_16x16x32_bf16 v[100:103], a[144:147], a[4:7], 0
v_mfma_f32_16x16x32_bf16 v[108:111], a[148:151], a[4:7], 0
RT 144,13,4096
RT 146,13,4608
v_mfma_f32_16x16x32_bf16 v[104:107], a[148:151], a[0:3], 0
v_mfma_f32_16x16x32_bf16 v[112:115], a[152:155], a[0:3], 0
RT 148,13,12288
RT 150,13,12800
v_mfma_f32_16x16x32_bf16 v[116:119], a[152:155], a[4:7], 0
v_mfma_f32_16x16x32_bf16 v[124:127], a[156:159], a[4:7], 0
RT 152,14,4096
RT 154,14,4608
v_mfma_f32_16x16x32_bf16 v[120:123], a[156:159], a[0:3], 0
WL 6
v_max_f32 v32, 0, v32
v_mfma_f32_16x16x32_bf16 v[128:131], a[160:163], a[0:3], 0
RT 156,14,12288
RT 158,14,12800
v_mfma_f32_16x16x32_bf16 v[132:135], a[160:163], a[4:7], 0
v_max_f32 v33, 0, v33
v_mul_f32 v32, v32, v40
v_mfma_f32_16x16x32_bf16 v[140:143], a[164:167], a[4:7], 0
RT 160,15,4096
RT 162,15,4608
v_mfma_f32_16x16x32_bf16 v[136:139], a[164:167], a[0:3], 0
v_mul_f32_e64 v33, v33, v41
v_mfma_f32_16x16x32_bf16 v[144:147], a[168:171], a[0:3], 0
RT 164,15,12288
RT 166,15,12800
v_mfma_f32_16x16x32_bf16 v[148:151], a[168:171], a[4:7], 0
CV 224,32,33
v_mfma_f32_16x16x32_bf16 v[156:159], a[172:175], a[4:7], 0
RT 168,16,4096
RT 170,16,4608
v_mfma_f32_16x16x32_bf16 v[152:155], a[172:175], a[0:3], 0
WL 6
v_max_f32 v34, 0, v34
MA 96,144,8
RT 172,16,12288
RT 174,16,12800
MA 100,144,12
s_waitcnt vmcnt(2)
s_waitcnt vmcnt(19)
s_barrier
v_mov_b32 v28, s97
buffer_store_dword v28, v24, s[20:23], s63 offen offset:16 sc1
MA 108,148,12
RT 144,13,16384
RT 146,13,16896
MA 104,148,8
v_max_f32 v35, 0, v35
v_mul_f32 v34, v34, v42
MA 112,152,8
RT 148,13,24576
RT 150,13,25088
MA 116,152,12
buffer_load_dwordx4 v1, s[12:15], s36 offen offset:0  lds
MA 124,156,12
RT 152,14,16384
RT 154,14,16896
MA 120,156,8
WL 6
v_mul_f32 v35, v35, v43
MA 128,160,8
RT 156,14,24576
RT 158,14,25088
MA 132,160,12
buffer_load_dwordx4 v2, s[12:15], s36 offen offset:1024  lds
MA 140,164,12
RT 160,15,16384
RT 162,15,16896
MA 136,164,8
CV 225,34,35
v_max_f32_e64 v36, 0, v36
MA 144,168,8
RT 164,15,24576
RT 166,15,25088
MA 148,168,12
buffer_load_dwordx4 v3, s[12:15], s36 offen offset:2048  lds
MA 156,172,12
RT 168,16,16384
RT 170,16,16896
MA 152,172,8
WL 6
v_max_f32 v37, 0, v37
MA 96,144,16
RT 172,16,24576
RT 174,16,25088
MA 100,144,20
buffer_load_dwordx4 v4, s[12:15], s36 offen offset:3072  lds
MA 108,148,20
RT 144,13,20480
RT 146,13,20992
MA 104,148,16
s_add_u32 m0, s37, 16384
s_add_u32 s36, s38, 4129408
MA 112,152,16
RT 148,13,28672
RT 150,13,29184
MA 116,152,20
buffer_load_dwordx4 v1, s[12:15], s36 offen offset:0  lds
MA 124,156,20
RT 152,14,20480
RT 154,14,20992
MA 120,156,16
WL 6
v_mul_f32 v36, v36, v44
MA 128,160,16
RT 156,14,28672
RT 158,14,29184
MA 132,160,20
buffer_load_dwordx4 v2, s[12:15], s36 offen offset:1024  lds
MA 140,164,20
RT 160,15,20480
RT 162,15,20992
MA 136,164,16
v_mul_f32_e64 v37, v37, v45
CV 228,36,37
MA 144,168,16
RT 164,15,28672
RT 166,15,29184
MA 148,168,20
buffer_load_dwordx4 v3, s[12:15], s36 offen offset:2048  lds
MA 156,172,20
RT 168,16,20480
RT 170,16,20992
MA 152,172,16
WL 6
v_max_f32 v38, 0, v38
MA 96,144,24
RT 172,16,28672
RT 174,16,29184
MA 100,144,28
buffer_load_dwordx4 v4, s[12:15], s36 offen offset:3072  lds
MA 108,148,28
RT 144,13,32768
RT 146,13,33280
MA 104,148,24
s_add_u32 m0, s37, 32768
s_add_u32 s36, s38, 4719232
MA 112,152,24
RT 148,13,40960
RT 150,13,41472
MA 116,152,28
buffer_load_dwordx4 v1, s[12:15], s36 offen offset:0  lds
MA 124,156,28
RT 152,14,32768
RT 154,14,33280
MA 120,156,24
WL 6
v_max_f32 v39, 0, v39
MA 128,160,24
RT 156,14,40960
RT 158,14,41472
MA 132,160,28
buffer_load_dwordx4 v2, s[12:15], s36 offen offset:1024  lds
MA 140,164,28
RT 160,15,32768
RT 162,15,33280
MA 136,164,24
v_mul_f32 v38, v38, v46
v_mul_f32 v39, v39, v47
MA 144,168,24
RT 164,15,40960
RT 166,15,41472
MA 148,168,28
buffer_load_dwordx4 v3, s[12:15], s36 offen offset:2048  lds
MA 156,172,28
RT 168,16,32768
RT 170,16,33280
MA 152,172,24
WL 6
s_nop 0
CV 229,38,39
MA 96,144,32
RT 172,16,40960
RT 174,16,41472
MA 100,144,36
buffer_load_dwordx4 v4, s[12:15], s36 offen offset:3072  lds
MA 108,148,36
RT 144,13,36864
RT 146,13,37376
MA 104,148,32
s_add_u32 m0, s37, 49152
s_add_u32 s36, s44, 256
MA 112,152,32
RT 148,13,45056
RT 150,13,45568
MA 116,152,36
buffer_load_dwordx4 v5, s[16:19], s36 offen offset:0  lds
MA 124,156,36
RT 152,14,36864
RT 154,14,37376
MA 120,156,32
WL 6
v_max_f32 v48, 0, v48
MA 128,160,32
RT 156,14,45056
RT 158,14,45568
MA 132,160,36
v_max_f32 v49, 0, v49
v_mul_f32 v48, v48, v56
MA 140,164,36
RT 160,15,36864
RT 162,15,37376
MA 136,164,32
buffer_load_dwordx4 v6, s[16:19], s36 offen offset:1024  lds
MA 144,168,32
RT 164,15,45056
RT 166,15,45568
MA 148,168,36
v_mul_f32_e64 v49, v49, v57
CV 226,48,49
MA 156,172,36
RT 168,16,36864
RT 170,16,37376
MA 152,172,32
WL 6
v_max_f32 v50, 0, v50
MA 96,144,40
RT 172,16,45056
RT 174,16,45568
MA 100,144,44
s_waitcnt vmcnt(24)
s_barrier
MA 108,148,44
RT 144,13,49152
RT 146,13,49664
MA 104,148,40
buffer_load_dword v31, v26, s[16:19], s46 offen
MA 112,152,40
RT 148,13,57344
RT 150,13,57856
MA 116,152,44
buffer_load_dword v31, v30, s[28:31], s85 offen
MA 124,156,44
RT 152,14,49152
RT 154,14,49664
MA 120,156,40
WL 6
v_max_f32 v51, 0, v51
MA 128,160,40
RT 156,14,57344
RT 158,14,57856
MA 132,160,44
v_mul_f32 v50, v50, v58
v_mul_f32 v51, v51, v59
MA 140,164,44
RT 160,15,49152
RT 162,15,49664
MA 136,164,40
CV 227,50,51
v_max_f32_e64 v52, 0, v52
MA 144,168,40
RT 164,15,57344
RT 166,15,57856
MA 148,168,44
v_max_f32 v53, 0, v53
v_mul_f32 v52, v52, v60
MA 156,172,44
RT 168,16,49152
RT 170,16,49664
MA 152,172,40
WL 6
v_mul_f32 v53, v53, v61
MA 96,144,48
RT 172,16,57344
RT 174,16,57856
MA 100,144,52
CV 230,52,53
v_max_f32_e64 v54, 0, v54
MA 108,148,52
RT 144,13,53248
RT 146,13,53760
MA 104,148,48
v_max_f32 v55, 0, v55
v_mul_f32 v54, v54, v62
MA 112,152,48
RT 148,13,61440
RT 150,13,61952
MA 116,152,52
s_getpc_b64 s[6:7]
s_nop 0
s_load_dword s5, s[6:7], s101
MA 124,156,52
RT 152,14,53248
RT 154,14,53760
MA 120,156,48
WL 6
v_mul_f32 v55, v55, v63
MA 128,160,48
RT 156,14,61440
RT 158,14,61952
MA 132,160,52
CV 231,54,55
v_max_f32_e64 v64, 0, v64
MA 140,164,52
RT 160,15,53248
RT 162,15,53760
MA 136,164,48
v_max_f32 v65, 0, v65
v_mul_f32 v64, v64, v72
MA 144,168,48
RT 164,15,61440
RT 166,15,61952
MA 148,168,52
buffer_load_dword v28, v23, s[20:23], s52 offen sc1
MA 156,172,52
RT 168,16,53248
RT 170,16,53760
MA 152,172,48
WL 6
v_mul_f32 v65, v65, v73
MA 96,144,56
RT 172,16,61440
RT 174,16,61952
MA 100,144,60
CV 232,64,65
v_max_f32_e64 v66, 0, v66
MA 108,148,60
RT 144,17,0
RT 146,17,512
MA 104,148,56
v_max_f32 v67, 0, v67
v_mul_f32 v66, v66, v74
MA 112,152,56
RT 148,17,8192
RT 150,17,8704
MA 116,152,60
v_mul_f32_e64 v67, v67, v75
CV 233,66,67
MA 124,156,60
RT 152,18,0
RT 154,18,512
MA 120,156,56
WL 6
v_max_f32 v68, 0, v68
MA 128,160,56
RT 156,18,8192
RT 158,18,8704
MA 132,160,60
v_max_f32 v69, 0, v69
v_mul_f32 v68, v68, v76
MA 140,164,60
RT 160,19,0
RT 162,19,512
MA 136,164,56
v_mul_f32_e64 v69, v69, v77
CV 236,68,69
MA 144,168,56
RT 164,19,8192
RT 166,19,8704
MA 148,168,60
v_max_f32 v70, 0, v70
v_max_f32 v71, 0, v71
MA 156,172,60
RT 168,20,0
RT 170,20,512
MA 152,172,56
WL 6
v_mul_f32 v70, v70, v78
MA 96,144,64
RT 172,20,8192
RT 174,20,8704
MA 100,144,68
v_mul_f32_e64 v71, v71, v79
CV 237,70,71
MA 108,148,68
RT 144,17,4096
RT 146,17,4608
MA 104,148,64
v_max_f32 v80, 0, v80
v_max_f32 v81, 0, v81
MA 112,152,64
RT 148,17,12288
RT 150,17,12800
MA 116,152,68
v_mul_f32 v80, v80, v88
v_mul_f32 v81, v81, v89
MA 124,156,68
RT 152,18,4096
RT 154,18,4608
MA 120,156,64
WL 6
s_nop 0
CV 234,80,81
MA 128,160,64
RT 156,18,12288
RT 158,18,12800
MA 132,160,68
v_max_f32 v82, 0, v82
v_max_f32 v83, 0, v83
MA 140,164,68
RT 160,19,4096
RT 162,19,4608
MA 136,164,64
v_mul_f32 v82, v82, v90
v_mul_f32 v83, v83, v91
MA 144,168,64
RT 164,19,12288
RT 166,19,12800
MA 148,168,68
CV 235,82,83
v_max_f32_e64 v84, 0, v84
MA 156,172,68
RT 168,20,4096
RT 170,20,4608
MA 152,172,64
WL 6
v_max_f32 v85, 0, v85
MA 96,144,72
RT 172,20,12288
RT 174,20,12800
MA 100,144,76
s_waitcnt vmcnt(13)
s_barrier
MA 108,148,76
RT 144,17,16384
RT 146,17,16896
MA 104,148,72
v_mul_f32 v84, v84, v92
v_mul_f32 v85, v85, v93
MA 112,152,72
RT 148,17,24576
RT 150,17,25088
MA 116,152,76
CV 238,84,85
v_max_f32_e64 v86, 0, v86
MA 124,156,76
RT 152,18,16384
RT 154,18,16896
MA 120,156,72
WL 6
v_max_f32 v87, 0, v87
MA 128,160,72
RT 156,18,24576
RT 158,18,25088
MA 132,160,76
v_mul_f32 v86, v86, v94
v_mul_f32 v87, v87, v95
MA 140,164,76
RT 160,19,16384
RT 162,19,16896
MA 136,164,72
CV 239,86,87
s_add_u32 s41, s47, 16384
MA 144,168,72
RT 164,19,24576
RT 166,19,25088
MA 148,168,76
buffer_store_dwordx4 v[224:227], v21, s[20:23], s41 offen offset:0 sc1
MA 156,172,76
RT 168,20,16384
RT 170,20,16896
MA 152,172,72
WL 6
s_nop 0
MA 96,144,80
RT 172,20,24576
RT 174,20,25088
MA 100,144,84
buffer_load_dwordx4 v7, s[16:19], s36 offen offset:2048  lds
MA 108,148,84
RT 144,17,20480
RT 146,17,20992
MA 104,148,80
buffer_store_dwordx4 v[228:231], v21, s[20:23], s41 offen offset:1024 sc1
MA 112,152,80
RT 148,17,28672
RT 150,17,29184
MA 116,152,84
buffer_load_dwordx4 v8, s[16:19], s36 offen offset:3072  lds
MA 124,156,84
RT 152,18,20480
RT 154,18,20992
MA 120,156,80
WL 6
s_add_u32 m0, s37, 65536
s_add_u32 s36, s53, 0
MA 128,160,80
RT 156,18,28672
RT 158,18,29184
MA 132,160,84
buffer_load_dwordx4 v5, s[16:19], s36 offen offset:0  lds
MA 140,164,84
RT 160,19,20480
RT 162,19,20992
MA 136,164,80
buffer_store_dwordx4 v[232:235], v21, s[20:23], s41 offen offset:2048 sc1
MA 144,168,80
RT 164,19,28672
RT 166,19,29184
MA 148,168,84
buffer_load_dwordx4 v6, s[16:19], s36 offen offset:1024  lds
MA 156,172,84
RT 168,20,20480
RT 170,20,20992
MA 152,172,80
WL 6
s_nop 0
MA 96,144,88
RT 172,20,28672
RT 174,20,29184
MA 100,144,92
buffer_load_dwordx4 v7, s[16:19], s36 offen offset:2048  lds
MA 108,148,92
RT 144,9,0
RT 146,9,512
MA 104,148,88
buffer_store_dwordx4 v[236:239], v21, s[20:23], s41 offen offset:3072 sc1
MA 112,152,88
RT 148,9,8192
RT 150,9,8704
MA 116,152,92
buffer_load_dwordx4 v8, s[16:19], s36 offen offset:3072  lds
MA 124,156,92
RT 152,10,0
RT 154,10,512
MA 120,156,88
WL 6
s_nop 0
s_add_u32 m0, s37, 81920
s_add_u32 s36, s44, 147712
MA 128,160,88
RT 156,10,8192
RT 158,10,8704
MA 132,160,92
buffer_load_dwordx4 v5, s[16:19], s36 offen offset:0  lds
MA 140,164,92
RT 160,11,0
RT 162,11,512
MA 136,164,88
MA 144,168,88
RT 164,11,8192
RT 166,11,8704
MA 148,168,92
buffer_load_dwordx4 v6, s[16:19], s36 offen offset:1024  lds
MA 156,172,92
RT 168,12,0
RT 170,12,512
MA 152,172,88
WL 6
s_nop 0
MA 96,144,96
RT 172,12,8192
RT 174,12,8704
MA 100,144,100
buffer_load_dwordx4 v7, s[16:19], s36 offen offset:2048  lds
MA 108,148,100
RT 144,9,4096
RT 146,9,4608
MA 104,148,96
MA 112,152,96
RT 148,9,12288
RT 150,9,12800
MA 116,152,100
buffer_load_dwordx4 v8, s[16:19], s36 offen offset:3072  lds
MA 124,156,100
RT 152,10,4096
RT 154,10,4608
MA 120,156,96
WL 6
s_nop 0
s_add_u32 m0, s37, 98304
s_add_u32 s36, s53, 147456
MA 128,160,96
RT 156,10,12288
RT 158,10,12800
MA 132,160,100
buffer_load_dwordx4 v5, s[16:19], s36 offen offset:0  lds
MA 140,164,100
RT 160,11,4096
RT 162,11,4608
MA 136,164,96
MA 144,168,96
RT 164,11,12288
RT 166,11,12800
MA 148,168,100
buffer_load_dwordx4 v6, s[16:19], s36 offen offset:1024  lds
MA 156,172,100
RT 168,12,4096
RT 170,12,4608
MA 152,172,96
WL 6
s_nop 0
MA 96,144,104
RT 172,12,12288
RT 174,12,12800
MA 100,144,108
s_cmp_lg_u32 s32, 0
s_cbranch_scc1 L_polld_8
s_mov_b32 s89, 0x20000
s_waitcnt vmcnt(16)
s_branch L_pollc_9
L_poll_7:
buffer_load_dword v28, v23, s[20:23], s52 offen sc1
s_waitcnt vmcnt(0)
L_pollc_9:
v_cmp_eq_u32 s[98:99], s97, v28
s_sub_u32 s89, s89, 1
s_and_b32 s98, s98, 0x70
s_cmp_eq_u32 s98, 0x70
s_cbranch_scc1 L_polld_8
s_sleep 4
s_cmp_lg_u32 s89, 0
s_cbranch_scc1 L_poll_7
L_polld_8:
s_waitcnt vmcnt(21)
s_barrier
MA 108,148,108
RT 144,9,16384
RT 146,9,16896
MA 104,148,104
s_add_u32 s35, s48, 8192
MA 112,152,104
RT 148,9,24576
RT 150,9,25088
MA 116,152,108
buffer_load_dwordx4 v7, s[16:19], s36 offen offset:2048  lds
MA 124,156,108
RT 152,10,16384
RT 154,10,16896
MA 120,156,104
WL 6
s_nop 0
MA 128,160,104
RT 156,10,24576
RT 158,10,25088
MA 132,160,108
buffer_load_dwordx4 v8, s[16:19], s36 offen offset:3072  lds
MA 140,164,108
RT 160,11,16384
RT 162,11,16896
MA 136,164,104
s_add_u32 m0, s37, 114688
s_add_u32 s36, s44, 295168
MA 144,168,104
RT 164,11,24576
RT 166,11,25088
MA 148,168,108
buffer_load_dwordx4 v5, s[16:19], s36 offen offset:0  lds
MA 156,172,108
RT 168,12,16384
RT 170,12,16896
MA 152,172,104
WL 6
s_nop 0
MA 96,144,112
RT 172,12,24576
RT 174,12,25088
MA 100,144,116
buffer_load_dwordx4 v6, s[16:19], s36 offen offset:1024  lds
MA 108,148,116
RT 144,9,20480
RT 146,9,20992
MA 104,148,112
MA 112,152,112
RT 148,9,28672
RT 150,9,29184
MA 116,152,116
buffer_load_dwordx4 v7, s[16:19], s36 offen offset:2048  lds
MA 124,156,116
RT 152,10,20480
RT 154,10,20992
MA 120,156,112
WL 6
s_nop 0
MA 128,160,112
RT 156,10,28672
RT 158,10,29184
MA 132,160,116
buffer_load_dwordx4 a[208:211], v21, s[20:23], s35 offen offset:0 sc1
MA 140,164,116
RT 160,11,20480
RT 162,11,20992
MA 136,164,112
buffer_load_dwordx4 v8, s[16:19], s36 offen offset:3072  lds
MA 144,168,112
RT 164,11,28672
RT 166,11,29184
MA 148,168,116
s_add_u32 m0, s37, 131072
s_add_u32 s36, s53, 294912
MA 156,172,116
RT 168,12,20480
RT 170,12,20992
MA 152,172,112
WL 6
s_nop 0
MA 96,144,120
RT 172,12,28672
RT 174,12,29184
MA 100,144,124
buffer_load_dwordx4 v5, s[16:19], s36 offen offset:0  lds
MA 108,148,124
RT 144,9,32768
RT 146,9,33280
MA 104,148,120
MA 112,152,120
RT 148,9,40960
RT 150,9,41472
MA 116,152,124
buffer_load_dwordx4 v6, s[16:19], s36 offen offset:1024  lds
MA 124,156,124
RT 152,10,32768
RT 154,10,33280
MA 120,156,120
WL 6
s_nop 0
MA 128,160,120
RT 156,10,40960
RT 158,10,41472
MA 132,160,124
buffer_load_dwordx4 v7, s[16:19], s36 offen offset:2048  lds
MA 140,164,124
RT 160,11,32768
RT 162,11,33280
MA 136,164,120
buffer_load_dwordx4 a[212:215], v21, s[20:23], s35 offen offset:1024 sc1
MA 144,168,120
RT 164,11,40960
RT 166,11,41472
MA 148,168,124
buffer_load_dwordx4 v8, s[16:19], s36 offen offset:3072  lds
MA 156,172,124
RT 168,12,32768
RT 170,12,33280
MA 152,172,120
WL 6
s_nop 0
s_add_u32 m0, s37, 147456
s_add_u32 s36, s45, 256
MA 96,144,128
RT 172,12,40960
RT 174,12,41472
MA 100,144,132
buffer_load_dwordx4 v5, s[16:19], s36 offen offset:0  lds
MA 108,148,132
RT 144,9,36864
RT 146,9,37376
MA 104,148,128
MA 112,152,128
RT 148,9,45056
RT 150,9,45568
MA 116,152,132
MA 124,156,132
RT 152,10,36864
RT 154,10,37376
MA 120,156,128
WL 6
s_nop 0
MA 128,160,128
RT 156,10,45056
RT 158,10,45568
MA 132,160,132
buffer_load_dwordx4 v6, s[16:19], s36 offen offset:1024  lds
MA 140,164,132
RT 160,11,36864
RT 162,11,37376
MA 136,164,128
MA 144,168,128
RT 164,11,45056
RT 166,11,45568
MA 148,168,132
MA 156,172,132
RT 168,12,36864
RT 170,12,37376
MA 152,172,128
WL 6
s_nop 0
MA 96,144,136
RT 172,12,45056
RT 174,12,45568
MA 100,144,140
s_waitcnt vmcnt(20)
s_barrier
v_sub_u32 v9, v9, v27
v_sub_u32 v10, v10, v27
v_sub_u32 v11, v11, v27
v_sub_u32 v12, v12, v27
v_sub_u32 v13, v13, v27
v_sub_u32 v14, v14, v27
v_sub_u32 v15, v15, v27
v_sub_u32 v16, v16, v27
v_sub_u32 v17, v17, v27
v_sub_u32 v18, v18, v27
v_sub_u32 v19, v19, v27
v_sub_u32 v20, v20, v27
MA 108,148,140
RT 144,9,49152
RT 146,9,51200
MA 104,148,136
buffer_load_dwordx4 a[216:219], v21, s[20:23], s35 offen offset:2048 sc1
MA 112,152,136
RT 148,10,49152
RT 150,10,51200
MA 116,152,140
buffer_load_dwordx4 v7, s[16:19], s36 offen offset:2048  lds
MA 124,156,140
RT 152,11,49152
RT 154,11,51200
MA 120,156,136
WL 6
s_nop 0
MA 128,160,136
RT 156,12,49152
RT 158,12,51200
MA 132,160,140
buffer_load_dwordx4 v8, s[16:19], s36 offen offset:3072  lds
MA 140,164,140
RT 160,9,53248
RT 162,9,55296
MA 136,164,136
s_add_u32 m0, s37, 0
s_add_u32 s36, s54, 0
MA 144,168,136
RT 164,10,53248
RT 166,10,55296
MA 148,168,140
buffer_load_dwordx4 v5, s[16:19], s36 offen offset:0  lds
MA 156,172,140
RT 168,11,53248
RT 170,11,55296
MA 152,172,136
WL 6
s_nop 0
v_mfma_f32_16x16x32_bf16 v[32:35], a[144:147], v[160:163], 0
RT 172,12,53248
RT 174,12,55296
v_mfma_f32_16x16x32_bf16 v[36:39], a[144:147], v[164:167], 0
buffer_load_dwordx4 v6, s[16:19], s36 offen offset:1024  lds
v_mfma_f32_16x16x32_bf16 v[44:47], a[148:151], v[164:167], 0
RT 144,9,57344
RT 146,9,59392
v_mfma_f32_16x16x32_bf16 v[40:43], a[148:151], v[160:163], 0
buffer_load_dwordx4 a[220:223], v21, s[20:23], s35 offen offset:3072 sc1
v_mfma_f32_16x16x32_bf16 v[48:51], a[152:155], v[160:163], 0
RT 148,10,57344
RT 150,10,59392
v_mfma_f32_16x16x32_bf16 v[52:55], a[152:155], v[164:167], 0
buffer_load_dwordx4 v7, s[16:19], s36 offen offset:2048  lds
v_mfma_f32_16x16x32_bf16 v[60:63], a[156:159], v[164:167], 0
RT 152,11,57344
RT 154,11,59392
v_mfma_f32_16x16x32_bf16 v[56:59], a[156:159], v[160:163], 0
WL 6
v_max_f32 v96, 0, v96
MV 32,160,168
RT 156,12,57344
RT 158,12,59392
MV 36,160,172
buffer_load_dwordx4 v8, s[16:19], s36 offen offset:3072  lds
v_max_f32_e64 v97, 0, v97
MV 44,164,172
RT 160,9,61440
RT 162,9,63488
MV 40,164,168
s_add_u32 m0, s50, 16384
s_add_u32 s36, s56, 0
v_mul_f32 v96, v96, v104
MV 48,168,168
RT 164,10,61440
RT 166,10,63488
MV 52,168,172
buffer_load_dwordx4 v25, s[16:19], s36 offen offset:0  lds
v_mul_f32_e64 v97, v97, v105
MV 60,172,172
RT 168,11,61440
RT 170,11,63488
MV 56,172,168
WL 6
CV 240,96,97
v_max_f32 v98, 0, v98
MV 32,144,176
RT 172,12,61440
RT 174,12,63488
MV 36,144,180
v_max_f32 v99, 0, v99
v_mul_f32 v98, v98, v106
v_mul_f32_e64 v99, v99, v107
MV 44,148,180
RT 144,13,0
RT 146,13,2048
MV 40,148,176
buffer_load_dwordx4 v22, s[16:19], s36 offen offset:1024  lds
CV 241,98,99
MV 48,152,176
RT 148,14,0
RT 150,14,2048
MV 52,152,180
s_add_u32 m0, s50, 24576
s_add_u32 s36, s56, 147456
v_max_f32_e64 v100, 0, v100
MV 60,156,180
RT 152,15,0
RT 154,15,2048
MV 56,156,176
WL 6
v_max_f32 v101, 0, v101
v_mul_f32_e64 v100, v100, v108
MV 32,160,184
RT 156,16,0
RT 158,16,2048
MV 36,160,188
s_add_u32 s35, s48, 12288
MV 44,164,188
RT 160,13,4096
RT 162,13,6144
MV 40,164,184
buffer_load_dwordx4 v25, s[16:19], s36 offen offset:0  lds
v_mul_f32_e64 v101, v101, v109
MV 48,168,184
RT 164,14,4096
RT 166,14,6144
MV 52,168,188
CV 244,100,101
v_max_f32 v102, 0, v102
v_max_f32 v103, 0, v103
MV 60,172,188
RT 168,15,4096
RT 170,15,6144
MV 56,172,184
WL 6
v_mul_f32 v102, v102, v110
v_mul_f32_e64 v103, v103, v111
v_mfma_f32_16x16x32_bf16 v[64:67], a[144:147], v[160:163], 0
RT 172,16,4096
RT 174,16,6144
v_mfma_f32_16x16x32_bf16 v[68:71], a[144:147], v[164:167], 0
buffer_load_dwordx4 v22, s[16:19], s36 offen offset:1024  lds
CV 245,102,103
v_mfma_f32_16x16x32_bf16 v[76:79], a[148:151], v[164:167], 0
RT 144,13,8192
RT 146,13,10240
v_mfma_f32_16x16x32_bf16 v[72:75], a[148:151], v[160:163], 0
v_max_f32 v112, 0, v112
v_max_f32 v113, 0, v113
v_mul_f32_e64 v112, v112, v120
v_mfma_f32_16x16x32_bf16 v[80:83], a[152:155], v[160:163], 0
RT 148,14,8192
RT 150,14,10240
v_mfma_f32_16x16x32_bf16 v[84:87], a[152:155], v[164:167], 0
v_mul_f32_e64 v113, v113, v121
CV 242,112,113
v_max_f32_e64 v114, 0, v114
v_mfma_f32_16x16x32_bf16 v[92:95], a[156:159], v[164:167], 0
RT 152,15,8192
RT 154,15,10240
v_mfma_f32_16x16x32_bf16 v[88:91], a[156:159], v[160:163], 0
WL 6
v_max_f32 v115, 0, v115
v_mul_f32_e64 v114, v114, v122
MV 64,160,168
RT 156,16,8192
RT 158,16,10240
MV 68,160,172
v_mul_f32_e64 v115, v115, v123
CV 243,114,115
v_max_f32_e64 v116, 0, v116
MV 76,164,172
RT 160,13,12288
RT 162,13,14336
MV 72,164,168
buffer_load_dwordx4 a[224:227], v21, s[20:23], s35 offen offset:0 sc1
MV 80,168,168
RT 164,14,12288
RT 166,14,14336
MV 84,168,172
v_max_f32 v117, 0, v117
v_mul_f32 v116, v116, v124
v_mul_f32_e64 v117, v117, v125
MV 92,172,172
RT 168,15,12288
RT 170,15,14336
MV 88,172,168
WL 6
CV 246,116,117
v_max_f32 v118, 0, v118
MV 64,144,176
RT 172,16,12288
RT 174,16,14336
MV 68,144,180
s_waitcnt vmcnt(25)
s_barrier
MV 76,148,180
RT 144,13,16384
RT 146,13,18432
MV 72,148,176
s_add_u32 m0, s50, 32768
s_add_u32 s36, s56, 294912
v_max_f32_e64 v119, 0, v119
MV 80,152,176
RT 148,14,16384
RT 150,14,18432
MV 84,152,180
buffer_load_dwordx4 v25, s[16:19], s36 offen offset:0  lds
v_mul_f32_e64 v118, v118, v126
MV 92,156,180
RT 152,15,16384
RT 154,15,18432
MV 88,156,176
WL 6
v_mul_f32 v119, v119, v127
CV 247,118,119
MV 64,160,184
RT 156,16,16384
RT 158,16,18432
MV 68,160,188
buffer_load_dwordx4 v22, s[16:19], s36 offen offset:1024  lds
v_max_f32_e64 v128, 0, v128
MV 76,164,188
RT 160,13,20480
RT 162,13,22528
MV 72,164,184
s_add_u32 m0, s50, 40960
s_add_u32 s36, s57, 0
v_max_f32 v129, 0, v129
MV 80,168,184
RT 164,14,20480
RT 166,14,22528
MV 84,168,188
buffer_load_dwordx4 v25, s[16:19], s36 offen offset:0  lds
v_mul_f32_e64 v128, v128, v136
MV 92,172,188
RT 168,15,20480
RT 170,15,22528
MV 88,172,184
WL 6
v_mul_f32 v129, v129, v137
CV 248,128,129
MV 32,144,192
RT 172,16,20480
RT 174,16,22528
MV 36,144,196
s_getpc_b64 s[6:7]
s_nop 0
s_load_dword s5, s[6:7], s101
MV 44,148,196
RT 144,13,24576
RT 146,13,26624
MV 40,148,192
buffer_load_dwordx4 a[228:231], v21, s[20:23], s35 offen offset:1024 sc1
MV 48,152,192
RT 148,14,24576
RT 150,14,26624
MV 52,152,196
buffer_load_dwordx4 v22, s[16:19], s36 offen offset:1024  lds
v_max_f32_e64 v130, 0, v130
MV 60,156,196
RT 152,15,24576
RT 154,15,26624
MV 56,156,192
WL 6
s_add_u32 m0, s37, 49152
s_add_u32 s36, s45, 147712
v_max_f32 v131, 0, v131
MV 32,160,200
RT 156,16,24576
RT 158,16,26624
MV 36,160,204
buffer_load_dwordx4 v5, s[16:19], s36 offen offset:0  lds
v_mul_f32_e64 v130, v130, v138
MV 44,164,204
RT 160,13,28672
RT 162,13,30720
MV 40,164,200
v_mul_f32_e64 v131, v131, v139
CV 249,130,131
v_max_f32_e64 v132, 0, v132
MV 48,168,200
RT 164,14,28672
RT 166,14,30720
MV 52,168,204
v_max_f32 v133, 0, v133
v_mul_f32 v132, v132, v140
v_mul_f32_e64 v133, v133, v141
MV 60,172,204
RT 168,15,28672
RT 170,15,30720
MV 56,172,200
WL 6
CV 252,132,133
v_max_f32 v134, 0, v134
MV 32,144,208
RT 172,16,28672
RT 174,16,30720
MV 36,144,212
buffer_load_dwordx4 v6, s[16:19], s36 offen offset:1024  lds
v_max_f32_e64 v135, 0, v135
MV 44,148,212
RT 144,13,32768
RT 146,13,34816
MV 40,148,208
buffer_load_dwordx4 a[232:235], v21, s[20:23], s35 offen offset:2048 sc1
MV 48,152,208
RT 148,14,32768
RT 150,14,34816
MV 52,152,212
v_mul_f32 v134, v134, v142
v_mul_f32 v135, v135, v143
CV 253,134,135
MV 60,156,212
RT 152,15,32768
RT 154,15,34816
MV 56,156,208
WL 6
v_max_f32 v144, 0, v144
v_max_f32_e64 v145, 0, v145
MV 32,160,216
RT 156,16,32768
RT 158,16,34816
MV 36,160,220
buffer_load_dwordx4 v7, s[16:19], s36 offen offset:2048  lds
v_mul_f32_e64 v144, v144, v152
MV 44,164,220
RT 160,13,36864
RT 162,13,38912
MV 40,164,216
v_mul_f32_e64 v145, v145, v153
CV 250,144,145
v_max_f32_e64 v146, 0, v146
MV 48,168,216
RT 164,14,36864
RT 166,14,38912
MV 52,168,220
v_max_f32 v147, 0, v147
v_mul_f32 v146, v146, v154
v_mul_f32_e64 v147, v147, v155
MV 60,172,220
RT 168,15,36864
RT 170,15,38912
MV 56,172,216
WL 6
CV 251,146,147
v_max_f32 v148, 0, v148
MV 64,144,192
RT 172,16,36864
RT 174,16,38912
MV 68,144,196
buffer_load_dwordx4 v8, s[16:19], s36 offen offset:3072  lds
v_max_f32_e64 v149, 0, v149
MV 76,148,196
RT 144,13,40960
RT 146,13,43008
MV 72,148,192
v_mul_f32 v148, v148, v156
v_mul_f32 v149, v149, v157
CV 254,148,149
MV 80,152,192
RT 148,14,40960
RT 150,14,43008
MV 84,152,196
v_max_f32 v150, 0, v150
v_max_f32 v151, 0, v151
v_mul_f32_e64 v150, v150, v158
MV 92,156,196
RT 152,15,40960
RT 154,15,43008
MV 88,156,192
WL 6
v_mul_f32 v151, v151, v159
CV 255,150,151
MV 64,160,200
RT 156,16,40960
RT 158,16,43008
MV 68,160,204
buffer_load_dwordx4 a[236:239], v21, s[20:23], s35 offen offset:3072 sc1
MV 76,164,204
RT 160,13,45056
RT 162,13,47104
MV 72,164,200
s_add_u32 s41, s47, 20480
buffer_store_dwordx4 v[240:243], v21, s[20:23], s41 offen offset:0 sc1
MV 80,168,200
RT 164,14,45056
RT 166,14,47104
MV 84,168,204
buffer_store_dwordx4 v[244:247], v21, s[20:23], s41 offen offset:1024 sc1
MV 92,172,204
RT 168,15,45056
RT 170,15,47104
MV 88,172,200
WL 6
s_nop 0
buffer_store_dwordx4 v[248:251], v21, s[20:23], s41 offen offset:2048 sc1
MV 64,144,208
RT 172,16,45056
RT 174,16,47104
MV 68,144,212
s_waitcnt vmcnt(29)
s_barrier
MV 76,148,212
RT 144,13,49152
RT 146,13,51200
MV 72,148,208
s_add_u32 m0, s37, 65536
s_add_u32 s36, s54, 147456
MV 80,152,208
RT 148,14,49152
RT 150,14,51200
MV 84,152,212
buffer_load_dwordx4 v5, s[16:19], s36 offen offset:0  lds
MV 92,156,212
RT 152,15,49152
RT 154,15,51200
MV 88,156,208
WL 6
s_nop 0
buffer_store_dwordx4 v[252:255], v21, s[20:23], s41 offen offset:3072 sc1
MV 64,160,216
RT 156,16,49152
RT 158,16,51200
MV 68,160,220
buffer_load_dwordx4 v6, s[16:19], s36 offen offset:1024  lds
MV 76,164,220
RT 160,13,53248
RT 162,13,55296
MV 72,164,216
v_bfe_u32 v144, v0, 2, 4
v_lshlrev_b32_e64 v144, 6, v144
v_bfe_u32 v145, v0, 4, 1
MV 80,168,216
RT 164,14,53248
RT 166,14,55296
MV 84,168,220
buffer_load_dwordx4 v7, s[16:19], s36 offen offset:2048  lds
MV 92,172,220
RT 168,15,53248
RT 170,15,55296
MV 88,172,216
WL 6
v_lshl_add_u32 v144, v145, 5, v144
v_and_b32 v145, 3, v0
MV 32,144,224
RT 172,16,53248
RT 174,16,55296
MV 36,144,228
buffer_load_dwordx4 v8, s[16:19], s36 offen offset:3072  lds
MV 44,148,228
RT 144,13,57344
RT 146,13,59392
MV 40,148,224
s_add_u32 m0, s37, 81920
s_add_u32 s36, s46, 256
MV 48,152,224
RT 148,14,57344
RT 150,14,59392
MV 52,152,228
buffer_load_dwordx4 v5, s[16:19], s36 offen offset:0  lds
MV 60,156,228
RT 152,15,57344
RT 154,15,59392
MV 56,156,224
WL 6
v_lshl_add_u32 v144, v145, 3, v144
v_xor_b32 v145, 32, v144
MV 32,160,232
RT 156,16,57344
RT 158,16,59392
MV 36,160,236
v_add_u32 v146, 0x10000, v144
v_add_u32 v147, 0x10000, v145
v_add_u32 v148, 0x20000, v144
MV 44,164,236
RT 160,13,61440
RT 162,13,63488
MV 40,164,232
buffer_load_dwordx4 v6, s[16:19], s36 offen offset:1024  lds
MV 48,168,232
RT 164,14,61440
RT 166,14,63488
MV 52,168,236
v_add_u32 v149, 0x20000, v145
v_lshrrev_b32_e64 v2, 5, v0
v_bfe_u32 v3, v0, 3, 2
MV 60,172,236
RT 168,15,61440
RT 170,15,63488
MV 56,172,232
WL 6
s_nop 0
v_lshl_add_u32 v2, v2, 4, v3
v_mul_u32_u24 v4, 1152, v2
MV 32,144,240
RT 172,16,61440
RT 174,16,63488
MV 36,144,244
buffer_load_dwordx4 v7, s[16:19], s36 offen offset:2048  lds
MV 44,148,244
RT 144,17,0
RT 146,17,2048
MV 40,148,240
v_bfe_u32 v2, v0, 4, 2
v_lshlrev_b32 v2, 1, v2
v_and_b32 v3, 7, v0
MV 48,152,240
RT 148,18,0
RT 150,18,2048
MV 52,152,244
v_xor_b32_e64 v2, v2, v3
v_lshl_add_u32 v4, v2, 4, v4
v_add_u32 v1, 256, v4
MV 60,156,244
RT 152,19,0
RT 154,19,2048
MV 56,156,240
WL 6
s_sub_u32 s96, s53, s44
v_add_u32_e64 v2, s96, v4
MV 32,160,248
RT 156,20,0
RT 158,20,2048
MV 36,160,252
buffer_load_dwordx4 v8, s[16:19], s36 offen offset:3072  lds
MV 44,164,252
RT 160,17,4096
RT 162,17,6144
MV 40,164,248
s_sub_u32 s96, s56, s44
s_and_b32 s95, s96, 64
v_xor_b32_e64 v3, s95, v4
MV 48,168,248
RT 164,18,4096
RT 166,18,6144
MV 52,168,252
s_and_b32 s96, s96, 128
v_add_u32_e64 v3, s96, v3
MV 60,172,252
RT 168,19,4096
RT 170,19,6144
MV 56,172,248
WL 6
s_nop 0
MV 64,144,224
RT 172,20,4096
RT 174,20,6144
MV 68,144,228
MV 76,148,228
RT 144,17,8192
RT 146,17,10240
MV 72,148,224
MV 80,152,224
RT 148,18,8192
RT 150,18,10240
MV 84,152,228
MV 92,156,228
RT 152,19,8192
RT 154,19,10240
MV 88,156,224
WL 6
s_nop 0
MV 64,160,232
RT 156,20,8192
RT 158,20,10240
MV 68,160,236
MV 76,164,236
RT 160,17,12288
RT 162,17,14336
MV 72,164,232
MV 80,168,232
RT 164,18,12288
RT 166,18,14336
MV 84,168,236
MV 92,172,236
RT 168,19,12288
RT 170,19,14336
MV 88,172,232
WL 6
s_nop 0
MV 64,144,240
RT 172,20,12288
RT 174,20,14336
MV 68,144,244
s_waitcnt vmcnt(63)
s_waitcnt vmcnt(28)
s_barrier
s_nop 0
MV 76,148,244
RT 144,17,16384
RT 146,17,18432
MV 72,148,240
s_add_u32 m0, s37, 98304
s_add_u32 s36, s55, 0
s_nop 0
MV 80,152,240
RT 148,18,16384
RT 150,18,18432
MV 84,152,244
buffer_load_dwordx4 v5, s[16:19], s36 offen offset:0  lds
MV 92,156,244
RT 152,19,16384
RT 154,19,18432
MV 88,156,240
WL 6
s_nop 0
MV 64,160,248
RT 156,20,16384
RT 158,20,18432
MV 68,160,252
buffer_load_dwordx4 v6, s[16:19], s36 offen offset:1024  lds
MV 76,164,252
RT 160,17,20480
RT 162,17,22528
MV 72,164,248
MV 80,168,248
RT 164,18,20480
RT 166,18,22528
MV 84,168,252
buffer_load_dwordx4 v7, s[16:19], s36 offen offset:2048  lds
MV 92,172,252
RT 168,19,20480
RT 170,19,22528
MV 88,172,248
WL 6
s_nop 0
MA 32,144,176
RT 172,20,20480
RT 174,20,22528
MA 36,144,180
buffer_load_dwordx4 v8, s[16:19], s36 offen offset:3072  lds
MA 44,148,180
RT 144,17,24576
RT 146,17,26624
MA 40,148,176
s_add_u32 m0, s37, 114688
s_add_u32 s36, s46, 147712
MA 48,152,176
RT 148,18,24576
RT 150,18,26624
MA 52,152,180
buffer_load_dwordx4 v5, s[16:19], s36 offen offset:0  lds
MA 60,156,180
RT 152,19,24576
RT 154,19,26624
MA 56,156,176
WL 6
s_nop 0
MA 32,160,184
RT 156,20,24576
RT 158,20,26624
MA 36,160,188
s_add_u32 s35, s49, 0
s_nop 0
MA 44,164,188
RT 160,17,28672
RT 162,17,30720
MA 40,164,184
buffer_load_dwordx4 v6, s[16:19], s36 offen offset:1024  lds
MA 48,168,184
RT 164,18,28672
RT 166,18,30720
MA 52,168,188
MA 60,172,188
RT 168,19,28672
RT 170,19,30720
MA 56,172,184
WL 6
s_nop 0
MA 32,144,192
RT 172,20,28672
RT 174,20,30720
MA 36,144,196
buffer_load_dwordx4 a[0:3], v21, s[20:23], s35 offen offset:0 sc1
MA 44,148,196
RT 144,9,0
RT 146,9,2048
MA 40,148,192
buffer_load_dwordx4 v7, s[16:19], s36 offen offset:2048  lds
MA 48,152,192
RT 148,10,0
RT 150,10,2048
MA 52,152,196
buffer_load_dwordx4 a[4:7], v21, s[20:23], s35 offen offset:1024 sc1
MA 60,156,196
RT 152,11,0
RT 154,11,2048
MA 56,156,192
WL 6
s_nop 0
MA 32,160,200
RT 156,12,0
RT 158,12,2048
MA 36,160,204
buffer_load_dwordx4 v8, s[16:19], s36 offen offset:3072  lds
MA 44,164,204
RT 160,9,4096
RT 162,9,6144
MA 40,164,200
buffer_load_dwordx4 a[8:11], v21, s[20:23], s35 offen offset:2048 sc1
MA 48,168,200
RT 164,10,4096
RT 166,10,6144
MA 52,168,204
MA 60,172,204
RT 168,11,4096
RT 170,11,6144
MA 56,172,200
WL 6
s_nop 0
MA 64,144,176
RT 172,12,4096
RT 174,12,6144
MA 68,144,180
buffer_load_dwordx4 a[12:15], v21, s[20:23], s35 offen offset:3072 sc1
MA 76,148,180
RT 144,9,8192
RT 146,9,10240
MA 72,148,176
MA 80,152,176
RT 148,10,8192
RT 150,10,10240
MA 84,152,180
MA 92,156,180
RT 152,11,8192
RT 154,11,10240
MA 88,156,176
WL 6
s_nop 0
MA 64,160,184
RT 156,12,8192
RT 158,12,10240
MA 68,160,188
s_add_u32 s35, s49, 4096
MA 76,164,188
RT 160,9,12288
RT 162,9,14336
MA 72,164,184
MA 80,168,184
RT 164,10,12288
RT 166,10,14336
MA 84,168,188
buffer_load_dwordx4 a[16:19], v21, s[20:23], s35 offen offset:0 sc1
MA 92,172,188
RT 168,11,12288
RT 170,11,14336
MA 88,172,184
WL 6
s_nop 0
MA 64,144,192
RT 172,12,12288
RT 174,12,14336
MA 68,144,196
s_waitcnt vmcnt(20)
s_waitcnt vmcnt(31)
s_barrier
v_mov_b32 v28, s97
buffer_store_dword v28, v24, s[20:23], s63 offen offset:32 sc1
MA 76,148,196
RT 144,144,16384
RT 146,144,17408
MA 72,148,192
buffer_load_dwordx4 a[20:23], v21, s[20:23], s35 offen offset:1024 sc1
MA 80,152,192
RT 148,145,16384
RT 150,145,17408
MA 84,152,196
s_add_u32 m0, s37, 131072
s_add_u32 s36, s55, 147456
MA 92,156,196
RT 152,144,18432
RT 154,144,19456
MA 88,156,192
WL 6
s_nop 0
MA 64,160,200
RT 156,145,18432
RT 158,145,19456
MA 68,160,204
buffer_load_dwordx4 a[24:27], v21, s[20:23], s35 offen offset:2048 sc1
MA 76,164,204
RT 160,144,20480
RT 162,144,21504
MA 72,164,200
buffer_load_dwordx4 v5, s[16:19], s36 offen offset:0  lds
MA 80,168,200
RT 164,145,20480
RT 166,145,21504
MA 84,168,204
MA 92,172,204
RT 168,144,22528
RT 170,144,23552
MA 88,172,200
WL 6
s_nop 0
v_mfma_f32_16x16x32_bf16 v[96:99], a[144:147], v[160:163], 0
RT 172,145,22528
RT 174,145,23552
v_mfma_f32_16x16x32_bf16 v[100:103], a[144:147], v[164:167], 0
buffer_load_dwordx4 a[28:31], v21, s[20:23], s35 offen offset:3072 sc1
v_mfma_f32_16x16x32_bf16 v[108:111], a[148:151], v[164:167], 0
RT 144,144,24576
RT 146,144,25600
v_mfma_f32_16x16x32_bf16 v[104:107], a[148:151], v[160:163], 0
buffer_load_dwordx4 v6, s[16:19], s36 offen offset:1024  lds
MV 96,152,168
RT 148,145,24576
RT 150,145,25600
MV 100,152,172
s_add_u32 s35, s49, 8192
MV 108,156,172
RT 152,144,26624
RT 154,144,27648
MV 104,156,168
WL 6
s_nop 0
MV 96,160,176
RT 156,145,26624
RT 158,145,27648
MV 100,160,180
buffer_load_dwordx4 v7, s[16:19], s36 offen offset:2048  lds
MV 108,164,180
RT 160,144,28672
RT 162,144,29696
MV 104,164,176
buffer_load_dwordx4 a[32:35], v21, s[20:23], s35 offen offset:0 sc1
MV 96,168,184
RT 164,145,28672
RT 166,145,29696
MV 100,168,188
buffer_load_dwordx4 v8, s[16:19], s36 offen offset:3072  lds
MV 108,172,188
RT 168,144,30720
RT 170,144,31744
MV 104,172,184
WL 6
s_nop 0
s_add_u32 m0, s50, 147456
s_add_u32 s36, s57, 147456
MV 96,144,192
RT 172,145,30720
RT 174,145,31744
MV 100,144,196
buffer_load_dwordx4 a[36:39], v21, s[20:23], s35 offen offset:1024 sc1
MV 108,148,196
RT 144,144,32768
RT 146,144,33792
MV 104,148,192
buffer_load_dwordx4 v25, s[16:19], s36 offen offset:0  lds
MV 96,152,200
RT 148,145,32768
RT 150,145,33792
MV 100,152,204
MV 108,156,204
RT 152,144,34816
RT 154,144,35840
MV 104,156,200
WL 6
s_nop 0
MV 96,160,208
RT 156,145,34816
RT 158,145,35840
MV 100,160,212
buffer_load_dwordx4 a[40:43], v21, s[20:23], s35 offen offset:2048 sc1
MV 108,164,212
RT 160,144,36864
RT 162,144,37888
MV 104,164,208
buffer_load_dwordx4 v22, s[16:19], s36 offen offset:1024  lds
MV 96,168,216
RT 164,145,36864
RT 166,145,37888
MV 100,168,220
buffer_load_dwordx4 a[44:47], v21, s[20:23], s35 offen offset:3072 sc1
MV 108,172,220
RT 168,144,38912
RT 170,144,39936
MV 104,172,216
WL 6
s_add_u32 m0, s50, 155648
s_add_u32 s36, s58, 0
MV 96,144,224
RT 172,145,38912
RT 174,145,39936
MV 100,144,228
buffer_load_dwordx4 v25, s[16:19], s36 offen offset:0  lds
MV 108,148,228
RT 144,144,40960
RT 146,144,41984
MV 104,148,224
s_add_u32 s35, s49, 12288
MV 96,152,232
RT 148,145,40960
RT 150,145,41984
MV 100,152,236
MV 108,156,236
RT 152,144,43008
RT 154,144,44032
MV 104,156,232
WL 6
s_nop 0
MV 96,160,240
RT 156,145,43008
RT 158,145,44032
MV 100,160,244
buffer_load_dwordx4 a[48:51], v21, s[20:23], s35 offen offset:0 sc1
MV 108,164,244
RT 160,144,45056
RT 162,144,46080
MV 104,164,240
buffer_load_dwordx4 v22, s[16:19], s36 offen offset:1024  lds
MV 96,168,248
RT 164,145,45056
RT 166,145,46080
MV 100,168,252
s_mov_b32 s12, s61
s_nop 0
s_and_b32 s13, s62, 0xffff
MV 108,172,252
RT 168,144,47104
RT 170,144,48128
MV 104,172,248
WL 6
s_nop 0
s_mov_b32 s14, 0x240000
MA 96,144,176
RT 172,145,47104
RT 174,145,48128
MA 100,144,180
s_waitcnt vmcnt(42)
s_waitcnt vmcnt(34)
s_barrier
s_nop 0
MA 108,148,180
RT 144,9,49152
RT 146,9,51200
MA 104,148,176
buffer_load_dwordx4 a[52:55], v21, s[20:23], s35 offen offset:1024 sc1
MA 96,152,184
RT 148,10,49152
RT 150,10,51200
MA 100,152,188
buffer_load_dwordx4 a[56:59], v21, s[20:23], s35 offen offset:2048 sc1
MA 108,156,188
RT 152,11,49152
RT 154,11,51200
MA 104,156,184
WL 6
s_add_u32 m0, s50, 0
s_add_u32 s36, s58, 147456
MA 96,160,192
RT 156,12,49152
RT 158,12,51200
MA 100,160,196
s_getpc_b64 s[6:7]
s_nop 0
s_load_dword s5, s[6:7], s101
MA 108,164,196
RT 160,9,53248
RT 162,9,55296
MA 104,164,192
buffer_load_dwordx4 a[60:63], v21, s[20:23], s35 offen offset:3072 sc1
MA 96,168,200
RT 164,10,53248
RT 166,10,55296
MA 100,168,204
buffer_load_dwordx4 v25, s[16:19], s36 offen offset:0  lds
MA 108,172,204
RT 168,11,53248
RT 170,11,55296
MA 104,172,200
WL 6
s_nop 0
s_mov_b32 s15, 0x20000
MA 32,144,208
RT 172,12,53248
RT 174,12,55296
MA 36,144,212
buffer_load_dwordx4 v22, s[16:19], s36 offen offset:1024  lds
MA 44,148,212
RT 144,9,57344
RT 146,9,59392
MA 40,148,208
s_add_u32 m0, s37, 16384
s_add_u32 s36, s45, 295168
MA 48,152,208
RT 148,10,57344
RT 150,10,59392
MA 52,152,212
buffer_load_dwordx4 v5, s[16:19], s36 offen offset:0  lds
MA 60,156,212
RT 152,11,57344
RT 154,11,59392
MA 56,156,208
WL 6
s_mul_i32 s95, s33, 3
MA 32,160,216
RT 156,12,57344
RT 158,12,59392
MA 36,160,220
s_add_u32 s95, s95, s42
s_lshl_b32 s64, s95, 7
MA 44,164,220
RT 160,9,61440
RT 162,9,63488
MA 40,164,216
buffer_load_dwordx4 v6, s[16:19], s36 offen offset:1024  lds
MA 48,168,216
RT 164,10,61440
RT 166,10,63488
MA 52,168,220
buffer_load_dword v28, v23, s[20:23], s52 offen sc1
MA 60,172,220
RT 168,11,61440
RT 170,11,63488
MA 56,172,216
WL 6
s_nop 0
s_add_u32 s64, s64, 0x2782400
MA 32,144,224
RT 172,12,61440
RT 174,12,63488
MA 36,144,228
buffer_load_dwordx4 v7, s[16:19], s36 offen offset:2048  lds
MA 44,148,228
RT 144,13,0
RT 146,13,2048
MA 40,148,224
s_lshl_b32 s65, s43, 2
s_add_u32 s65, s65, s64
MA 48,152,224
RT 148,14,0
RT 150,14,2048
MA 52,152,228
s_lshr_b32 s95, s43, 1
s_lshl_b32 s96, s95, 11
MA 60,156,228
RT 152,15,0
RT 154,15,2048
MA 56,156,224
WL 6
s_add_u32 s66, s39, s96
MA 32,160,232
RT 156,16,0
RT 158,16,2048
MA 36,160,236
buffer_load_dwordx4 v8, s[16:19], s36 offen offset:3072  lds
MA 44,164,236
RT 160,13,4096
RT 162,13,6144
MA 40,164,232
s_add_u32 s66, s66, 8192
s_and_b32 s96, s43, 1
s_nop 0
MA 48,168,232
RT 164,14,4096
RT 166,14,6144
MA 52,168,236
s_lshl_b32 s76, s96, 7
s_add_u32 s66, s66, s76
MA 60,172,236
RT 168,15,4096
RT 170,15,6144
MA 56,172,232
WL 6
s_lshl_b32 s95, s95, 12
MA 64,144,208
RT 172,16,4096
RT 174,16,6144
MA 68,144,212
s_lshl_b32 s96, s96, 10
s_add_u32 s95, s95, s96
MA 76,148,212
RT 144,13,8192
RT 146,13,10240
MA 72,148,208
s_add_u32 s76, s95, s39
s_add_u32 s96, s43, 1
MA 80,152,208
RT 148,14,8192
RT 150,14,10240
MA 84,152,212
s_and_b32 s96, s96, 3
s_nop 0
s_mul_i32 s96, s96, 2359296
MA 92,156,212
RT 152,15,8192
RT 154,15,10240
MA 88,156,208
WL 6
s_add_u32 s72, s76, s96
MA 64,160,216
RT 156,16,8192
RT 158,16,10240
MA 68,160,220
s_add_u32 s96, s43, 2
s_and_b32 s96, s96, 3
MA 76,164,220
RT 160,13,12288
RT 162,13,14336
MA 72,164,216
s_mul_i32 s96, s96, 2359296
s_add_u32 s73, s76, s96
s_add_u32 s96, s43, 3
MA 80,168,216
RT 164,14,12288
RT 166,14,14336
MA 84,168,220
s_and_b32 s96, s96, 3
s_mul_i32 s96, s96, 2359296
s_add_u32 s74, s76, s96
MA 92,172,220
RT 168,15,12288
RT 170,15,14336
MA 88,172,216
WL 6
v_and_b32 v150, 0x37, v0
v_lshlrev_b32_e64 v150, 4, v150
MA 64,144,224
RT 172,16,12288
RT 174,16,14336
MA 68,144,228
s_waitcnt vmcnt(22)
s_waitcnt vmcnt(36)
s_barrier
s_nop 0
MA 76,148,228
RT 144,13,16384
RT 146,13,18432
MA 72,148,224
s_add_u32 m0, s37, 32768
s_add_u32 s36, s54, 294912
MA 80,152,224
RT 148,14,16384
RT 150,14,18432
MA 84,152,228
buffer_load_dwordx4 v5, s[16:19], s36 offen offset:0  lds
MA 92,156,228
RT 152,15,16384
RT 154,15,18432
MA 88,156,224
WL 6
s_nop 0
v_bfe_u32 v155, v0, 3, 1
v_lshl_add_u32 v150, v155, 10, v150
MA 64,160,232
RT 156,16,16384
RT 158,16,18432
MA 68,160,236
buffer_load_dwordx4 v6, s[16:19], s36 offen offset:1024  lds
MA 76,164,236
RT 160,13,20480
RT 162,13,22528
MA 72,164,232
s_mul_i32 s67, s42, 384
s_add_u32 s67, s67, s4
s_lshl_b32 s96, s43, 6
MA 80,168,232
RT 164,14,20480
RT 166,14,22528
MA 84,168,236
buffer_load_dwordx4 v7, s[16:19], s36 offen offset:2048  lds
MA 92,172,236
RT 168,15,20480
RT 170,15,22528
MA 88,172,232
WL 6
s_add_u32 s75, s67, s96
s_add_u32 s77, s75, 18432
MA 32,144,0
RT 172,16,20480
RT 174,16,22528
MA 36,144,4
buffer_load_dwordx4 v8, s[16:19], s36 offen offset:3072  lds
MA 44,148,4
RT 144,13,24576
RT 146,13,26624
MA 40,148,0
s_add_u32 m0, s37, 49152
s_add_u32 s36, s46, 295168
MA 48,152,0
RT 148,14,24576
RT 150,14,26624
MA 52,152,4
buffer_load_dwordx4 v5, s[16:19], s36 offen offset:0  lds
MA 60,156,4
RT 152,15,24576
RT 154,15,26624
MA 56,156,0
WL 6
v_bfe_u32 v156, v0, 4, 1
v_lshlrev_b32 v156, 5, v156
MA 32,160,8
RT 156,16,24576
RT 158,16,26624
MA 36,160,12
v_lshrrev_b32_e64 v157, 5, v0
v_lshl_add_u32 v156, v157, 4, v156
s_lshl_b32 s95, s43, 3
s_nop 0
MA 44,164,12
RT 160,13,28672
RT 162,13,30720
MA 40,164,8
buffer_load_dwordx4 v6, s[16:19], s36 offen offset:1024  lds
MA 48,168,8
RT 164,14,28672
RT 166,14,30720
MA 52,168,12
v_and_b32 v151, 7, v0
v_add_u32 v151, s95, v151
v_lshlrev_b32_e64 v153, 2, v151
MA 60,172,12
RT 168,15,28672
RT 170,15,30720
MA 56,172,8
WL 6
s_nop 0
v_mul_u32_u24 v151, 1152, v151
v_lshl_add_u32 v151, v155, 6, v151
MA 32,144,16
RT 172,16,28672
RT 174,16,30720
MA 36,144,20
buffer_load_dwordx4 v7, s[16:19], s36 offen offset:2048  lds
MA 44,148,20
RT 144,13,32768
RT 146,13,34816
MA 40,148,16
v_add_u32 v151, v151, v156
v_and_b32 v152, 15, v0
v_lshlrev_b32_e64 v154, 2, v152
MA 48,152,16
RT 148,14,32768
RT 150,14,34816
MA 52,152,20
v_mul_u32_u24 v152, 1152, v152
v_add_u32 v152, v152, v156
s_lshl_b32 s96, s33, 2
MA 60,156,20
RT 152,15,32768
RT 154,15,34816
MA 56,156,16
WL 6
s_add_u32 s96, s96, s43
s_lshl_b32 s96, s96, 2
s_nop 0
MA 32,160,24
RT 156,16,32768
RT 158,16,34816
MA 36,160,28
buffer_load_dwordx4 v8, s[16:19], s36 offen offset:3072  lds
MA 44,164,28
RT 160,13,36864
RT 162,13,38912
MA 40,164,24
s_add_u32 s96, s96, s32
s_lshl_b32 s68, s96, 7
s_add_u32 s68, s68, 0x2500000
MA 48,168,24
RT 164,14,36864
RT 166,14,38912
MA 52,168,28
s_mov_b32 s70, 0x3f80
s_mov_b32 s71, 0x3f800000
s_nop 0
MA 60,172,28
RT 168,15,36864
RT 170,15,38912
MA 56,172,24
WL 6
s_nop 0
MA 64,144,0
RT 172,16,36864
RT 174,16,38912
MA 68,144,4
MA 76,148,4
RT 144,13,40960
RT 146,13,43008
MA 72,148,0
MA 80,152,0
RT 148,14,40960
RT 150,14,43008
MA 84,152,4
MA 92,156,4
RT 152,15,40960
RT 154,15,43008
MA 88,156,0
WL 6
s_nop 0
MA 64,160,8
RT 156,16,40960
RT 158,16,43008
MA 68,160,12
MA 76,164,12
RT 160,13,45056
RT 162,13,47104
MA 72,164,8
MA 80,168,8
RT 164,14,45056
RT 166,14,47104
MA 84,168,12
MA 92,172,12
RT 168,15,45056
RT 170,15,47104
MA 88,172,8
WL 6
s_nop 0
MA 64,144,16
RT 172,16,45056
RT 174,16,47104
MA 68,144,20
s_cmp_lg_u32 s32, 0
s_cbranch_scc1 L_polld_11
s_mov_b32 s89, 0x20000
s_waitcnt vmcnt(10)
s_branch L_pollc_12
L_poll_10:
buffer_load_dword v28, v23, s[20:23], s52 offen sc1
s_waitcnt vmcnt(0)
L_pollc_12:
v_cmp_eq_u32 s[98:99], s97, v28
s_sub_u32 s89, s89, 1
s_and_b32 s98, s98, 0x700
s_cmp_eq_u32 s98, 0x700
s_cbranch_scc1 L_polld_11
s_sleep 4
s_cmp_lg_u32 s89, 0
s_cbranch_scc1 L_poll_10
L_polld_11:
s_waitcnt vmcnt(15)
s_waitcnt vmcnt(26)
s_barrier
s_nop 0
MA 76,148,20
RT 144,13,49152
RT 146,13,51200
MA 72,148,16
s_add_u32 s35, s48, 16384
MA 80,152,16
RT 148,14,49152
RT 150,14,51200
MA 84,152,20
s_add_u32 m0, s37, 65536
s_add_u32 s36, s55, 294912
MA 92,156,20
RT 152,15,49152
RT 154,15,51200
MA 88,156,16
WL 6
s_nop 0
MA 64,160,24
RT 156,16,49152
RT 158,16,51200
MA 68,160,28
buffer_load_dwordx4 a[96:99], v21, s[20:23], s35 offen offset:0 sc1
MA 76,164,28
RT 160,13,53248
RT 162,13,55296
MA 72,164,24
buffer_load_dwordx4 a[100:103], v21, s[20:23], s35 offen offset:1024 sc1
MA 80,168,24
RT 164,14,53248
RT 166,14,55296
MA 84,168,28
buffer_load_dwordx4 v5, s[16:19], s36 offen offset:0  lds
MA 92,172,28
RT 168,15,53248
RT 170,15,55296
MA 88,172,24
WL 6
s_nop 0
MA 32,144,32
RT 172,16,53248
RT 174,16,55296
MA 36,144,36
buffer_load_dwordx4 a[104:107], v21, s[20:23], s35 offen offset:2048 sc1
MA 44,148,36
RT 144,13,57344
RT 146,13,59392
MA 40,148,32
buffer_load_dwordx4 a[108:111], v21, s[20:23], s35 offen offset:3072 sc1
MA 48,152,32
RT 148,14,57344
RT 150,14,59392
MA 52,152,36
buffer_load_dwordx4 v6, s[16:19], s36 offen offset:1024  lds
MA 60,156,36
RT 152,15,57344
RT 154,15,59392
MA 56,156,32
WL 6
s_nop 0
MA 32,160,40
RT 156,16,57344
RT 158,16,59392
MA 36,160,44
s_add_u32 s35, s48, 20480
MA 44,164,44
RT 160,13,61440
RT 162,13,63488
MA 40,164,40
buffer_load_dwordx4 a[112:115], v21, s[20:23], s35 offen offset:0 sc1
MA 48,168,40
RT 164,14,61440
RT 166,14,63488
MA 52,168,44
buffer_load_dwordx4 v7, s[16:19], s36 offen offset:2048  lds
MA 60,172,44
RT 168,15,61440
RT 170,15,63488
MA 56,172,40
WL 6
s_nop 0
MA 32,144,48
RT 172,16,61440
RT 174,16,63488
MA 36,144,52
buffer_load_dwordx4 a[116:119], v21, s[20:23], s35 offen offset:1024 sc1
MA 44,148,52
RT 144,17,0
RT 146,17,2048
MA 40,148,48
buffer_load_dwordx4 a[120:123], v21, s[20:23], s35 offen offset:2048 sc1
MA 48,152,48
RT 148,18,0
RT 150,18,2048
MA 52,152,52
buffer_load_dwordx4 v8, s[16:19], s36 offen offset:3072  lds
MA 60,156,52
RT 152,19,0
RT 154,19,2048
MA 56,156,48
WL 6
s_add_u32 m0, s37, 81920
s_nop 0
MA 32,160,56
RT 156,20,0
RT 158,20,2048
MA 36,160,60
buffer_load_dwordx4 a[124:127], v21, s[20:23], s35 offen offset:3072 sc1
MA 44,164,60
RT 160,17,4096
RT 162,17,6144
MA 40,164,56
buffer_load_dwordx4 v1, s[28:31], s78 offen  lds
MA 48,168,56
RT 164,18,4096
RT 166,18,6144
MA 52,168,60
s_add_u32 m0, s37, 82944
s_nop 0
s_nop 0
MA 60,172,60
RT 168,19,4096
RT 170,19,6144
MA 56,172,56
WL 6
s_nop 0
MA 64,144,32
RT 172,20,4096
RT 174,20,6144
MA 68,144,36
buffer_load_dwordx4 v1, s[28:31], s79 offen  lds
MA 76,148,36
RT 144,17,8192
RT 146,17,10240
MA 72,148,32
s_add_u32 m0, s37, 83968
s_nop 0
s_nop 0
MA 80,152,32
RT 148,18,8192
RT 150,18,10240
MA 84,152,36
MA 92,156,36
RT 152,19,8192
RT 154,19,10240
MA 88,156,32
WL 6
s_nop 0
MA 64,160,40
RT 156,20,8192
RT 158,20,10240
MA 68,160,44
buffer_load_dwordx4 v1, s[28:31], s80 offen  lds
MA 76,164,44
RT 160,17,12288
RT 162,17,14336
MA 72,164,40
s_add_u32 m0, s37, 84992
s_nop 0
s_nop 0
MA 80,168,40
RT 164,18,12288
RT 166,18,14336
MA 84,168,44
MA 92,172,44
RT 168,19,12288
RT 170,19,14336
MA 88,172,40
WL 6
s_nop 0
MA 64,144,48
RT 172,20,12288
RT 174,20,14336
MA 68,144,52
s_waitcnt vmcnt(28)
s_barrier
MA 76,148,52
RT 144,148,16384
RT 146,148,17408
MA 72,148,48
buffer_load_dwordx4 v1, s[28:31], s81 offen  lds
MA 80,152,48
RT 148,149,16384
RT 150,149,17408
MA 84,152,52
s_add_u32 m0, s84, 98304
s_nop 0
s_nop 0
MA 92,156,52
RT 152,148,18432
RT 154,148,19456
MA 88,156,48
WL 6
s_nop 0
MA 64,160,56
RT 156,149,18432
RT 158,149,19456
MA 68,160,60
buffer_load_dwordx4 v1, s[28:31], s82 offen  lds
MA 76,164,60
RT 160,148,20480
RT 162,148,21504
MA 72,164,56
s_add_u32 m0, s50, 114688
s_add_u32 s36, s57, 294912
MA 80,168,56
RT 164,149,20480
RT 166,149,21504
MA 84,168,60
buffer_load_dwordx4 v25, s[16:19], s36 offen offset:0  lds
MA 92,172,60
RT 168,148,22528
RT 170,148,23552
MA 88,172,56
WL 6
s_nop 0
MA 96,144,208
RT 172,149,22528
RT 174,149,23552
MA 100,144,212
MA 108,148,212
RT 144,148,24576
RT 146,148,25600
MA 104,148,208
buffer_load_dwordx4 v22, s[16:19], s36 offen offset:1024  lds
MA 96,152,216
RT 148,149,24576
RT 150,149,25600
MA 100,152,220
s_add_u32 m0, s50, 122880
s_add_u32 s36, s58, 294912
MA 108,156,220
RT 152,148,26624
RT 154,148,27648
MA 104,156,216
WL 6
s_nop 0
MA 96,160,224
RT 156,149,26624
RT 158,149,27648
MA 100,160,228
buffer_load_dwordx4 v25, s[16:19], s36 offen offset:0  lds
MA 108,164,228
RT 160,148,28672
RT 162,148,29696
MA 104,164,224
MA 96,168,232
RT 164,149,28672
RT 166,149,29696
MA 100,168,236
s_add_u32 s35, s49, 16384
MA 108,172,236
RT 168,148,30720
RT 170,148,31744
MA 104,172,232
WL 6
s_nop 0
MA 96,144,0
RT 172,149,30720
RT 174,149,31744
MA 100,144,4
buffer_load_dwordx4 a[64:67], v21, s[20:23], s35 offen offset:0 sc1
MA 108,148,4
RT 144,144,0
RT 146,144,1024
MA 104,148,0
buffer_load_dwordx4 a[68:71], v21, s[20:23], s35 offen offset:1024 sc1
MA 96,152,8
RT 148,145,0
RT 150,145,1024
MA 100,152,12
buffer_load_dwordx4 a[72:75], v21, s[20:23], s35 offen offset:2048 sc1
MA 108,156,12
RT 152,144,2048
RT 154,144,3072
MA 104,156,8
WL 6
s_nop 0
MA 96,160,16
RT 156,145,2048
RT 158,145,3072
MA 100,160,20
buffer_load_dwordx4 a[76:79], v21, s[20:23], s35 offen offset:3072 sc1
MA 108,164,20
RT 160,144,4096
RT 162,144,5120
MA 104,164,16
s_add_u32 s35, s49, 20480
MA 96,168,24
RT 164,145,4096
RT 166,145,5120
MA 100,168,28
buffer_load_dwordx4 a[80:83], v21, s[20:23], s35 offen offset:0 sc1
MA 108,172,28
RT 168,144,6144
RT 170,144,7168
MA 104,172,24
WL 6
s_nop 0
MA 96,144,32
RT 172,145,6144
RT 174,145,7168
MA 100,144,36
s_waitcnt vmcnt(13)
s_waitcnt vmcnt(29)
s_barrier
s_nop 0
MA 108,148,36
RT 144,9,16384
RT 146,9,18432
MA 104,148,32
buffer_load_dwordx4 a[84:87], v21, s[20:23], s35 offen offset:1024 sc1
MA 96,152,40
RT 148,10,16384
RT 150,10,18432
MA 100,152,44
buffer_load_dwordx4 a[88:91], v21, s[20:23], s35 offen offset:2048 sc1
MA 108,156,44
RT 152,11,16384
RT 154,11,18432
MA 104,156,40
WL 6
s_nop 0
MA 96,160,48
RT 156,12,16384
RT 158,12,18432
MA 100,160,52
buffer_load_dwordx4 a[92:95], v21, s[20:23], s35 offen offset:3072 sc1
MA 108,164,52
RT 160,9,20480
RT 162,9,22528
MA 104,164,48
buffer_load_dword v28, v23, s[20:23], s52 offen sc1
MA 96,168,56
RT 164,10,20480
RT 166,10,22528
MA 100,168,60
buffer_load_dwordx4 v22, s[16:19], s36 offen offset:1024  lds
MA 108,172,60
RT 168,11,20480
RT 170,11,22528
MA 104,172,56
WL 6
s_add_u32 m0, s37, 131072
s_nop 0
MA 32,144,96
RT 172,12,20480
RT 174,12,22528
MA 36,144,100
buffer_load_dwordx4 v2, s[28:31], s78 offen  lds
MA 44,148,100
RT 144,9,24576
RT 146,9,26624
MA 40,148,96
s_getpc_b64 s[6:7]
s_nop 0
s_load_dword s5, s[6:7], s101
MA 48,152,96
RT 148,10,24576
RT 150,10,26624
MA 52,152,100
s_add_u32 m0, s37, 132096
s_nop 0
s_nop 0
MA 60,156,100
RT 152,11,24576
RT 154,11,26624
MA 56,156,96
WL 6
s_nop 0
MA 32,160,104
RT 156,12,24576
RT 158,12,26624
MA 36,160,108
buffer_load_dwordx4 v2, s[28:31], s79 offen  lds
MA 44,164,108
RT 160,9,28672
RT 162,9,30720
MA 40,164,104
s_add_u32 m0, s37, 133120
s_nop 0
s_nop 0
MA 48,168,104
RT 164,10,28672
RT 166,10,30720
MA 52,168,108
MA 60,172,108
RT 168,11,28672
RT 170,11,30720
MA 56,172,104
WL 6
s_nop 0
MA 32,144,112
RT 172,12,28672
RT 174,12,30720
MA 36,144,116
buffer_load_dwordx4 v2, s[28:31], s80 offen  lds
MA 44,148,116
RT 144,9,32768
RT 146,9,34816
MA 40,148,112
s_add_u32 m0, s37, 134144
s_nop 0
s_nop 0
MA 48,152,112
RT 148,10,32768
RT 150,10,34816
MA 52,152,116
MA 60,156,116
RT 152,11,32768
RT 154,11,34816
MA 56,156,112
WL 6
s_nop 0
MA 32,160,120
RT 156,12,32768
RT 158,12,34816
MA 36,160,124
buffer_load_dwordx4 v2, s[28:31], s81 offen  lds
MA 44,164,124
RT 160,9,36864
RT 162,9,38912
MA 40,164,120
s_add_u32 m0, s84, 147456
s_nop 0
s_nop 0
MA 48,168,120
RT 164,10,36864
RT 166,10,38912
MA 52,168,124
MA 60,172,124
RT 168,11,36864
RT 170,11,38912
MA 56,172,120
WL 6
s_nop 0
MA 64,144,96
RT 172,12,36864
RT 174,12,38912
MA 68,144,100
buffer_load_dwordx4 v2, s[28:31], s82 offen  lds
MA 76,148,100
RT 144,9,40960
RT 146,9,43008
MA 72,148,96
MA 80,152,96
RT 148,10,40960
RT 150,10,43008
MA 84,152,100
MA 92,156,100
RT 152,11,40960
RT 154,11,43008
MA 88,156,96
WL 6
s_nop 0
MA 64,160,104
RT 156,12,40960
RT 158,12,43008
MA 68,160,108
MA 76,164,108
RT 160,9,45056
RT 162,9,47104
MA 72,164,104
MA 80,168,104
RT 164,10,45056
RT 166,10,47104
MA 84,168,108
MA 92,172,108
RT 168,11,45056
RT 170,11,47104
MA 88,172,104
WL 6
s_nop 0
MA 64,144,112
RT 172,12,45056
RT 174,12,47104
MA 68,144,116
s_waitcnt vmcnt(7)
s_cmp_lg_u32 s32, 0
s_cbranch_scc1 L_polld_14
s_mov_b32 s89, 0x20000
s_waitcnt vmcnt(6)
s_branch L_pollc_15
L_poll_13:
buffer_load_dword v28, v23, s[20:23], s52 offen sc1
s_waitcnt vmcnt(0)
L_pollc_15:
v_cmp_eq_u32 s[98:99], s97, v28
s_sub_u32 s89, s89, 1
s_and_b32 s98, s98, 0x1000
s_cmp_eq_u32 s98, 0x1000
s_cbranch_scc1 L_polld_14
s_sleep 4
s_cmp_lg_u32 s89, 0
s_cbranch_scc1 L_poll_13
L_polld_14:
s_waitcnt vmcnt(24)
s_barrier
s_nop 0
MA 76,148,116
RT 144,9,49152
RT 146,9,51200
MA 72,148,112
s_add_u32 s35, s83, 0
s_nop 0
MA 80,152,112
RT 148,10,49152
RT 150,10,51200
MA 84,152,116
buffer_load_dwordx4 a[128:131], v21, s[20:23], s35 offen offset:0 sc1
MA 92,156,116
RT 152,11,49152
RT 154,11,51200
MA 88,156,112
WL 6
s_add_u32 m0, s37, 0
s_nop 0
s_nop 0
MA 64,160,120
RT 156,12,49152
RT 158,12,51200
MA 68,160,124
buffer_load_dwordx4 a[132:135], v21, s[20:23], s35 offen offset:1024 sc1
MA 76,164,124
RT 160,9,53248
RT 162,9,55296
MA 72,164,120
buffer_load_dwordx4 a[136:139], v21, s[20:23], s35 offen offset:2048 sc1
MA 80,168,120
RT 164,10,53248
RT 166,10,55296
MA 84,168,124
buffer_load_dwordx4 a[140:143], v21, s[20:23], s35 offen offset:3072 sc1
MA 92,172,124
RT 168,11,53248
RT 170,11,55296
MA 88,172,120
WL 6
s_nop 0
MA 32,144,64
RT 172,12,53248
RT 174,12,55296
MA 36,144,68
s_add_u32 s35, s83, 4096
MA 44,148,68
RT 144,9,57344
RT 146,9,59392
MA 40,148,64
buffer_load_dwordx4 a[240:243], v21, s[20:23], s35 offen offset:0 sc1
MA 48,152,64
RT 148,10,57344
RT 150,10,59392
MA 52,152,68
buffer_load_dwordx4 a[244:247], v21, s[20:23], s35 offen offset:1024 sc1
MA 60,156,68
RT 152,11,57344
RT 154,11,59392
MA 56,156,64
WL 6
s_nop 0
MA 32,160,72
RT 156,12,57344
RT 158,12,59392
MA 36,160,76
buffer_load_dwordx4 a[248:251], v21, s[20:23], s35 offen offset:2048 sc1
MA 44,164,76
RT 160,9,61440
RT 162,9,63488
MA 40,164,72
buffer_load_dwordx4 a[252:255], v21, s[20:23], s35 offen offset:3072 sc1
MA 48,168,72
RT 164,10,61440
RT 166,10,63488
MA 52,168,76
s_add_u32 s35, s83, 8192
MA 60,172,76
RT 168,11,61440
RT 170,11,63488
MA 56,172,72
WL 6
s_nop 0
MA 32,144,80
RT 172,12,61440
RT 174,12,63488
MA 36,144,84
buffer_load_dwordx4 v[136:139], v21, s[20:23], s35 offen offset:0 sc1
MA 44,148,84
RT 144,13,0
RT 146,13,2048
MA 40,148,80
buffer_load_dwordx4 v[140:143], v21, s[20:23], s35 offen offset:1024 sc1
MA 48,152,80
RT 148,14,0
RT 150,14,2048
MA 52,152,84
buffer_load_dword v155, v154, s[20:23], s68 offen offset:0 sc1
MA 60,156,84
RT 152,15,0
RT 154,15,2048
MA 56,156,80
WL 6
s_nop 0
MA 32,160,88
RT 156,16,0
RT 158,16,2048
MA 36,160,92
buffer_load_dword v156, v154, s[20:23], s68 offen offset:64 sc1
MA 44,164,92
RT 160,13,4096
RT 162,13,6144
MA 40,164,88
buffer_load_dword v157, v153, s[20:23], s68 offen offset:0 sc1
MA 48,168,88
RT 164,14,4096
RT 166,14,6144
MA 52,168,92
buffer_load_dwordx4 v3, s[28:31], s78 offen  lds
MA 60,172,92
RT 168,15,4096
RT 170,15,6144
MA 56,172,88
WL 6
s_add_u32 m0, s37, 1024
s_nop 0
MA 64,144,64
RT 172,16,4096
RT 174,16,6144
MA 68,144,68
buffer_load_dwordx4 v3, s[28:31], s79 offen  lds
MA 76,148,68
RT 144,13,8192
RT 146,13,10240
MA 72,148,64
s_add_u32 m0, s37, 2048
s_nop 0
s_nop 0
MA 80,152,64
RT 148,14,8192
RT 150,14,10240
MA 84,152,68
MA 92,156,68
RT 152,15,8192
RT 154,15,10240
MA 88,156,64
WL 6
s_nop 0
MA 64,160,72
RT 156,16,8192
RT 158,16,10240
MA 68,160,76
buffer_load_dwordx4 v3, s[28:31], s80 offen  lds
MA 76,164,76
RT 160,13,12288
RT 162,13,14336
MA 72,164,72
s_add_u32 m0, s37, 3072
s_nop 0
s_nop 0
MA 80,168,72
RT 164,14,12288
RT 166,14,14336
MA 84,168,76
MA 92,172,76
RT 168,15,12288
RT 170,15,14336
MA 88,172,72
WL 6
s_nop 0
MA 64,144,80
RT 172,16,12288
RT 174,16,14336
MA 68,144,84
s_waitcnt vmcnt(6)
s_waitcnt vmcnt(21)
s_barrier
s_nop 0
MA 76,148,84
RT 144,13,16384
RT 146,13,18432
MA 72,148,80
buffer_load_dwordx4 v3, s[28:31], s81 offen  lds
MA 80,152,80
RT 148,14,16384
RT 150,14,18432
MA 84,152,84
s_add_u32 m0, s84, 16384
s_nop 0
s_nop 0
MA 92,156,84
RT 152,15,16384
RT 154,15,18432
MA 88,156,80
WL 6
s_nop 0
MA 64,160,88
RT 156,16,16384
RT 158,16,18432
MA 68,160,92
buffer_load_dwordx4 v3, s[28:31], s82 offen  lds
MA 76,164,92
RT 160,13,20480
RT 162,13,22528
MA 72,164,88
s_add_u32 m0, s50, 32768
s_add_u32 s36, s86, 0
s_nop 0
MA 80,168,88
RT 164,14,20480
RT 166,14,22528
MA 84,168,92
buffer_load_dwordx4 v25, s[16:19], s36 offen offset:0  lds
MA 92,172,92
RT 168,15,20480
RT 170,15,22528
MA 88,172,88
WL 6
s_nop 0
MA 32,144,128
RT 172,16,20480
RT 174,16,22528
MA 36,144,132
buffer_load_dwordx4 v22, s[16:19], s36 offen offset:1024  lds
MA 44,148,132
RT 144,13,24576
RT 146,13,26624
MA 40,148,128
s_add_u32 m0, s50, 40960
s_add_u32 s36, s86, 147456
MA 48,152,128
RT 148,14,24576
RT 150,14,26624
MA 52,152,132
buffer_load_dwordx4 v25, s[16:19], s36 offen offset:0  lds
MA 60,156,132
RT 152,15,24576
RT 154,15,26624
MA 56,156,128
WL 6
s_nop 0
MA 32,160,136
RT 156,16,24576
RT 158,16,26624
MA 36,160,140
buffer_load_dwordx4 v22, s[16:19], s36 offen offset:1024  lds
MA 44,164,140
RT 160,13,28672
RT 162,13,30720
MA 40,164,136
s_add_u32 m0, s50, 49152
s_add_u32 s36, s86, 294912
MA 48,168,136
RT 164,14,28672
RT 166,14,30720
MA 52,168,140
buffer_load_dwordx4 v25, s[16:19], s36 offen offset:0  lds
MA 60,172,140
RT 168,15,28672
RT 170,15,30720
MA 56,172,136
WL 6
s_nop 0
MA 32,144,240
RT 172,16,28672
RT 174,16,30720
MA 36,144,244
MA 44,148,244
RT 144,13,32768
RT 146,13,34816
MA 40,148,240
buffer_load_dwordx4 v22, s[16:19], s36 offen offset:1024  lds
MA 48,152,240
RT 148,14,32768
RT 150,14,34816
MA 52,152,244
s_add_u32 m0, s50, 57344
s_add_u32 s36, s87, 0
s_nop 0
MA 60,156,244
RT 152,15,32768
RT 154,15,34816
MA 56,156,240
WL 6
s_nop 0
MA 32,160,248
RT 156,16,32768
RT 158,16,34816
MA 36,160,252
buffer_load_dwordx4 v25, s[16:19], s36 offen offset:0  lds
MA 44,164,252
RT 160,146,49152
RT 162,146,50176
MA 40,164,248
MA 48,168,248
RT 164,147,49152
RT 166,147,50176
MA 52,168,252
MA 60,172,252
RT 168,146,51200
RT 170,146,52224
MA 56,172,248
WL 6
s_nop 0
MV 32,144,136
RT 172,147,51200
RT 174,147,52224
MV 36,144,140
buffer_load_dwordx4 v22, s[16:19], s36 offen offset:1024  lds
MV 44,148,140
RT 144,146,53248
RT 146,146,54272
MV 40,148,136
MV 48,152,136
RT 148,147,53248
RT 150,147,54272
MV 52,152,140
MV 60,156,140
RT 152,146,55296
RT 154,146,56320
MV 56,156,136
WL 6
s_nop 0
MA 96,160,96
RT 156,147,55296
RT 158,147,56320
MA 100,160,100
MA 108,164,100
RT 160,146,57344
RT 162,146,58368
MA 104,164,96
MA 96,168,104
RT 164,147,57344
RT 166,147,58368
MA 100,168,108
MA 108,172,108
RT 168,146,59392
RT 170,146,60416
MA 104,172,104
WL 6
s_nop 0
s_add_u32 s41, s40, 8192
MA 96,144,112
RT 172,147,59392
RT 174,147,60416
MA 100,144,116
CV 128,32,33
CV 129,34,35
MA 108,148,116
RT 144,146,61440
RT 146,146,62464
MA 104,148,112
CV 130,40,41
CV 131,42,43
MA 96,152,120
RT 148,147,61440
RT 150,147,62464
MA 100,152,124
buffer_store_dwordx4 v[128:131], v21, s[20:23], s41 offen offset:0 sc1
MA 108,156,124
RT 152,146,63488
RT 154,146,64512
MA 104,156,120
WL 6
s_nop 0
CV 132,48,49
MA 96,160,64
RT 156,147,63488
RT 158,147,64512
MA 100,160,68
s_waitcnt vmcnt(9)
s_barrier
MA 108,164,68
RT 160,17,0
RT 162,17,2048
MA 104,164,64
s_add_u32 m0, s50, 65536
s_add_u32 s36, s87, 147456
MA 96,168,72
RT 164,18,0
RT 166,18,2048
MA 100,168,76
buffer_load_dwordx4 v25, s[16:19], s36 offen offset:0  lds
MA 108,172,76
RT 168,19,0
RT 170,19,2048
MA 104,172,72
WL 6
s_nop 0
CV 133,50,51
MA 96,144,80
RT 172,20,0
RT 174,20,2048
MA 100,144,84
buffer_load_dwordx4 v22, s[16:19], s36 offen offset:1024  lds
MA 108,148,84
RT 144,17,4096
RT 146,17,6144
MA 104,148,80
s_add_u32 m0, s50, 73728
s_add_u32 s36, s88, 0
s_nop 0
MA 96,152,88
RT 148,18,4096
RT 150,18,6144
MA 100,152,92
buffer_load_dwordx4 v25, s[16:19], s36 offen offset:0  lds
MA 108,156,92
RT 152,19,4096
RT 154,19,6144
MA 104,156,88
WL 6
s_nop 0
CV 134,56,57
MA 64,160,128
RT 156,20,4096
RT 158,20,6144
MA 68,160,132
buffer_load_dwordx4 v22, s[16:19], s36 offen offset:1024  lds
MA 76,164,132
RT 160,17,8192
RT 162,17,10240
MA 72,164,128
s_add_u32 m0, s50, 81920
s_add_u32 s36, s88, 147456
MA 80,168,128
RT 164,18,8192
RT 166,18,10240
MA 84,168,132
buffer_load_dwordx4 v25, s[16:19], s36 offen offset:0  lds
MA 92,172,132
RT 168,19,8192
RT 170,19,10240
MA 88,172,128
WL 6
s_nop 0
CV 135,58,59
MA 64,144,136
RT 172,20,8192
RT 174,20,10240
MA 68,144,140
buffer_load_dwordx4 v22, s[16:19], s36 offen offset:1024  lds
MA 76,148,140
RT 144,17,12288
RT 146,17,14336
MA 72,148,136
s_add_u32 m0, s50, 90112
s_add_u32 s36, s87, 294912
MA 80,152,136
RT 148,18,12288
RT 150,18,14336
MA 84,152,140
buffer_load_dwordx4 v25, s[16:19], s36 offen offset:0  lds
MA 92,156,140
RT 152,19,12288
RT 154,19,14336
MA 88,156,136
WL 6
s_nop 0
MA 64,160,240
RT 156,20,12288
RT 158,20,14336
MA 68,160,244
buffer_store_dwordx4 v[132:135], v21, s[20:23], s41 offen offset:1024 sc1
MA 76,164,244
RT 160,17,16384
RT 162,17,18432
MA 72,164,240
buffer_load_dwordx4 v22, s[16:19], s36 offen offset:1024  lds
MA 80,168,240
RT 164,18,16384
RT 166,18,18432
MA 84,168,244
s_add_u32 m0, s50, 98304
s_add_u32 s36, s88, 294912
MA 92,172,244
RT 168,19,16384
RT 170,19,18432
MA 88,172,240
WL 6
s_nop 0
CV 128,36,37
MA 64,144,248
RT 172,20,16384
RT 174,20,18432
MA 68,144,252
buffer_load_dwordx4 v25, s[16:19], s36 offen offset:0  lds
MA 76,148,252
RT 144,9,0
RT 146,9,2048
MA 72,148,248
CV 129,38,39
CV 130,44,45
MA 80,152,248
RT 148,10,0
RT 150,10,2048
MA 84,152,252
CV 131,46,47
MA 92,156,252
RT 152,11,0
RT 154,11,2048
MA 88,156,248
WL 6
s_nop 0
MV 64,160,136
RT 156,12,0
RT 158,12,2048
MV 68,160,140
buffer_load_dwordx4 v22, s[16:19], s36 offen offset:1024  lds
MV 76,164,140
RT 160,9,4096
RT 162,9,6144
MV 72,164,136
buffer_store_dwordx4 v[128:131], v21, s[20:23], s41 offen offset:2048 sc1
MV 80,168,136
RT 164,10,4096
RT 166,10,6144
MV 84,168,140
CV 132,52,53
CV 133,54,55
CV 134,60,61
MV 92,172,140
RT 168,11,4096
RT 170,11,6144
MV 88,172,136
WL 6
s_nop 0
CV 135,62,63
MA 96,144,128
RT 172,12,4096
RT 174,12,6144
MA 100,144,132
buffer_store_dwordx4 v[132:135], v21, s[20:23], s41 offen offset:3072 sc1
MA 108,148,132
RT 144,9,8192
RT 146,9,10240
MA 104,148,128
v_mfma_f32_16x16x32_bf16 v[112:115], a[152:155], a[128:131], 0
RT 148,10,8192
RT 150,10,10240
v_mfma_f32_16x16x32_bf16 v[116:119], a[152:155], a[132:135], 0
v_mfma_f32_16x16x32_bf16 v[124:127], a[156:159], a[132:135], 0
RT 152,11,8192
RT 154,11,10240
v_mfma_f32_16x16x32_bf16 v[120:123], a[156:159], a[128:131], 0
WL 6
s_add_u32 s41, s51, 0
MA 96,160,136
RT 156,12,8192
RT 158,12,10240
MA 100,160,140
CV 128,64,65
CV 129,66,67
MA 108,164,140
RT 160,9,12288
RT 162,9,14336
MA 104,164,136
CV 130,72,73
CV 131,74,75
MA 112,168,136
RT 164,10,12288
RT 166,10,14336
MA 116,168,140
s_getpc_b64 s[6:7]
s_nop 0
s_load_dword s5, s[6:7], s101
MA 124,172,140
RT 168,11,12288
RT 170,11,14336
MA 120,172,136
WL 6
s_nop 0
MA 96,144,240
RT 172,12,12288
RT 174,12,14336
MA 100,144,244
buffer_store_dwordx4 v[128:131], v21, s[20:23], s41 offen offset:0 sc1
MA 108,148,244
RT 144,9,16384
RT 146,9,18432
MA 104,148,240
CV 132,80,81
CV 133,82,83
MA 112,152,240
RT 148,10,16384
RT 150,10,18432
MA 116,152,244
CV 134,88,89
CV 135,90,91
MA 124,156,244
RT 152,11,16384
RT 154,11,18432
MA 120,156,240
WL 6
s_nop 0
MA 96,160,248
RT 156,12,16384
RT 158,12,18432
MA 100,160,252
s_waitcnt vmcnt(10)
s_barrier
MA 108,164,252
RT 160,144,32768
RT 162,144,33792
MA 104,164,248
buffer_store_dwordx4 v[132:135], v21, s[20:23], s41 offen offset:1024 sc1
MA 112,168,248
RT 164,145,32768
RT 166,145,33792
MA 116,168,252
CV 128,68,69
CV 129,70,71
MA 124,172,252
RT 168,144,34816
RT 170,144,35840
MA 120,172,248
WL 6
s_nop 0
CV 130,76,77
MV 96,144,136
RT 172,145,34816
RT 174,145,35840
MV 100,144,140
CV 131,78,79
MV 108,148,140
RT 144,144,36864
RT 146,144,37888
MV 104,148,136
buffer_store_dwordx4 v[128:131], v21, s[20:23], s41 offen offset:2048 sc1
MV 112,152,136
RT 148,145,36864
RT 150,145,37888
MV 116,152,140
CV 132,84,85
CV 133,86,87
MV 124,156,140
RT 152,144,38912
RT 154,144,39936
MV 120,156,136
WL 6
s_nop 0
CV 134,92,93
MV 112,160,160
RT 156,145,38912
RT 158,145,39936
MV 116,160,164
CV 135,94,95
MV 124,164,164
RT 160,144,40960
RT 162,144,41984
MV 120,164,160
buffer_store_dwordx4 v[132:135], v21, s[20:23], s41 offen offset:3072 sc1
MV 112,168,168
RT 164,145,40960
RT 166,145,41984
MV 116,168,172
MV 124,172,172
RT 168,144,43008
RT 170,144,44032
MV 120,172,168
WL 6
s_add_u32 s41, s59, 0
MV 112,144,176
RT 172,145,43008
RT 174,145,44032
MV 116,144,180
CV 128,96,97
CV 129,98,99
CV 130,104,105
MV 124,148,180
RT 144,144,45056
RT 146,144,46080
MV 120,148,176
CV 131,106,107
buffer_store_dwordx4 v[128:131], v21, s[20:23], s41 offen offset:0 sc1
MV 112,152,184
RT 148,145,45056
RT 150,145,46080
MV 116,152,188
CV 132,100,101
CV 133,102,103
CV 134,108,109
MV 124,156,188
RT 152,144,47104
RT 154,144,48128
MV 120,156,184
WL 6
s_nop 0
CV 135,110,111
MV 112,160,192
RT 156,145,47104
RT 158,145,48128
MV 116,160,196
buffer_store_dwordx4 v[132:135], v21, s[20:23], s41 offen offset:2048 sc1
v_mov_b32_e64 v96, 0
MV 124,164,196
RT 160,144,49152
RT 162,144,50176
MV 120,164,192
v_mov_b32 v97, 0
v_mov_b32 v98, 0
MV 112,168,200
RT 164,145,49152
RT 166,145,50176
MV 116,168,204
v_mov_b32 v99, 0
v_mov_b32 v100, 0
MV 124,172,204
RT 168,144,51200
RT 170,144,52224
MV 120,172,200
WL 6
v_mov_b32 v101, 0
MV 112,144,208
RT 172,145,51200
RT 174,145,52224
MV 116,144,212
v_mov_b32 v102, 0
v_mov_b32 v103, 0
MV 124,148,212
RT 144,144,53248
RT 146,144,54272
MV 120,148,208
buffer_load_dwordx4 v[32:35], v152, s[8:11], s75 offen offset:0
MV 112,152,216
RT 148,145,53248
RT 150,145,54272
MV 116,152,220
buffer_load_dwordx4 v[36:39], v152, s[8:11], s77 offen offset:0
MV 124,156,220
RT 152,144,55296
RT 154,144,56320
MV 120,156,216
WL 6
s_nop 0
MV 112,160,224
RT 156,145,55296
RT 158,145,56320
MV 116,160,228
buffer_load_dwordx4 v[40:43], v151, s[8:11], s67 offen offset:256
MV 124,164,228
RT 160,144,57344
RT 162,144,58368
MV 120,164,224
MV 112,168,232
RT 164,145,57344
RT 166,145,58368
MV 116,168,236
MV 124,172,236
RT 168,144,59392
RT 170,144,60416
MV 120,172,232
WL 6
s_nop 0
MV 112,144,240
RT 172,145,59392
RT 174,145,60416
MV 116,144,244
MV 124,148,244
RT 144,144,61440
RT 146,144,62464
MV 120,148,240
MV 112,152,248
RT 148,145,61440
RT 150,145,62464
MV 116,152,252
MV 124,156,252
RT 152,144,63488
RT 154,144,64512
MV 120,156,248
WL 6
s_nop 0
MA 112,160,176
RT 156,145,63488
RT 158,145,64512
MA 116,160,180
MA 124,164,180
RT 160,146,0
RT 162,146,1024
MA 120,164,176
MA 112,168,184
RT 164,147,0
RT 166,147,1024
MA 116,168,188
MA 124,172,188
RT 168,146,2048
RT 170,146,3072
MA 120,172,184
WL 6
s_nop 0
MA 112,144,192
RT 172,147,2048
RT 174,147,3072
MA 116,144,196
MA 124,148,196
RT 144,146,4096
RT 146,146,5120
MA 120,148,192
MA 112,152,200
RT 148,147,4096
RT 150,147,5120
MA 116,152,204
MA 124,156,204
RT 152,146,6144
RT 154,146,7168
MA 120,156,200
WL 6
s_nop 0
MA 112,160,208
RT 156,147,6144
RT 158,147,7168
MA 116,160,212
MA 124,164,212
RT 160,146,8192
RT 162,146,9216
MA 120,164,208
MA 112,168,216
RT 164,147,8192
RT 166,147,9216
MA 116,168,220
MA 124,172,220
RT 168,146,10240
RT 170,146,11264
MA 120,172,216
WL 6
s_nop 0
MA 112,144,224
RT 172,147,10240
RT 174,147,11264
MA 116,144,228
MA 124,148,228
RT 144,146,12288
RT 146,146,13312
MA 120,148,224
MA 112,152,232
RT 148,147,12288
RT 150,147,13312
MA 116,152,236
MA 124,156,236
RT 152,146,14336
RT 154,146,15360
MA 120,156,232
WL 6
s_nop 0
MA 112,160,0
RT 156,147,14336
RT 158,147,15360
MA 116,160,4
s_waitcnt vmcnt(3)
s_waitcnt vmcnt(11)
s_barrier
v_mov_b32 v28, s97
buffer_store_dword v28, v24, s[20:23], s65 offen offset:0 sc1
MA 124,164,4
RT 160,146,16384
RT 162,146,17408
MA 120,164,0
MA 112,168,8
RT 164,147,16384
RT 166,147,17408
MA 116,168,12
MA 124,172,12
RT 168,146,18432
RT 170,146,19456
MA 120,172,8
WL 6
s_nop 0
MA 112,144,16
RT 172,147,18432
RT 174,147,19456
MA 116,144,20
MA 124,148,20
RT 144,146,20480
RT 146,146,21504
MA 120,148,16
MA 112,152,24
RT 148,147,20480
RT 150,147,21504
MA 116,152,28
MA 124,156,28
RT 152,146,22528
RT 154,146,23552
MA 120,156,24
WL 6
s_nop 0
MA 112,160,32
RT 156,147,22528
RT 158,147,23552
MA 116,160,36
MA 124,164,36
RT 160,146,24576
RT 162,146,25600
MA 120,164,32
MA 112,168,40
RT 164,147,24576
RT 166,147,25600
MA 116,168,44
MA 124,172,44
RT 168,146,26624
RT 170,146,27648
MA 120,172,40
WL 6
s_nop 0
MA 112,144,48
RT 172,147,26624
RT 174,147,27648
MA 116,144,52
MA 124,148,52
RT 144,146,28672
RT 146,146,29696
MA 120,148,48
MA 112,152,56
RT 148,147,28672
RT 150,147,29696
MA 116,152,60
MA 124,156,60
RT 152,146,30720
RT 154,146,31744
MA 120,156,56
WL 6
s_nop 0
MA 112,160,96
RT 156,147,30720
RT 158,147,31744
MA 116,160,100
MA 124,164,100
RT 160,146,32768
RT 162,146,33792
MA 120,164,96
MA 112,168,104
RT 164,147,32768
RT 166,147,33792
MA 116,168,108
MA 124,172,108
RT 168,146,34816
RT 170,146,35840
MA 120,172,104
WL 6
s_nop 0
MA 112,144,112
RT 172,147,34816
RT 174,147,35840
MA 116,144,116
MA 124,148,116
RT 144,146,36864
RT 146,146,37888
MA 120,148,112
MA 112,152,120
RT 148,147,36864
RT 150,147,37888
MA 116,152,124
MA 124,156,124
RT 152,146,38912
RT 154,146,39936
MA 120,156,120
WL 6
s_nop 0
MA 112,160,64
RT 156,147,38912
RT 158,147,39936
MA 116,160,68
MA 124,164,68
MA 120,164,64
MA 112,168,72
MA 116,168,76
MA 124,172,76
MA 120,172,72
WL 0
s_nop 0
MA 112,144,80
MA 116,144,84
MA 124,148,84
MA 120,148,80
MA 112,152,88
MA 116,152,92
MA 124,156,92
MA 120,156,88
s_cmp_lg_u32 s32, 0
s_cbranch_scc1 L_polld_17
s_mov_b32 s89, 0x20000
L_poll_16:
buffer_load_dword v28, v23, s[20:23], s64 offen sc1
s_waitcnt vmcnt(0)
L_pollc_18:
v_cmp_eq_u32 s[98:99], s97, v28
s_sub_u32 s89, s89, 1
s_and_b32 s98, s98, 0xf
s_cmp_eq_u32 s98, 0xf
s_cbranch_scc1 L_polld_17
s_sleep 1
s_cmp_lg_u32 s89, 0
s_cbranch_scc1 L_poll_16
L_polld_17:
s_barrier
s_nop 0
buffer_load_dwordx4 v[48:51], v21, s[20:23], s72 offen offset:0 sc1
buffer_load_dwordx4 v[52:55], v21, s[20:23], s72 offen offset:2048 sc1
buffer_load_dwordx4 v[56:59], v150, s[20:23], s66 offen sc1
buffer_load_dwordx4 v[60:63], v21, s[20:23], s73 offen offset:0 sc1
buffer_load_dwordx4 v[64:67], v21, s[20:23], s73 offen offset:2048 sc1
s_add_u32 s66, s66, 2359296
buffer_load_dwordx4 v[68:71], v150, s[20:23], s66 offen sc1
buffer_load_dwordx4 v[72:75], v21, s[20:23], s74 offen offset:0 sc1
buffer_load_dwordx4 v[76:79], v21, s[20:23], s74 offen offset:2048 sc1
s_add_u32 s66, s66, 2359296
buffer_load_dwordx4 v[80:83], v150, s[20:23], s66 offen sc1
s_add_u32 s66, s66, 2359296
buffer_load_dwordx4 v[84:87], v150, s[20:23], s66 offen sc1
s_waitcnt vmcnt(11)
v_lshlrev_b32 v160, 16, v32
v_and_b32 v161, 0xffff0000, v32
v_lshlrev_b32_e64 v162, 16, v33
v_and_b32 v163, 0xffff0000, v33
v_lshlrev_b32_e64 v164, 16, v34
v_and_b32 v165, 0xffff0000, v34
v_lshlrev_b32_e64 v166, 16, v35
v_and_b32 v167, 0xffff0000, v35
v_lshlrev_b32_e64 v168, 16, v36
v_and_b32 v169, 0xffff0000, v36
v_lshlrev_b32_e64 v170, 16, v37
v_and_b32 v171, 0xffff0000, v37
v_lshlrev_b32_e64 v172, 16, v38
v_and_b32 v173, 0xffff0000, v38
v_lshlrev_b32_e64 v174, 16, v39
v_and_b32 v175, 0xffff0000, v39
v_lshlrev_b32_e64 v176, 16, v40
v_and_b32 v177, 0xffff0000, v40
v_lshlrev_b32_e64 v178, 16, v41
v_and_b32 v179, 0xffff0000, v41
v_lshlrev_b32_e64 v180, 16, v42
v_and_b32 v181, 0xffff0000, v42
v_lshlrev_b32_e64 v182, 16, v43
v_and_b32 v183, 0xffff0000, v43
s_waitcnt vmcnt(7)
v_dot2c_f32_bf16 v112, s70, v48
v_dot2c_f32_bf16 v113, s71, v48
v_dot2c_f32_bf16 v114, s70, v49
v_dot2c_f32_bf16 v115, s71, v49
v_dot2c_f32_bf16 v120, s70, v50
v_dot2c_f32_bf16 v121, s71, v50
v_dot2c_f32_bf16 v122, s70, v51
v_dot2c_f32_bf16 v123, s71, v51
v_dot2c_f32_bf16 v116, s70, v52
v_dot2c_f32_bf16 v117, s71, v52
v_dot2c_f32_bf16 v118, s70, v53
v_dot2c_f32_bf16 v119, s71, v53
v_dot2c_f32_bf16 v124, s70, v54
v_dot2c_f32_bf16 v125, s71, v54
v_dot2c_f32_bf16 v126, s70, v55
v_dot2c_f32_bf16 v127, s71, v55
v_dot2c_f32_bf16 v96, s70, v56
v_dot2c_f32_bf16 v97, s71, v56
v_dot2c_f32_bf16 v98, s70, v57
v_dot2c_f32_bf16 v99, s71, v57
v_dot2c_f32_bf16 v100, s70, v58
v_dot2c_f32_bf16 v101, s71, v58
v_dot2c_f32_bf16 v102, s70, v59
v_dot2c_f32_bf16 v103, s71, v59
s_waitcnt vmcnt(4)
v_dot2c_f32_bf16 v112, s70, v60
v_dot2c_f32_bf16 v113, s71, v60
v_dot2c_f32_bf16 v114, s70, v61
v_dot2c_f32_bf16 v115, s71, v61
v_dot2c_f32_bf16 v120, s70, v62
v_dot2c_f32_bf16 v121, s71, v62
v_dot2c_f32_bf16 v122, s70, v63
v_dot2c_f32_bf16 v123, s71, v63
v_dot2c_f32_bf16 v116, s70, v64
v_dot2c_f32_bf16 v117, s71, v64
v_dot2c_f32_bf16 v118, s70, v65
v_dot2c_f32_bf16 v119, s71, v65
v_dot2c_f32_bf16 v124, s70, v66
v_dot2c_f32_bf16 v125, s71, v66
v_dot2c_f32_bf16 v126, s70, v67
v_dot2c_f32_bf16 v127, s71, v67
v_dot2c_f32_bf16 v96, s70, v68
v_dot2c_f32_bf16 v97, s71, v68
v_dot2c_f32_bf16 v98, s70, v69
v_dot2c_f32_bf16 v99, s71, v69
v_dot2c_f32_bf16 v100, s70, v70
v_dot2c_f32_bf16 v101, s71, v70
v_dot2c_f32_bf16 v102, s70, v71
v_dot2c_f32_bf16 v103, s71, v71
s_waitcnt vmcnt(1)
v_dot2c_f32_bf16 v112, s70, v72
v_dot2c_f32_bf16 v113, s71, v72
v_dot2c_f32_bf16 v114, s70, v73
v_dot2c_f32_bf16 v115, s71, v73
v_dot2c_f32_bf16 v120, s70, v74
v_dot2c_f32_bf16 v121, s71, v74
v_dot2c_f32_bf16 v122, s70, v75
v_dot2c_f32_bf16 v123, s71, v75
v_dot2c_f32_bf16 v116, s70, v76
v_dot2c_f32_bf16 v117, s71, v76
v_dot2c_f32_bf16 v118, s70, v77
v_dot2c_f32_bf16 v119, s71, v77
v_dot2c_f32_bf16 v124, s70, v78
v_dot2c_f32_bf16 v125, s71, v78
v_dot2c_f32_bf16 v126, s70, v79
v_dot2c_f32_bf16 v127, s71, v79
v_dot2c_f32_bf16 v96, s70, v80
v_dot2c_f32_bf16 v97, s71, v80
v_dot2c_f32_bf16 v98, s70, v81
v_dot2c_f32_bf16 v99, s71, v81
v_dot2c_f32_bf16 v100, s70, v82
v_dot2c_f32_bf16 v101, s71, v82
v_dot2c_f32_bf16 v102, s70, v83
v_dot2c_f32_bf16 v103, s71, v83
s_waitcnt vmcnt(0)
v_dot2c_f32_bf16 v96, s70, v84
v_dot2c_f32_bf16 v97, s71, v84
v_dot2c_f32_bf16 v98, s70, v85
v_dot2c_f32_bf16 v99, s71, v85
v_dot2c_f32_bf16 v100, s70, v86
v_dot2c_f32_bf16 v101, s71, v86
v_dot2c_f32_bf16 v102, s70, v87
v_dot2c_f32_bf16 v103, s71, v87
s_nop 2
v_permlane16_swap_b32 v112, v120
v_permlane16_swap_b32 v113, v121
v_permlane16_swap_b32 v114, v122
v_permlane16_swap_b32 v115, v123
v_fmac_f32 v160, v112, v155
v_fmac_f32_e64 v161, v113, v155
CV 184,160,161
v_fmac_f32 v162, v114, v155
v_fmac_f32 v163, v115, v155
CV 185,162,163
v_fmac_f32 v164, v120, v155
v_fmac_f32 v165, v121, v155
CV 186,164,165
v_fmac_f32 v166, v122, v155
v_fmac_f32 v167, v123, v155
CV 187,166,167
buffer_store_dwordx4 v[184:187], v152, s[12:15], s75 offen offset:0 sc1
v_permlane16_swap_b32 v116, v124
v_permlane16_swap_b32 v117, v125
v_permlane16_swap_b32 v118, v126
v_permlane16_swap_b32 v119, v127
v_fmac_f32 v168, v116, v156
v_fmac_f32 v169, v117, v156
CV 188,168,169
v_fmac_f32 v170, v118, v156
v_fmac_f32 v171, v119, v156
CV 189,170,171
v_fmac_f32 v172, v124, v156
v_fmac_f32 v173, v125, v156
CV 190,172,173
v_fmac_f32 v174, v126, v156
v_fmac_f32 v175, v127, v156
CV 191,174,175
buffer_store_dwordx4 v[188:191], v152, s[12:15], s77 offen offset:0 sc1
v_permlane16_swap_b32 v96, v100
v_permlane16_swap_b32 v97, v101
v_permlane16_swap_b32 v98, v102
v_permlane16_swap_b32 v99, v103
v_fmac_f32 v176, v96, v157
v_fmac_f32 v177, v97, v157
CV 192,176,177
v_fmac_f32 v178, v98, v157
v_fmac_f32 v179, v99, v157
CV 193,178,179
v_fmac_f32 v180, v100, v157
v_fmac_f32 v181, v101, v157
CV 194,180,181
v_fmac_f32 v182, v102, v157
v_fmac_f32 v183, v103, v157
CV 195,182,183
buffer_store_dwordx4 v[192:195], v151, s[12:15], s67 offen offset:256 sc1
s_endpgm
.p2align 6
L_att:
s_sub_u32 s66, s66, 2048
s_subb_u32 s67, s67, 0
s_mov_b32 s12, s66
s_and_b32 s13, s67, 0xffff
s_mov_b32 s14, 0x1e6800
s_mov_b32 s15, 0x20000
s_mov_b32 s28, s68
s_nop 0
s_and_b32 s29, s69, 0xffff
s_mov_b32 s30, 0x5100
s_mov_b32 s31, 0x20000
s_mul_i32 s37, s32, 3072
s_and_b32 s35, s32, 1
s_lshl_b32 s35, s35, 4
s_add_u32 s37, s37, s35
s_and_b32 s35, s32, 2
s_lshl_b32 s35, s35, 7
s_add_u32 s37, s37, s35
s_mul_i32 s50, s34, 288
s_and_b32 s47, s50, 0xffc0
s_add_u32 s49, s47, 1152
s_lshl_b32 s52, s34, 7
s_add_u32 s52, s52, 0x2782000
s_add_u32 s46, s52, 512
s_lshl_b32 s63, s33, 2
s_add_u32 s63, s63, s52
s_lshl_b32 s35, s33, 2
s_add_u32 s35, s35, s34
s_lshl_b32 s44, s35, 7
s_add_u32 s44, s44, 0x2780000
s_lshl_b32 s35, s35, 2
s_add_u32 s35, s35, s32
s_mul_i32 s45, s35, 10240
s_add_u32 s45, s45, 0x2200000
s_lshl_b32 s51, s34, 3
s_add_u32 s51, s51, s32
s_lshl_b32 s51, s51, 4
s_add_u32 s51, s51, s33
s_mul_i32 s51, s51, 2944
s_add_u32 s51, s51, 0x2510000
s_add_u32 s6, s60, 1
s_and_b32 s6, s6, 3
s_mulk_i32 s6, 9216
s_add_u32 m0, s5, s6
s_add_u32 s7, s4, s6
buffer_load_dwordx4 v105, s[8:11], s7 offen  lds
v_mul_u32_u24 v28, 3641, v0
v_lshrrev_b32 v28, 16, v28
v_mul_u32_u24 v9, 18, v28
v_sub_u32 v9, v0, v9
s_mul_i32 s96, s32, 18
s_and_b32 s95, s33, 7
s_mul_i32 s95, s95, 72
s_addk_i32 m0, 1024
s_addk_i32 s7, 128
buffer_load_dwordx4 v105, s[8:11], s7 offen  lds
s_add_u32 s96, s96, s95
v_add_u32 v9, s96, v9
v_mul_u32_u24 v9, 3456, v9
v_lshl_add_u32 v9, v28, 7, v9
v_add_u32 v9, 2048, v9
v_cmp_gt_u32 vcc, 54, v0
v_mov_b32 v28, 0x40000000
s_addk_i32 m0, 1024
s_addk_i32 s7, 128
buffer_load_dwordx4 v105, s[8:11], s7 offen  lds
s_nop 0
v_cndmask_b32 v9, v28, v9, vcc
s_lshl_b32 s95, s32, 6
v_add_u32 v29, s95, v0
v_mov_b32 v96, 0
v_mov_b32 v97, 0
v_mov_b32 v98, 0
v_mov_b32 v99, 0
s_addk_i32 m0, 1024
s_addk_i32 s7, 128
buffer_load_dwordx4 v105, s[8:11], s7 offen  lds
v_lshlrev_b32_e64 v28, 5, v29
v_add_u32 v28, 155648, v28
ds_write_b128 v28, v[96:99]
ds_write_b128 v28, v[96:99] offset:16
v_add_u32_e64 v28, 0, v29
v_mul_u32_u24 v30, 7282, v28
v_lshrrev_b32 v30, 16, v30
s_addk_i32 m0, 1024
s_addk_i32 s7, 128
buffer_load_dwordx4 v105, s[8:11], s7 offen  lds
v_mul_u32_u24 v31, 3641, v30
v_lshrrev_b32 v31, 16, v31
v_add_lshl_u32 v90, v28, v30, 2
v_mul_u32_u24 v30, 240, v31
v_add_u32 v90, v90, v30
v_and_b32 v31, 1, v31
v_mul_u32_u24 v31, 80, v31
s_addk_i32 m0, 1024
s_addk_i32 s7, 128
buffer_load_dwordx4 v105, s[8:11], s7 offen  lds
v_add_u32_e64 v90, v90, v31
v_add_u32 v90, 155648, v90
v_add_u32 v28, 256, v29
v_mul_u32_u24 v30, 7282, v28
v_lshrrev_b32_e64 v30, 16, v30
v_mul_u32_u24 v31, 3641, v30
v_lshrrev_b32_e64 v31, 16, v31
v_add_lshl_u32 v91, v28, v30, 2
s_addk_i32 m0, 1024
s_addk_i32 s7, 128
buffer_load_dwordx4 v105, s[8:11], s7 offen  lds
v_mul_u32_u24 v30, 240, v31
v_add_u32 v91, v91, v30
v_and_b32 v31, 1, v31
v_mul_u32_u24 v31, 80, v31
v_add_u32_e64 v91, v91, v31
v_add_u32 v91, 155648, v91
v_add_u32 v28, 512, v29
s_addk_i32 m0, 1024
s_addk_i32 s7, 128
buffer_load_dwordx4 v105, s[8:11], s7 offen  lds
v_mul_u32_u24 v30, 7282, v28
v_lshrrev_b32_e64 v30, 16, v30
v_mul_u32_u24 v31, 3641, v30
v_lshrrev_b32_e64 v31, 16, v31
v_add_lshl_u32 v92, v28, v30, 2
v_mul_u32_u24 v30, 240, v31
v_add_u32 v92, v92, v30
s_addk_i32 m0, 1024
s_addk_i32 s7, 128
buffer_load_dwordx4 v105, s[8:11], s7 offen  lds
v_and_b32 v31, 1, v31
v_mul_u32_u24 v31, 80, v31
v_add_u32_e64 v92, v92, v31
v_add_u32 v92, 155648, v92
v_add_u32 v28, 768, v29
v_mul_u32_u24 v30, 7282, v28
v_lshrrev_b32_e64 v30, 16, v30
v_mul_u32_u24 v31, 3641, v30
s_add_u32 s6, s60, 2
s_and_b32 s6, s6, 3
s_mulk_i32 s6, 9216
s_add_u32 m0, s5, s6
s_add_u32 s7, s4, s6
buffer_load_dwordx4 v104, s[8:11], s7 offen  lds
v_lshrrev_b32 v31, 16, v31
v_add_lshl_u32 v93, v28, v30, 2
v_mul_u32_u24 v30, 240, v31
v_add_u32 v93, v93, v30
v_and_b32 v31, 1, v31
v_mul_u32_u24 v31, 80, v31
v_add_u32 v93, v93, v31
s_addk_i32 m0, 1024
s_addk_i32 s7, 128
s_nop 0
buffer_load_dwordx4 v104, s[8:11], s7 offen  lds
v_add_u32 v93, 155648, v93
v_add_u32 v28, 1024, v29
v_mul_u32_u24 v30, 7282, v28
v_lshrrev_b32_e64 v30, 16, v30
v_mul_u32_u24 v31, 3641, v30
v_lshrrev_b32_e64 v31, 16, v31
v_add_lshl_u32 v94, v28, v30, 2
v_mul_u32_u24 v30, 240, v31
s_addk_i32 m0, 1024
s_addk_i32 s7, 128
buffer_load_dwordx4 v104, s[8:11], s7 offen  lds
v_add_u32 v94, v94, v30
v_and_b32 v31, 1, v31
v_mul_u32_u24 v31, 80, v31
v_add_u32_e64 v94, v94, v31
v_add_u32 v94, 155648, v94
v_add_u32 v28, 1280, v29
v_mul_u32_u24 v30, 7282, v28
s_addk_i32 m0, 1024
s_addk_i32 s7, 128
buffer_load_dwordx4 v104, s[8:11], s7 offen  lds
v_lshrrev_b32_e64 v30, 16, v30
v_mul_u32_u24 v31, 3641, v30
v_lshrrev_b32_e64 v31, 16, v31
v_add_lshl_u32 v95, v28, v30, 2
v_mul_u32_u24 v30, 240, v31
v_add_u32 v95, v95, v30
v_and_b32 v31, 1, v31
s_addk_i32 m0, 1024
s_addk_i32 s7, 128
buffer_load_dwordx4 v104, s[8:11], s7 offen  lds
v_mul_u32_u24 v31, 80, v31
v_add_u32_e64 v95, v95, v31
v_add_u32 v95, 155648, v95
v_cmp_gt_u32_e64 vcc, 16, v29
v_mov_b32 v28, 150000
s_nop 0
v_cndmask_b32 v95, v28, v95, vcc
s_lshl_b32 s96, s32, 3
s_addk_i32 m0, 1024
s_addk_i32 s7, 128
buffer_load_dwordx4 v104, s[8:11], s7 offen  lds
v_mov_b32 v111, 0x40000000
v_add_u32_e64 v28, 0, v0
v_mul_u32_u24 v30, 5462, v28
v_lshrrev_b32 v30, 16, v30
v_mul_u32_u24 v31, 12, v30
v_sub_u32 v31, v28, v31
v_lshrrev_b32 v28, 3, v30
s_addk_i32 m0, 1024
s_addk_i32 s7, 128
buffer_load_dwordx4 v104, s[8:11], s7 offen  lds
v_and_b32 v30, 7, v30
v_add_u32 v30, s96, v30
v_mul_u32_u24 v30, 3456, v30
v_lshl_add_u32 v30, v31, 4, v30
v_add_u32 v30, 2048, v30
v_lshl_add_u32 v4, v28, 7, v30
v_mul_u32_u24 v28, 1152, v28
s_addk_i32 m0, 1024
s_addk_i32 s7, 128
buffer_load_dwordx4 v104, s[8:11], s7 offen  lds
v_add_u32 v1, v28, v30
v_add_u32 v28, 64, v0
v_mul_u32_u24 v30, 5462, v28
v_lshrrev_b32 v30, 16, v30
v_mul_u32_u24 v31, 12, v30
v_sub_u32 v31, v28, v31
v_lshrrev_b32 v28, 3, v30
v_and_b32 v30, 7, v30
s_addk_i32 m0, 1024
s_addk_i32 s7, 128
buffer_load_dwordx4 v104, s[8:11], s7 offen  lds
v_add_u32 v30, s96, v30
v_mul_u32_u24 v30, 3456, v30
v_lshl_add_u32 v30, v31, 4, v30
v_add_u32 v30, 1024, v30
v_lshl_add_u32 v5, v28, 7, v30
v_mul_u32_u24 v28, 1152, v28
v_add_u32 v2, v28, v30
s_add_u32 s6, s60, 3
s_and_b32 s6, s6, 3
s_mulk_i32 s6, 9216
s_add_u32 m0, s5, s6
s_add_u32 s7, s4, s6
buffer_load_dwordx4 v105, s[8:11], s7 offen  lds
v_add_u32 v28, 128, v0
v_mul_u32_u24 v30, 5462, v28
v_lshrrev_b32 v30, 16, v30
v_mul_u32_u24 v31, 12, v30
v_sub_u32 v31, v28, v31
v_lshrrev_b32 v28, 3, v30
v_and_b32 v30, 7, v30
v_add_u32 v30, s96, v30
s_addk_i32 m0, 1024
s_addk_i32 s7, 128
buffer_load_dwordx4 v105, s[8:11], s7 offen  lds
v_mul_u32_u24 v30, 3456, v30
v_lshl_add_u32 v30, v31, 4, v30
v_add_u32_e64 v30, 0, v30
v_lshl_add_u32 v6, v28, 7, v30
v_mul_u32_u24 v28, 1152, v28
v_add_u32_e64 v3, v28, v30
v_mul_u32_u24 v7, 3072, v22
s_addk_i32 m0, 1024
s_addk_i32 s7, 128
buffer_load_dwordx4 v105, s[8:11], s7 offen  lds
v_and_b32_e64 v28, 1, v22
v_cmp_eq_u32 s[42:43], 1, v28
v_lshl_add_u32 v7, v28, 4, v7
v_lshrrev_b32_e64 v28, 1, v22
v_lshl_add_u32 v7, v28, 8, v7
v_bfe_u32 v28, v0, 2, 2
v_mul_u32_u24 v30, 192, v28
s_addk_i32 m0, 1024
s_addk_i32 s7, 128
buffer_load_dwordx4 v105, s[8:11], s7 offen  lds
v_add_u32_e64 v7, v7, v30
v_bfe_u32 v30, v0, 1, 1
v_mul_u32_u24 v30, 72, v30
v_add_u32 v7, v7, v30
v_and_b32 v30, 1, v0
v_lshl_add_u32 v7, v30, 5, v7
s_and_b32 s96, s50, 63
v_add_u32 v7, s96, v7
s_addk_i32 m0, 1024
s_addk_i32 s7, 128
buffer_load_dwordx4 v105, s[8:11], s7 offen  lds
v_add_u32 v8, 0x10000, v7
v_mul_u32_u24 v18, 960, v22
v_mul_u32_u24 v30, 40, v28
v_add_u32 v18, v18, v30
v_add_u32 v18, 155648, v18
v_and_b32 v30, 3, v0
v_cmp_eq_u32 vcc, v30, v22
s_addk_i32 m0, 1024
s_addk_i32 s7, 128
buffer_load_dwordx4 v105, s[8:11], s7 offen  lds
v_mov_b32 v30, 163328
v_mov_b32 v31, 320
v_cndmask_b32 v18, v30, v18, vcc
v_cndmask_b32 v19, 0, v31, vcc
v_cmp_eq_u32 vcc, 0, v29
v_lshlrev_b32 v21, 4, v0
s_nop 0
s_addk_i32 m0, 1024
s_addk_i32 s7, 128
buffer_load_dwordx4 v105, s[8:11], s7 offen  lds
v_mov_b32 v20, 0
v_cndmask_b32 v20, v111, v20, vcc
s_lshl_b32 s96, s32, 5
v_add_u32_e64 v28, s96, v23
v_mul_u32_u24 v10, 112, v28
v_mul_u32_u24 v28, 14336, v22
v_add_u32_e64 v10, v10, v28
v_add_u32 v10, 98304, v10
s_addk_i32 m0, 1024
s_addk_i32 s7, 128
buffer_load_dwordx4 v105, s[8:11], s7 offen  lds
v_bfe_u32 v28, v0, 2, 2
v_lshl_add_u32 v28, v22, 3, v28
v_mul_u32_u24 v11, 112, v28
v_and_b32_e64 v28, 3, v0
v_lshl_add_u32 v11, v28, 3, v11
s_mul_i32 s96, s32, 14336
s_add_u32 s96, s96, 98304
s_addk_i32 m0, 1024
s_addk_i32 s7, 128
buffer_load_dwordx4 v105, s[8:11], s7 offen  lds
v_add_u32 v11, s96, v11
v_lshlrev_b32 v12, 4, v0
v_accvgpr_write_b32 a250, v90
v_accvgpr_write_b32 a251, v91
v_accvgpr_write_b32 a252, v92
v_accvgpr_write_b32 a253, v93
v_accvgpr_write_b32 a254, v94
v_accvgpr_write_b32 a255, v95
v_lshrrev_b32_e64 v106, 3, v23
v_mul_u32_u24 v106, 9216, v106
v_and_b32_e64 v107, 7, v23
v_lshl_add_u32 v106, v107, 7, v106
v_lshrrev_b32 v107, 1, v23
v_xor_b32 v107, v107, v22
v_lshl_add_u32 v106, v107, 4, v106
v_add_u32 v106, s5, v106
v_xor_b32 v107, 64, v106
v_mov_b32 v80, 0x3f803f80
v_mov_b32 v81, 0x3f803f80
v_mov_b32 v82, 0x3f803f80
v_mov_b32 v83, 0x3f803f80
v_mov_b32 v72, 0
v_mov_b32 v73, 0
v_mov_b32 v76, 0
v_mov_b32 v77, 0
v_lshrrev_b32 v108, 2, v23
v_cmp_eq_u32 vcc, v108, v22
v_and_b32 v108, 1, v23
v_lshlrev_b32 v108, 4, v108
v_mov_b32 v78, 0x3f80
v_lshlrev_b32 v78, v108, v78
v_cndmask_b32 v78, 0, v78, vcc
v_and_b32 v108, 2, v23
v_cmp_eq_u32 vcc, 0, v108
s_nop 1
v_cndmask_b32 v74, 0, v78, vcc
v_sub_u32 v75, v78, v74
s_waitcnt vmcnt(8)
ds_read_b128 v[112:115], v106 offset:0
ds_read_b128 v[116:119], v106 offset:18432
ds_read_b128 v[120:123], v107 offset:0
ds_read_b128 v[124:127], v107 offset:18432
s_waitcnt vmcnt(7)
s_nop 0
ds_read_b128 v[128:131], v106 offset:1024
ds_read_b128 v[132:135], v106 offset:19456
ds_read_b128 v[136:139], v107 offset:1024
ds_read_b128 v[140:143], v107 offset:19456
WL 4
s_nop 0
v_mfma_f32_16x16x32_bf16 v[64:67], v[80:83], v[112:115], 0
v_mfma_f32_16x16x32_bf16 v[68:71], v[80:83], v[116:119], 0
v_mfma_f32_16x16x32_bf16 v[64:67], v[80:83], v[120:123], v[64:67]
v_mfma_f32_16x16x32_bf16 v[68:71], v[80:83], v[124:127], v[68:71]
s_waitcnt vmcnt(6)
s_nop 0
ds_read_b128 v[144:147], v106 offset:2048
ds_read_b128 v[148:151], v106 offset:20480
ds_read_b128 v[152:155], v107 offset:2048
ds_read_b128 v[156:159], v107 offset:20480
WL 4
s_nop 0
v_mfma_f32_16x16x32_bf16 v[64:67], v[80:83], v[128:131], v[64:67]
v_mfma_f32_16x16x32_bf16 v[68:71], v[80:83], v[132:135], v[68:71]
v_mfma_f32_16x16x32_bf16 v[64:67], v[80:83], v[136:139], v[64:67]
v_mfma_f32_16x16x32_bf16 v[68:71], v[80:83], v[140:143], v[68:71]
s_waitcnt vmcnt(5)
s_nop 0
ds_read_b128 v[160:163], v106 offset:3072
ds_read_b128 v[164:167], v106 offset:21504
ds_read_b128 v[168:171], v107 offset:3072
ds_read_b128 v[172:175], v107 offset:21504
WL 4
s_nop 0
v_mfma_f32_16x16x32_bf16 v[64:67], v[80:83], v[144:147], v[64:67]
v_mfma_f32_16x16x32_bf16 v[68:71], v[80:83], v[148:151], v[68:71]
v_mfma_f32_16x16x32_bf16 v[64:67], v[80:83], v[152:155], v[64:67]
v_mfma_f32_16x16x32_bf16 v[68:71], v[80:83], v[156:159], v[68:71]
s_waitcnt vmcnt(4)
s_nop 0
ds_read_b128 v[176:179], v106 offset:4096
ds_read_b128 v[180:183], v106 offset:22528
ds_read_b128 v[184:187], v107 offset:4096
ds_read_b128 v[188:191], v107 offset:22528
WL 4
s_nop 0
v_mfma_f32_16x16x32_bf16 v[64:67], v[80:83], v[160:163], v[64:67]
v_mfma_f32_16x16x32_bf16 v[68:71], v[80:83], v[164:167], v[68:71]
v_mfma_f32_16x16x32_bf16 v[64:67], v[80:83], v[168:171], v[64:67]
v_mfma_f32_16x16x32_bf16 v[68:71], v[80:83], v[172:175], v[68:71]
s_waitcnt vmcnt(3)
s_nop 0
ds_read_b128 v[192:195], v106 offset:5120
ds_read_b128 v[196:199], v106 offset:23552
ds_read_b128 v[200:203], v107 offset:5120
ds_read_b128 v[204:207], v107 offset:23552
WL 4
s_nop 0
v_mfma_f32_16x16x32_bf16 v[64:67], v[80:83], v[176:179], v[64:67]
v_mfma_f32_16x16x32_bf16 v[68:71], v[80:83], v[180:183], v[68:71]
v_mfma_f32_16x16x32_bf16 v[64:67], v[80:83], v[184:187], v[64:67]
v_mfma_f32_16x16x32_bf16 v[68:71], v[80:83], v[188:191], v[68:71]
s_waitcnt vmcnt(2)
s_nop 0
ds_read_b128 v[208:211], v106 offset:6144
ds_read_b128 v[212:215], v106 offset:24576
ds_read_b128 v[216:219], v107 offset:6144
ds_read_b128 v[220:223], v107 offset:24576
WL 4
s_nop 0
v_mfma_f32_16x16x32_bf16 v[64:67], v[80:83], v[192:195], v[64:67]
v_mfma_f32_16x16x32_bf16 v[68:71], v[80:83], v[196:199], v[68:71]
v_mfma_f32_16x16x32_bf16 v[64:67], v[80:83], v[200:203], v[64:67]
v_mfma_f32_16x16x32_bf16 v[68:71], v[80:83], v[204:207], v[68:71]
s_waitcnt vmcnt(1)
s_nop 0
ds_read_b128 v[224:227], v106 offset:7168
ds_read_b128 v[228:231], v106 offset:25600
ds_read_b128 v[232:235], v107 offset:7168
ds_read_b128 v[236:239], v107 offset:25600
WL 4
s_nop 0
v_mfma_f32_16x16x32_bf16 v[64:67], v[80:83], v[208:211], v[64:67]
v_mfma_f32_16x16x32_bf16 v[68:71], v[80:83], v[212:215], v[68:71]
v_mfma_f32_16x16x32_bf16 v[64:67], v[80:83], v[216:219], v[64:67]
v_mfma_f32_16x16x32_bf16 v[68:71], v[80:83], v[220:223], v[68:71]
s_waitcnt vmcnt(0)
s_nop 0
ds_read_b128 v[240:243], v106 offset:8192
ds_read_b128 v[244:247], v106 offset:26624
ds_read_b128 v[248:251], v107 offset:8192
ds_read_b128 v[252:255], v107 offset:26624
WL 4
s_nop 0
v_mfma_f32_16x16x32_bf16 v[64:67], v[80:83], v[224:227], v[64:67]
v_mfma_f32_16x16x32_bf16 v[68:71], v[80:83], v[228:231], v[68:71]
v_mfma_f32_16x16x32_bf16 v[64:67], v[80:83], v[232:235], v[64:67]
v_mfma_f32_16x16x32_bf16 v[68:71], v[80:83], v[236:239], v[68:71]
WL 0
s_nop 0
v_mfma_f32_16x16x32_bf16 v[64:67], v[80:83], v[240:243], v[64:67]
v_mfma_f32_16x16x32_bf16 v[68:71], v[80:83], v[244:247], v[68:71]
v_mfma_f32_16x16x32_bf16 v[64:67], v[80:83], v[248:251], v[64:67]
v_mfma_f32_16x16x32_bf16 v[68:71], v[80:83], v[252:255], v[68:71]
s_barrier
s_add_u32 m0, s37, 0
s_add_u32 s36, s49, 0
s_nop 0
buffer_load_dwordx4 v1, s[12:15], s36 offen offset:0  lds
buffer_load_dwordx4 v2, s[12:15], s36 offen offset:1024  lds
buffer_load_dwordx4 v3, s[12:15], s36 offen offset:2048  lds
s_add_u32 m0, s37, 12800
s_add_u32 s36, s49, 110592
buffer_load_dwordx4 v1, s[12:15], s36 offen offset:0  lds
buffer_load_dwordx4 v2, s[12:15], s36 offen offset:1024  lds
buffer_load_dwordx4 v3, s[12:15], s36 offen offset:2048  lds
buffer_load_dword v13, v9, s[12:15], s50 offen offset:1152
buffer_load_dword v13, v9, s[12:15], s50 offen offset:2304
s_nop 3
s_mov_b32 s35, 0xbae38e39
v_mul_f32 v78, s35, v64
v_mul_f32_e64 v79, s35, v68
CV 108,78,79
v_lshlrev_b32 v64, 16, v108
v_lshlrev_b32 v65, 16, v108
v_lshlrev_b32 v66, 16, v108
v_lshlrev_b32 v67, 16, v108
v_and_b32 v68, 0xffff0000, v108
v_and_b32 v69, 0xffff0000, v108
v_and_b32 v70, 0xffff0000, v108
v_and_b32 v71, 0xffff0000, v108
v_sub_f32 v14, v78, v64
v_sub_f32 v15, v79, v68
v_mfma_f32_16x16x32_bf16 v[32:35], v[74:77], v[112:115], v[64:67]
v_mfma_f32_16x16x32_bf16 v[36:39], v[72:75], v[112:115], v[64:67]
v_mfma_f32_16x16x32_bf16 v[40:43], v[74:77], v[116:119], v[68:71]
v_mfma_f32_16x16x32_bf16 v[44:47], v[72:75], v[116:119], v[68:71]
v_mfma_f32_16x16x32_bf16 v[48:51], v[74:77], v[120:123], v[64:67]
s_nop 3
s_nop 0
CV 112,32,33
CV 113,34,35
v_mfma_f32_16x16x32_bf16 v[52:55], v[72:75], v[120:123], v[64:67]
CV 114,36,37
CV 115,38,39
v_mfma_f32_16x16x32_bf16 v[56:59], v[74:77], v[124:127], v[68:71]
CV 116,40,41
CV 117,42,43
v_mfma_f32_16x16x32_bf16 v[60:63], v[72:75], v[124:127], v[68:71]
CV 118,44,45
CV 119,46,47
v_mfma_f32_16x16x32_bf16 v[96:99], v[112:115], v[112:115], 0
v_accvgpr_write_b32 a0, v112
v_accvgpr_write_b32 a1, v113
v_mfma_f32_16x16x32_bf16 v[32:35], v[74:77], v[128:131], v[64:67]
CV 120,48,49
CV 121,50,51
v_mfma_f32_16x16x32_bf16 v[36:39], v[72:75], v[128:131], v[64:67]
CV 122,52,53
CV 123,54,55
v_mfma_f32_16x16x32_bf16 v[100:103], v[116:119], v[116:119], 0
v_accvgpr_write_b32 a4, v116
v_accvgpr_write_b32 a5, v117
v_mfma_f32_16x16x32_bf16 v[40:43], v[74:77], v[132:135], v[68:71]
CV 124,56,57
CV 125,58,59
v_mfma_f32_16x16x32_bf16 v[44:47], v[72:75], v[132:135], v[68:71]
CV 126,60,61
CV 127,62,63
v_mfma_f32_16x16x32_bf16 v[96:99], v[120:123], v[120:123], v[96:99]
v_accvgpr_write_b32 a8, v120
v_accvgpr_write_b32 a9, v121
v_mfma_f32_16x16x32_bf16 v[48:51], v[74:77], v[136:139], v[64:67]
CV 128,32,33
CV 129,34,35
v_mfma_f32_16x16x32_bf16 v[52:55], v[72:75], v[136:139], v[64:67]
CV 130,36,37
CV 131,38,39
v_mfma_f32_16x16x32_bf16 v[100:103], v[124:127], v[124:127], v[100:103]
v_accvgpr_write_b32 a12, v124
v_accvgpr_write_b32 a13, v125
v_mfma_f32_16x16x32_bf16 v[56:59], v[74:77], v[140:143], v[68:71]
CV 132,40,41
CV 133,42,43
v_mfma_f32_16x16x32_bf16 v[60:63], v[72:75], v[140:143], v[68:71]
CV 134,44,45
CV 135,46,47
v_mfma_f32_16x16x32_bf16 v[96:99], v[128:131], v[128:131], v[96:99]
v_accvgpr_write_b32 a16, v128
v_accvgpr_write_b32 a17, v129
v_mfma_f32_16x16x32_bf16 v[32:35], v[74:77], v[144:147], v[64:67]
CV 136,48,49
CV 137,50,51
v_mfma_f32_16x16x32_bf16 v[36:39], v[72:75], v[144:147], v[64:67]
CV 138,52,53
CV 139,54,55
v_mfma_f32_16x16x32_bf16 v[100:103], v[132:135], v[132:135], v[100:103]
v_accvgpr_write_b32 a20, v132
v_accvgpr_write_b32 a21, v133
v_mfma_f32_16x16x32_bf16 v[40:43], v[74:77], v[148:151], v[68:71]
CV 140,56,57
CV 141,58,59
v_mfma_f32_16x16x32_bf16 v[44:47], v[72:75], v[148:151], v[68:71]
CV 142,60,61
CV 143,62,63
v_mfma_f32_16x16x32_bf16 v[96:99], v[136:139], v[136:139], v[96:99]
v_accvgpr_write_b32 a24, v136
v_accvgpr_write_b32 a25, v137
v_mfma_f32_16x16x32_bf16 v[48:51], v[74:77], v[152:155], v[64:67]
CV 144,32,33
CV 145,34,35
v_mfma_f32_16x16x32_bf16 v[52:55], v[72:75], v[152:155], v[64:67]
CV 146,36,37
CV 147,38,39
v_mfma_f32_16x16x32_bf16 v[100:103], v[140:143], v[140:143], v[100:103]
v_accvgpr_write_b32 a28, v140
v_accvgpr_write_b32 a29, v141
v_mfma_f32_16x16x32_bf16 v[56:59], v[74:77], v[156:159], v[68:71]
CV 148,40,41
CV 149,42,43
v_mfma_f32_16x16x32_bf16 v[60:63], v[72:75], v[156:159], v[68:71]
CV 150,44,45
CV 151,46,47
v_mfma_f32_16x16x32_bf16 v[96:99], v[144:147], v[144:147], v[96:99]
v_accvgpr_write_b32 a32, v144
v_accvgpr_write_b32 a33, v145
v_mfma_f32_16x16x32_bf16 v[32:35], v[74:77], v[160:163], v[64:67]
CV 152,48,49
CV 153,50,51
v_mfma_f32_16x16x32_bf16 v[36:39], v[72:75], v[160:163], v[64:67]
CV 154,52,53
CV 155,54,55
v_mfma_f32_16x16x32_bf16 v[100:103], v[148:151], v[148:151], v[100:103]
v_accvgpr_write_b32 a36, v148
v_accvgpr_write_b32 a37, v149
v_mfma_f32_16x16x32_bf16 v[40:43], v[74:77], v[164:167], v[68:71]
CV 156,56,57
CV 157,58,59
v_mfma_f32_16x16x32_bf16 v[44:47], v[72:75], v[164:167], v[68:71]
CV 158,60,61
CV 159,62,63
v_mfma_f32_16x16x32_bf16 v[96:99], v[152:155], v[152:155], v[96:99]
v_accvgpr_write_b32 a40, v152
v_accvgpr_write_b32 a41, v153
v_mfma_f32_16x16x32_bf16 v[48:51], v[74:77], v[168:171], v[64:67]
CV 160,32,33
CV 161,34,35
v_mfma_f32_16x16x32_bf16 v[52:55], v[72:75], v[168:171], v[64:67]
CV 162,36,37
CV 163,38,39
v_mfma_f32_16x16x32_bf16 v[100:103], v[156:159], v[156:159], v[100:103]
v_accvgpr_write_b32 a44, v156
v_accvgpr_write_b32 a45, v157
v_mfma_f32_16x16x32_bf16 v[56:59], v[74:77], v[172:175], v[68:71]
CV 164,40,41
CV 165,42,43
v_mfma_f32_16x16x32_bf16 v[60:63], v[72:75], v[172:175], v[68:71]
CV 166,44,45
CV 167,46,47
v_mfma_f32_16x16x32_bf16 v[96:99], v[160:163], v[160:163], v[96:99]
v_accvgpr_write_b32 a48, v160
v_accvgpr_write_b32 a49, v161
v_mfma_f32_16x16x32_bf16 v[32:35], v[74:77], v[176:179], v[64:67]
CV 168,48,49
CV 169,50,51
v_mfma_f32_16x16x32_bf16 v[36:39], v[72:75], v[176:179], v[64:67]
CV 170,52,53
CV 171,54,55
v_mfma_f32_16x16x32_bf16 v[100:103], v[164:167], v[164:167], v[100:103]
v_accvgpr_write_b32 a52, v164
v_accvgpr_write_b32 a53, v165
v_mfma_f32_16x16x32_bf16 v[40:43], v[74:77], v[180:183], v[68:71]
CV 172,56,57
CV 173,58,59
v_mfma_f32_16x16x32_bf16 v[44:47], v[72:75], v[180:183], v[68:71]
CV 174,60,61
CV 175,62,63
v_mfma_f32_16x16x32_bf16 v[96:99], v[168:171], v[168:171], v[96:99]
v_accvgpr_write_b32 a56, v168
v_accvgpr_write_b32 a57, v169
v_mfma_f32_16x16x32_bf16 v[48:51], v[74:77], v[184:187], v[64:67]
CV 176,32,33
CV 177,34,35
v_mfma_f32_16x16x32_bf16 v[52:55], v[72:75], v[184:187], v[64:67]
CV 178,36,37
CV 179,38,39
v_mfma_f32_16x16x32_bf16 v[100:103], v[172:175], v[172:175], v[100:103]
v_accvgpr_write_b32 a60, v172
v_accvgpr_write_b32 a61, v173
v_mfma_f32_16x16x32_bf16 v[56:59], v[74:77], v[188:191], v[68:71]
CV 180,40,41
CV 181,42,43
v_mfma_f32_16x16x32_bf16 v[60:63], v[72:75], v[188:191], v[68:71]
CV 182,44,45
CV 183,46,47
v_mfma_f32_16x16x32_bf16 v[96:99], v[176:179], v[176:179], v[96:99]
v_accvgpr_write_b32 a64, v176
v_accvgpr_write_b32 a65, v177
v_mfma_f32_16x16x32_bf16 v[32:35], v[74:77], v[192:195], v[64:67]
CV 184,48,49
CV 185,50,51
v_mfma_f32_16x16x32_bf16 v[36:39], v[72:75], v[192:195], v[64:67]
CV 186,52,53
CV 187,54,55
v_mfma_f32_16x16x32_bf16 v[100:103], v[180:183], v[180:183], v[100:103]
v_accvgpr_write_b32 a68, v180
v_accvgpr_write_b32 a69, v181
v_mfma_f32_16x16x32_bf16 v[40:43], v[74:77], v[196:199], v[68:71]
CV 188,56,57
CV 189,58,59
v_mfma_f32_16x16x32_bf16 v[44:47], v[72:75], v[196:199], v[68:71]
CV 190,60,61
CV 191,62,63
v_mfma_f32_16x16x32_bf16 v[96:99], v[184:187], v[184:187], v[96:99]
v_accvgpr_write_b32 a72, v184
v_accvgpr_write_b32 a73, v185
v_mfma_f32_16x16x32_bf16 v[48:51], v[74:77], v[200:203], v[64:67]
CV 192,32,33
CV 193,34,35
v_mfma_f32_16x16x32_bf16 v[52:55], v[72:75], v[200:203], v[64:67]
CV 194,36,37
CV 195,38,39
v_mfma_f32_16x16x32_bf16 v[100:103], v[188:191], v[188:191], v[100:103]
v_accvgpr_write_b32 a76, v188
v_accvgpr_write_b32 a77, v189
v_mfma_f32_16x16x32_bf16 v[56:59], v[74:77], v[204:207], v[68:71]
CV 196,40,41
CV 197,42,43
v_mfma_f32_16x16x32_bf16 v[60:63], v[72:75], v[204:207], v[68:71]
CV 198,44,45
CV 199,46,47
v_mfma_f32_16x16x32_bf16 v[96:99], v[192:195], v[192:195], v[96:99]
v_accvgpr_write_b32 a80, v192
v_accvgpr_write_b32 a81, v193
v_mfma_f32_16x16x32_bf16 v[32:35], v[74:77], v[208:211], v[64:67]
CV 200,48,49
CV 201,50,51
v_mfma_f32_16x16x32_bf16 v[36:39], v[72:75], v[208:211], v[64:67]
CV 202,52,53
CV 203,54,55
v_mfma_f32_16x16x32_bf16 v[100:103], v[196:199], v[196:199], v[100:103]
v_accvgpr_write_b32 a84, v196
v_accvgpr_write_b32 a85, v197
v_mfma_f32_16x16x32_bf16 v[40:43], v[74:77], v[212:215], v[68:71]
CV 204,56,57
CV 205,58,59
v_mfma_f32_16x16x32_bf16 v[44:47], v[72:75], v[212:215], v[68:71]
CV 206,60,61
CV 207,62,63
v_mfma_f32_16x16x32_bf16 v[96:99], v[200:203], v[200:203], v[96:99]
v_accvgpr_write_b32 a88, v200
v_accvgpr_write_b32 a89, v201
v_mfma_f32_16x16x32_bf16 v[48:51], v[74:77], v[216:219], v[64:67]
CV 208,32,33
CV 209,34,35
v_mfma_f32_16x16x32_bf16 v[52:55], v[72:75], v[216:219], v[64:67]
CV 210,36,37
CV 211,38,39
v_mfma_f32_16x16x32_bf16 v[100:103], v[204:207], v[204:207], v[100:103]
v_accvgpr_write_b32 a92, v204
v_accvgpr_write_b32 a93, v205
v_mfma_f32_16x16x32_bf16 v[56:59], v[74:77], v[220:223], v[68:71]
CV 212,40,41
CV 213,42,43
v_mfma_f32_16x16x32_bf16 v[60:63], v[72:75], v[220:223], v[68:71]
CV 214,44,45
CV 215,46,47
v_mfma_f32_16x16x32_bf16 v[96:99], v[208:211], v[208:211], v[96:99]
v_accvgpr_write_b32 a96, v208
v_accvgpr_write_b32 a97, v209
v_mfma_f32_16x16x32_bf16 v[32:35], v[74:77], v[224:227], v[64:67]
CV 216,48,49
CV 217,50,51
v_mfma_f32_16x16x32_bf16 v[36:39], v[72:75], v[224:227], v[64:67]
CV 218,52,53
CV 219,54,55
v_mfma_f32_16x16x32_bf16 v[100:103], v[212:215], v[212:215], v[100:103]
v_accvgpr_write_b32 a100, v212
v_accvgpr_write_b32 a101, v213
v_mfma_f32_16x16x32_bf16 v[40:43], v[74:77], v[228:231], v[68:71]
CV 220,56,57
CV 221,58,59
v_mfma_f32_16x16x32_bf16 v[44:47], v[72:75], v[228:231], v[68:71]
CV 222,60,61
CV 223,62,63
v_mfma_f32_16x16x32_bf16 v[96:99], v[216:219], v[216:219], v[96:99]
v_accvgpr_write_b32 a104, v216
v_accvgpr_write_b32 a105, v217
v_mfma_f32_16x16x32_bf16 v[48:51], v[74:77], v[232:235], v[64:67]
CV 224,32,33
CV 225,34,35
v_mfma_f32_16x16x32_bf16 v[52:55], v[72:75], v[232:235], v[64:67]
CV 226,36,37
CV 227,38,39
v_mfma_f32_16x16x32_bf16 v[100:103], v[220:223], v[220:223], v[100:103]
v_accvgpr_write_b32 a108, v220
v_accvgpr_write_b32 a109, v221
v_mfma_f32_16x16x32_bf16 v[56:59], v[74:77], v[236:239], v[68:71]
CV 228,40,41
CV 229,42,43
v_mfma_f32_16x16x32_bf16 v[60:63], v[72:75], v[236:239], v[68:71]
CV 230,44,45
CV 231,46,47
v_mfma_f32_16x16x32_bf16 v[96:99], v[224:227], v[224:227], v[96:99]
v_accvgpr_write_b32 a112, v224
v_accvgpr_write_b32 a113, v225
v_mfma_f32_16x16x32_bf16 v[32:35], v[74:77], v[240:243], v[64:67]
CV 232,48,49
CV 233,50,51
v_mfma_f32_16x16x32_bf16 v[36:39], v[72:75], v[240:243], v[64:67]
CV 234,52,53
CV 235,54,55
v_mfma_f32_16x16x32_bf16 v[100:103], v[228:231], v[228:231], v[100:103]
v_accvgpr_write_b32 a116, v228
v_accvgpr_write_b32 a117, v229
v_mfma_f32_16x16x32_bf16 v[40:43], v[74:77], v[244:247], v[68:71]
CV 236,56,57
CV 237,58,59
v_mfma_f32_16x16x32_bf16 v[44:47], v[72:75], v[244:247], v[68:71]
CV 238,60,61
CV 239,62,63
v_mfma_f32_16x16x32_bf16 v[96:99], v[232:235], v[232:235], v[96:99]
v_accvgpr_write_b32 a120, v232
v_accvgpr_write_b32 a121, v233
v_mfma_f32_16x16x32_bf16 v[48:51], v[74:77], v[248:251], v[64:67]
CV 240,32,33
CV 241,34,35
v_mfma_f32_16x16x32_bf16 v[52:55], v[72:75], v[248:251], v[64:67]
CV 242,36,37
CV 243,38,39
v_mfma_f32_16x16x32_bf16 v[100:103], v[236:239], v[236:239], v[100:103]
v_accvgpr_write_b32 a124, v236
v_accvgpr_write_b32 a125, v237
v_mfma_f32_16x16x32_bf16 v[56:59], v[74:77], v[252:255], v[68:71]
CV 244,40,41
CV 245,42,43
v_mfma_f32_16x16x32_bf16 v[60:63], v[72:75], v[252:255], v[68:71]
CV 246,44,45
CV 247,46,47
v_mfma_f32_16x16x32_bf16 v[96:99], v[240:243], v[240:243], v[96:99]
v_accvgpr_write_b32 a128, v240
v_accvgpr_write_b32 a129, v241
s_nop 3
s_nop 0
CV 248,48,49
CV 249,50,51
CV 250,52,53
CV 251,54,55
v_mfma_f32_16x16x32_bf16 v[100:103], v[244:247], v[244:247], v[100:103]
v_accvgpr_write_b32 a132, v244
v_accvgpr_write_b32 a133, v245
s_nop 3
s_nop 0
CV 252,56,57
CV 253,58,59
CV 254,60,61
CV 255,62,63
v_mfma_f32_16x16x32_bf16 v[96:99], v[248:251], v[248:251], v[96:99]
v_accvgpr_write_b32 a136, v248
v_accvgpr_write_b32 a137, v249
s_nop 3
s_nop 0
v_mfma_f32_16x16x32_bf16 v[100:103], v[252:255], v[252:255], v[100:103]
v_accvgpr_write_b32 a140, v252
v_accvgpr_write_b32 a141, v253
s_mul_i32 s95, s34, 5184
v_lshlrev_b32_e64 v110, 2, v29
v_add_u32 v109, 4096, v110
buffer_load_dword a244, v110, s[28:31], s95 offen offset:0
buffer_load_dword a245, v110, s[28:31], s95 offen offset:1024
buffer_load_dword a246, v110, s[28:31], s95 offen offset:2048
buffer_load_dword a247, v110, s[28:31], s95 offen offset:3072
buffer_load_dword a248, v109, s[28:31], s95 offen offset:0
buffer_load_dword a249, v109, s[28:31], s95 offen offset:1024
v_and_b32 v28, 1, v0
v_cmp_eq_u32 vcc, 1, v28
v_and_b32_e64 v28, 2, v0
v_cmp_eq_u32 s[54:55], 2, v28
v_lshrrev_b32_e64 v28, 2, v23
v_lshl_add_u32 v28, v28, 4, v23
v_lshlrev_b32 v28, 2, v28
s_nop 0
v_cndmask_b32 v96, v96, v97, vcc
v_cndmask_b32 v98, v98, v99, vcc
v_cndmask_b32 v24, v96, v98, s[54:55]
ds_bpermute_b32 v16, v28, v24
v_cndmask_b32 v100, v100, v101, vcc
v_cndmask_b32 v102, v102, v103, vcc
v_cndmask_b32 v25, v100, v102, s[54:55]
ds_bpermute_b32 v17, v28, v25
s_lshr_b32 s101, s2, 3
s_lshl_b32 s101, s101, 2
s_add_u32 s101, s101, s32
s_lshl_b32 s101, s101, 6
s_add_u32 s101, s101, 8192
s_waitcnt vmcnt(8)
s_barrier
RT 144,7,0
RT 146,7,768
RT 148,7,8
RT 150,7,776
RT 152,7,16
RT 154,7,784
RT 156,7,24
RT 158,7,792
RT 160,7,32
RT 162,7,800
RT 164,7,1536
RT 166,7,2304
RT 168,7,1544
RT 170,7,2312
WL 6
s_nop 0
v_mfma_f32_16x16x32_bf16 v[32:35], a[144:147], v[112:115], 0
RT 172,7,1552
RT 174,7,2320
v_mfma_f32_16x16x32_bf16 v[52:55], a[144:147], v[116:119], 0
s_add_u32 m0, s37, 25600
s_add_u32 s36, s49, 221184
v_mfma_f32_16x16x32_bf16 v[56:59], a[148:151], v[116:119], 0
RT 144,7,1560
RT 146,7,2328
v_mfma_f32_16x16x32_bf16 v[36:39], a[148:151], v[112:115], 0
buffer_load_dwordx4 v1, s[12:15], s36 offen offset:0  lds
v_mfma_f32_16x16x32_bf16 v[40:43], a[152:155], v[112:115], 0
RT 148,7,1568
RT 150,7,2336
v_mfma_f32_16x16x32_bf16 v[60:63], a[152:155], v[116:119], 0
s_mov_b32 s35, 0x3ae38e39
v_mul_f32_e64 v14, v14, v14
v_mfma_f32_16x16x32_bf16 v[64:67], a[156:159], v[116:119], 0
RT 152,7,12800
RT 154,7,13568
v_mfma_f32_16x16x32_bf16 v[44:47], a[156:159], v[112:115], 0
WL 6
v_mul_f32 v15, v15, v15
v_mfma_f32_16x16x32_bf16 v[48:51], a[160:163], v[112:115], 0
RT 156,7,12808
RT 158,7,13576
v_mfma_f32_16x16x32_bf16 v[68:71], a[160:163], v[116:119], 0
buffer_load_dwordx4 v2, s[12:15], s36 offen offset:1024  lds
v_mfma_f32_16x16x32_bf16 v[92:95], a[164:167], v[116:119], 0
RT 160,7,12816
RT 162,7,13584
v_mfma_f32_16x16x32_bf16 v[72:75], a[164:167], v[112:115], 0
s_getpc_b64 s[6:7]
s_nop 0
s_load_dword s5, s[6:7], s101
v_mfma_f32_16x16x32_bf16 v[76:79], a[168:171], v[112:115], 0
RT 164,7,12824
RT 166,7,13592
v_mfma_f32_16x16x32_bf16 v[96:99], a[168:171], v[116:119], 0
buffer_load_dwordx4 v3, s[12:15], s36 offen offset:2048  lds
v_mfma_f32_16x16x32_bf16 v[100:103], a[172:175], v[116:119], 0
RT 168,7,12832
RT 170,7,13600
v_mfma_f32_16x16x32_bf16 v[80:83], a[172:175], v[112:115], 0
WL 6
s_nop 0
s_add_u32 m0, s37, 38400
s_add_u32 s36, s49, 331776
v_mfma_f32_16x16x32_bf16 v[84:87], a[144:147], v[112:115], 0
RT 172,7,14336
RT 174,7,15104
v_mfma_f32_16x16x32_bf16 v[104:107], a[144:147], v[116:119], 0
buffer_load_dwordx4 v1, s[12:15], s36 offen offset:0  lds
v_mfma_f32_16x16x32_bf16 v[108:111], a[148:151], v[116:119], 0
RT 144,7,14344
RT 146,7,15112
v_mfma_f32_16x16x32_bf16 v[88:91], a[148:151], v[112:115], 0
v_fma_f32 v16, v16, s35, -v14
v_fma_f32 v17, v17, s35, -v15
MV 32,152,120
RT 148,7,14352
RT 150,7,15120
MV 52,152,124
buffer_load_dwordx4 v2, s[12:15], s36 offen offset:1024  lds
MV 56,156,124
RT 152,7,14360
RT 154,7,15128
MV 36,156,120
WL 6
v_max_f32 v16, 0, v16
MV 40,160,120
RT 156,7,14368
RT 158,7,15136
MV 60,160,124
buffer_load_dwordx4 v3, s[12:15], s36 offen offset:2048  lds
s_waitcnt vmcnt(0)
s_barrier
MV 64,164,124
RT 160,7,25600
RT 162,7,26368
MV 44,164,120
s_add_u32 m0, s37, 51200
s_add_u32 s36, s49, 442368
MV 48,168,120
RT 164,7,25608
RT 166,7,26376
MV 68,168,124
buffer_load_dwordx4 v1, s[12:15], s36 offen offset:0  lds
MV 92,172,124
RT 168,7,25616
RT 170,7,26384
MV 72,172,120
WL 6
v_max_f32 v17, 0, v17
MV 76,144,120
RT 172,7,25624
RT 174,7,26392
MV 96,144,124
buffer_load_dwordx4 v2, s[12:15], s36 offen offset:1024  lds
MV 100,148,124
RT 144,7,25632
RT 146,7,26400
MV 80,148,120
CV 26,16,17
v_lshlrev_b32_e64 v16, 16, v26
MV 84,152,120
RT 148,7,27136
RT 150,7,27904
MV 104,152,124
buffer_load_dwordx4 v3, s[12:15], s36 offen offset:2048  lds
MV 108,156,124
RT 152,7,27144
RT 154,7,27912
MV 88,156,120
WL 6
s_nop 0
s_add_u32 m0, s37, 64000
s_add_u32 s36, s49, 552960
MV 32,160,128
RT 156,7,27152
RT 158,7,27920
MV 52,160,132
buffer_load_dwordx4 v1, s[12:15], s36 offen offset:0  lds
MV 56,164,132
RT 160,7,27160
RT 162,7,27928
MV 36,164,128
v_and_b32 v17, 0xffff0000, v26
v_add_f32 v16, 0x3727c5ac, v16
MV 40,168,128
RT 164,7,27168
RT 166,7,27936
MV 60,168,132
buffer_load_dwordx4 v2, s[12:15], s36 offen offset:1024  lds
MV 64,172,132
RT 168,7,38400
RT 170,7,39168
MV 44,172,128
WL 6
s_nop 0
v_add_f32 v17, 0x3727c5ac, v17
MV 48,144,128
RT 172,7,38408
RT 174,7,39176
MV 68,144,132
buffer_load_dwordx4 v3, s[12:15], s36 offen offset:2048  lds
MV 92,148,132
RT 144,7,38416
RT 146,7,39184
MV 72,148,128
s_add_u32 m0, s37, 76800
s_add_u32 s36, s49, 663552
MV 76,152,128
RT 148,7,38424
RT 150,7,39192
MV 96,152,132
buffer_load_dwordx4 v1, s[12:15], s36 offen offset:0  lds
MV 100,156,132
RT 152,7,38432
RT 154,7,39200
MV 80,156,128
WL 6
s_nop 0
CV 26,16,17
MV 84,160,128
RT 156,7,39936
RT 158,7,40704
MV 104,160,132
buffer_load_dwordx4 v2, s[12:15], s36 offen offset:1024  lds
MV 108,164,132
RT 160,7,39944
RT 162,7,40712
MV 88,164,128
v_lshlrev_b32_e64 v16, 16, v26
v_and_b32 v17, 0xffff0000, v26
MV 32,168,136
RT 164,7,39952
RT 166,7,40720
MV 52,168,140
buffer_load_dwordx4 v3, s[12:15], s36 offen offset:2048  lds
MV 56,172,140
RT 168,7,39960
RT 170,7,40728
MV 36,172,136
WL 6
s_add_u32 m0, s37, 0
s_add_u32 s36, s49, 774144
MV 40,144,136
RT 172,7,39968
RT 174,7,40736
MV 60,144,140
s_waitcnt vmcnt(3)
s_barrier
MV 64,148,140
RT 144,7,51200
RT 146,7,51968
MV 44,148,136
buffer_load_dwordx4 v1, s[12:15], s36 offen offset:0  lds
MV 48,152,136
RT 148,7,51208
RT 150,7,51976
MV 68,152,140
v_sqrt_f32 v16, v16
v_sqrt_f32 v17, v17
s_nop 0
s_nop 0
MV 92,156,140
RT 152,7,51216
RT 154,7,51984
MV 72,156,136
WL 6
CV 26,16,17
v_lshlrev_b32 v16, 16, v26
MV 76,160,136
RT 156,7,51224
RT 158,7,51992
MV 96,160,140
buffer_load_dwordx4 v2, s[12:15], s36 offen offset:1024  lds
MV 100,164,140
RT 160,7,51232
RT 162,7,52000
MV 80,164,136
v_and_b32 v17, 0xffff0000, v26
v_mul_f32 v14, v16, v16
v_mul_f32 v15, v17, v17
MV 84,168,136
RT 164,7,52736
RT 166,7,53504
MV 104,168,140
buffer_load_dwordx4 v3, s[12:15], s36 offen offset:2048  lds
MV 108,172,140
RT 168,7,52744
RT 170,7,53512
MV 88,172,136
WL 6
s_nop 0
s_add_u32 m0, s37, 12800
s_add_u32 s36, s49, 884736
MV 32,144,144
RT 172,7,52752
RT 174,7,53520
MV 52,144,148
s_getpc_b64 s[6:7]
s_nop 0
s_load_dword s5, s[6:7], s101
MV 56,148,148
RT 144,7,52760
RT 146,7,53528
MV 36,148,144
buffer_load_dwordx4 v1, s[12:15], s36 offen offset:0  lds
MV 40,152,144
RT 148,7,52768
RT 150,7,53536
MV 60,152,148
v_accvgpr_write_b32 a240, v14
v_accvgpr_write_b32 a241, v15
MV 64,156,148
RT 152,7,64000
RT 154,7,64768
MV 44,156,144
WL 6
v_rcp_f32 v16, v16
MV 48,160,144
RT 156,7,64008
RT 158,7,64776
MV 68,160,148
buffer_load_dwordx4 v2, s[12:15], s36 offen offset:1024  lds
MV 92,164,148
RT 160,7,64016
RT 162,7,64784
MV 72,164,144
v_rcp_f32 v17, v17
s_nop 0
MV 76,168,144
RT 164,7,64024
RT 166,7,64792
MV 96,168,148
buffer_load_dwordx4 v3, s[12:15], s36 offen offset:2048  lds
MV 100,172,148
RT 168,7,64032
RT 170,7,64800
MV 80,172,144
WL 6
s_nop 0
s_add_u32 m0, s37, 25600
s_add_u32 s36, s49, 995328
MV 84,144,144
RT 172,8,0
RT 174,8,768
MV 104,144,148
v_mul_f32 v14, 0x3fb8aa3b, v16
v_mul_f32 v15, 0x3fb8aa3b, v17
v_accvgpr_write_b32 a2, v114
MV 108,148,148
RT 144,8,8
RT 146,8,776
MV 88,148,144
buffer_load_dwordx4 v1, s[12:15], s36 offen offset:0  lds
MV 32,152,152
RT 148,8,16
RT 150,8,784
MV 52,152,156
v_accvgpr_write_b32 a3, v115
v_accvgpr_write_b32 a6, v118
v_accvgpr_write_b32 a7, v119
MV 56,156,156
RT 152,8,24
RT 154,8,792
MV 36,156,152
WL 6
s_nop 0
v_accvgpr_write_b32 a10, v122
v_accvgpr_write_b32 a11, v123
MV 40,160,152
RT 156,8,32
RT 158,8,800
MV 60,160,156
s_waitcnt vmcnt(4)
s_barrier
MV 64,164,156
RT 160,8,11264
RT 162,8,12032
MV 44,164,152
buffer_load_dwordx4 v2, s[12:15], s36 offen offset:1024  lds
MV 48,168,152
RT 164,8,11272
RT 166,8,12040
MV 68,168,156
v_accvgpr_write_b32 a14, v126
v_accvgpr_write_b32 a15, v127
v_accvgpr_write_b32 a18, v130
MV 92,172,156
RT 168,8,11280
RT 170,8,12048
MV 72,172,152
WL 6
s_nop 0
v_accvgpr_write_b32 a19, v131
v_accvgpr_write_b32 a22, v134
MV 76,144,152
RT 172,8,11288
RT 174,8,12056
MV 96,144,156
buffer_load_dwordx4 v3, s[12:15], s36 offen offset:2048  lds
MV 100,148,156
RT 144,8,11296
RT 146,8,12064
MV 80,148,152
s_add_u32 m0, s37, 38400
s_add_u32 s36, s49, 1105920
MV 84,152,152
RT 148,8,12800
RT 150,8,13568
MV 104,152,156
buffer_load_dwordx4 v1, s[12:15], s36 offen offset:0  lds
MV 108,156,156
RT 152,8,12808
RT 154,8,13576
MV 88,156,152
WL 6
s_nop 0
v_accvgpr_write_b32 a23, v135
v_accvgpr_write_b32 a26, v138
MV 32,160,160
RT 156,8,12816
RT 158,8,13584
MV 52,160,164
buffer_load_dwordx4 v2, s[12:15], s36 offen offset:1024  lds
MV 56,164,164
RT 160,8,12824
RT 162,8,13592
MV 36,164,160
v_accvgpr_write_b32 a27, v139
v_accvgpr_write_b32 a30, v142
v_accvgpr_write_b32 a31, v143
MV 40,168,160
RT 164,8,12832
RT 166,8,13600
MV 60,168,164
buffer_load_dwordx4 v3, s[12:15], s36 offen offset:2048  lds
MV 64,172,164
RT 168,7,0
RT 170,7,768
MV 44,172,160
WL 6
s_nop 0
s_add_u32 m0, s37, 51200
s_add_u32 s36, s49, 1216512
MV 48,144,160
RT 172,7,8
RT 174,7,776
MV 68,144,164
v_accvgpr_write_b32 a34, v146
v_accvgpr_write_b32 a35, v147
v_accvgpr_write_b32 a38, v150
MV 92,148,164
RT 144,7,16
RT 146,7,784
MV 72,148,160
buffer_load_dwordx4 v1, s[12:15], s36 offen offset:0  lds
MV 76,152,160
RT 148,7,24
RT 150,7,792
MV 96,152,164
v_accvgpr_write_b32 a39, v151
v_accvgpr_write_b32 a42, v154
v_accvgpr_write_b32 a43, v155
MV 100,156,164
RT 152,7,32
RT 154,7,800
MV 80,156,160
WL 6
s_nop 0
v_accvgpr_write_b32 a46, v158
v_accvgpr_write_b32 a47, v159
MV 84,160,160
RT 156,7,1536
RT 158,7,2304
MV 104,160,164
buffer_load_dwordx4 v2, s[12:15], s36 offen offset:1024  lds
MV 108,164,164
RT 160,7,1544
RT 162,7,2312
MV 88,164,160
v_accvgpr_write_b32 a50, v162
v_accvgpr_write_b32 a51, v163
v_accvgpr_write_b32 a54, v166
MV 32,168,168
RT 164,7,1552
RT 166,7,2320
MV 52,168,172
v_accvgpr_write_b32 a55, v167
v_accvgpr_write_b32 a58, v170
v_accvgpr_write_b32 a59, v171
MV 56,172,172
RT 168,7,1560
RT 170,7,2328
MV 36,172,168
WL 6
s_nop 0
v_accvgpr_write_b32 a62, v174
v_accvgpr_write_b32 a63, v175
MV 40,144,168
RT 172,7,1568
RT 174,7,2336
MV 60,144,172
s_waitcnt vmcnt(5)
s_barrier
MV 64,148,172
RT 144,7,12800
RT 146,7,13568
MV 44,148,168
s_getpc_b64 s[6:7]
s_nop 0
s_load_dword s5, s[6:7], s101
MV 48,152,168
RT 148,7,12808
RT 150,7,13576
MV 68,152,172
buffer_load_dwordx4 v3, s[12:15], s36 offen offset:2048  lds
MV 92,156,172
RT 152,7,12816
RT 154,7,13584
MV 72,156,168
WL 6
s_nop 0
s_add_u32 m0, s37, 64000
s_add_u32 s36, s49, 1327104
MV 76,160,168
RT 156,7,12824
RT 158,7,13592
MV 96,160,172
buffer_load_dwordx4 v1, s[12:15], s36 offen offset:0  lds
MV 100,164,172
RT 160,7,12832
RT 162,7,13600
MV 80,164,168
v_accvgpr_write_b32 a66, v178
v_accvgpr_write_b32 a67, v179
v_accvgpr_write_b32 a70, v182
MV 84,168,168
RT 164,7,14336
RT 166,7,15104
MV 104,168,172
buffer_load_dwordx4 v2, s[12:15], s36 offen offset:1024  lds
MV 108,172,172
RT 168,7,14344
RT 170,7,15112
MV 88,172,168
WL 6
s_nop 0
v_accvgpr_write_b32 a71, v183
v_accvgpr_write_b32 a74, v186
MV 32,144,176
RT 172,7,14352
RT 174,7,15120
MV 52,144,180
buffer_load_dwordx4 v3, s[12:15], s36 offen offset:2048  lds
MV 56,148,180
RT 144,7,14360
RT 146,7,15128
MV 36,148,176
s_add_u32 m0, s37, 76800
s_add_u32 s36, s49, 1437696
MV 40,152,176
RT 148,7,14368
RT 150,7,15136
MV 60,152,180
v_accvgpr_write_b32 a75, v187
v_accvgpr_write_b32 a78, v190
v_accvgpr_write_b32 a79, v191
MV 64,156,180
RT 152,7,25600
RT 154,7,26368
MV 44,156,176
WL 6
s_nop 0
v_accvgpr_write_b32 a82, v194
v_accvgpr_write_b32 a83, v195
MV 48,160,176
RT 156,7,25608
RT 158,7,26376
MV 68,160,180
buffer_load_dwordx4 v1, s[12:15], s36 offen offset:0  lds
MV 92,164,180
RT 160,7,25616
RT 162,7,26384
MV 72,164,176
v_accvgpr_write_b32 a86, v198
v_accvgpr_write_b32 a87, v199
v_accvgpr_write_b32 a90, v202
MV 76,168,176
RT 164,7,25624
RT 166,7,26392
MV 96,168,180
v_accvgpr_write_b32 a91, v203
v_accvgpr_write_b32 a94, v206
v_accvgpr_write_b32 a95, v207
MV 100,172,180
RT 168,7,25632
RT 170,7,26400
MV 80,172,176
WL 6
s_nop 0
v_accvgpr_write_b32 a98, v210
v_accvgpr_write_b32 a99, v211
MV 84,144,176
RT 172,7,27136
RT 174,7,27904
MV 104,144,180
buffer_load_dwordx4 v2, s[12:15], s36 offen offset:1024  lds
MV 108,148,180
RT 144,7,27144
RT 146,7,27912
MV 88,148,176
v_accvgpr_write_b32 a102, v214
v_accvgpr_write_b32 a103, v215
v_accvgpr_write_b32 a106, v218
MV 32,152,184
RT 148,7,27152
RT 150,7,27920
MV 52,152,188
v_accvgpr_write_b32 a107, v219
v_accvgpr_write_b32 a110, v222
v_accvgpr_write_b32 a111, v223
MV 56,156,188
RT 152,7,27160
RT 154,7,27928
MV 36,156,184
WL 6
s_nop 0
v_accvgpr_write_b32 a114, v226
v_accvgpr_write_b32 a115, v227
MV 40,160,184
RT 156,7,27168
RT 158,7,27936
MV 60,160,188
s_waitcnt vmcnt(5)
s_barrier
MV 64,164,188
RT 160,7,38400
RT 162,7,39168
MV 44,164,184
buffer_load_dwordx4 v3, s[12:15], s36 offen offset:2048  lds
MV 48,168,184
RT 164,7,38408
RT 166,7,39176
MV 68,168,188
s_add_u32 m0, s37, 0
s_nop 0
s_add_u32 s36, s49, 1548288
MV 92,172,188
RT 168,7,38416
RT 170,7,39184
MV 72,172,184
WL 6
s_nop 0
v_accvgpr_write_b32 a118, v230
v_accvgpr_write_b32 a119, v231
MV 76,144,184
RT 172,7,38424
RT 174,7,39192
MV 96,144,188
buffer_load_dwordx4 v1, s[12:15], s36 offen offset:0  lds
MV 100,148,188
RT 144,7,38432
RT 146,7,39200
MV 80,148,184
v_accvgpr_write_b32 a122, v234
v_accvgpr_write_b32 a123, v235
v_accvgpr_write_b32 a126, v238
MV 84,152,184
RT 148,7,39936
RT 150,7,40704
MV 104,152,188
buffer_load_dwordx4 v2, s[12:15], s36 offen offset:1024  lds
MV 108,156,188
RT 152,7,39944
RT 154,7,40712
MV 88,156,184
WL 6
s_nop 0
v_accvgpr_write_b32 a127, v239
v_accvgpr_write_b32 a130, v242
MV 32,160,192
RT 156,7,39952
RT 158,7,40720
MV 52,160,196
buffer_load_dwordx4 v3, s[12:15], s36 offen offset:2048  lds
MV 56,164,196
RT 160,7,39960
RT 162,7,40728
MV 36,164,192
s_add_u32 m0, s37, 12800
s_add_u32 s36, s49, 1658880
MV 40,168,192
RT 164,7,39968
RT 166,7,40736
MV 60,168,196
v_accvgpr_write_b32 a131, v243
v_accvgpr_write_b32 a134, v246
v_accvgpr_write_b32 a135, v247
MV 64,172,196
RT 168,7,51200
RT 170,7,51968
MV 44,172,192
WL 6
s_nop 0
v_accvgpr_write_b32 a138, v250
v_accvgpr_write_b32 a139, v251
MV 48,144,192
RT 172,7,51208
RT 174,7,51976
MV 68,144,196
buffer_load_dwordx4 v1, s[12:15], s36 offen offset:0  lds
MV 92,148,196
RT 144,7,51216
RT 146,7,51984
MV 72,148,192
v_accvgpr_write_b32 a142, v254
v_accvgpr_write_b32 a143, v255
s_waitcnt vmcnt(40)
s_nop 0
MV 76,152,192
RT 148,7,51224
RT 150,7,51992
MV 96,152,196
v_accvgpr_read_b32 v24, a250
ds_write_b32 v24, a244
MV 100,156,196
RT 152,7,51232
RT 154,7,52000
MV 80,156,192
WL 7
s_nop 0
v_accvgpr_read_b32 v25, a251
MV 84,160,192
RT 156,7,52736
RT 158,7,53504
MV 104,160,196
s_getpc_b64 s[6:7]
s_nop 0
s_load_dword s5, s[6:7], s101
MV 108,164,196
RT 160,7,52744
RT 162,7,53512
MV 88,164,192
buffer_load_dwordx4 v2, s[12:15], s36 offen offset:1024  lds
MV 32,168,200
RT 164,7,52752
RT 166,7,53520
MV 52,168,204
ds_write_b32 v25, a245
v_accvgpr_read_b32 v26, a252
MV 56,172,204
RT 168,7,52760
RT 170,7,53528
MV 36,172,200
WL 7
s_nop 0
ds_write_b32 v26, a246
MV 40,144,200
RT 172,7,52768
RT 174,7,53536
MV 60,144,204
s_waitcnt vmcnt(5)
s_barrier
MV 64,148,204
RT 144,7,64000
RT 146,7,64768
MV 44,148,200
buffer_load_dwordx4 v3, s[12:15], s36 offen offset:2048  lds
MV 48,152,200
RT 148,7,64008
RT 150,7,64776
MV 68,152,204
s_add_u32 m0, s37, 25600
s_add_u32 s36, s49, 1769472
MV 92,156,204
RT 152,7,64016
RT 154,7,64784
MV 72,156,200
WL 6
s_nop 0
v_accvgpr_read_b32 v27, a253
MV 76,160,200
RT 156,7,64024
RT 158,7,64792
MV 96,160,204
buffer_load_dwordx4 v1, s[12:15], s36 offen offset:0  lds
MV 100,164,204
RT 160,7,64032
RT 162,7,64800
MV 80,164,200
ds_write_b32 v27, a247
v_accvgpr_read_b32 v24, a254
MV 84,168,200
RT 164,8,0
RT 166,8,768
MV 104,168,204
buffer_load_dwordx4 v2, s[12:15], s36 offen offset:1024  lds
MV 108,172,204
RT 168,8,8
RT 170,8,776
MV 88,172,200
WL 7
s_nop 0
ds_write_b32 v24, a248
MV 32,144,208
RT 172,8,16
RT 174,8,784
MV 52,144,212
buffer_load_dwordx4 v3, s[12:15], s36 offen offset:2048  lds
MV 56,148,212
RT 144,8,24
RT 146,8,792
MV 36,148,208
s_add_u32 m0, s37, 38400
s_add_u32 s36, s49, 1880064
MV 40,152,208
RT 148,8,32
RT 150,8,800
MV 60,152,212
v_accvgpr_read_b32 v25, a255
ds_write_b32 v25, a249
MV 64,156,212
RT 152,8,11264
RT 154,8,12032
MV 44,156,208
WL 7
s_nop 0
MV 48,160,208
RT 156,8,11272
RT 158,8,12040
MV 68,160,212
buffer_load_dwordx4 v1, s[12:15], s36 offen offset:0  lds
MV 92,164,212
RT 160,8,11280
RT 162,8,12048
MV 72,164,208
MV 76,168,208
RT 164,8,11288
RT 166,8,12056
MV 96,168,212
MV 100,172,212
RT 168,8,11296
RT 170,8,12064
MV 80,172,208
WL 6
s_nop 0
MV 84,144,208
RT 172,8,12800
RT 174,8,13568
MV 104,144,212
buffer_load_dwordx4 v2, s[12:15], s36 offen offset:1024  lds
MV 108,148,212
RT 144,8,12808
RT 146,8,13576
MV 88,148,208
MV 32,152,216
RT 148,8,12816
RT 150,8,13584
MV 52,152,220
MV 56,156,220
RT 152,8,12824
RT 154,8,13592
MV 36,156,216
WL 6
s_nop 0
MV 40,160,216
RT 156,8,12832
RT 158,8,13600
MV 60,160,220
WL 15
s_waitcnt vmcnt(5)
s_barrier
s_nop 0
MV 64,164,220
RT 160,7,0
RT 162,7,768
MV 44,164,216
buffer_load_dwordx4 v3, s[12:15], s36 offen offset:2048  lds
MV 48,168,216
RT 164,7,8
RT 166,7,776
MV 68,168,220
s_add_u32 m0, s37, 51200
s_add_u32 s36, s49, 128
MV 92,172,220
RT 168,7,16
RT 170,7,784
MV 72,172,216
WL 6
v_mov_b32 v29, v18
RT 176,29,0
MV 76,144,216
RT 172,7,24
RT 174,7,792
MV 96,144,220
buffer_load_dwordx4 v1, s[12:15], s36 offen offset:0  lds
RT 178,29,160
MV 100,148,220
RT 144,7,32
RT 146,7,800
MV 80,148,216
RT 180,29,8
RT 182,29,168
RT 184,29,16
MV 84,152,216
RT 148,7,1536
RT 150,7,2304
MV 104,152,220
buffer_load_dwordx4 v2, s[12:15], s36 offen offset:1024  lds
RT 186,29,176
MV 108,156,220
RT 152,7,1544
RT 154,7,2312
MV 88,156,216
WL 11
s_nop 0
RT 188,29,24
RT 190,29,184
MV 32,160,224
RT 156,7,1552
RT 158,7,2320
MV 52,160,228
buffer_load_dwordx4 v3, s[12:15], s36 offen offset:2048  lds
RT 192,29,32
MV 56,164,228
RT 160,7,1560
RT 162,7,2328
MV 36,164,224
s_getpc_b64 s[6:7]
s_nop 0
s_load_dword s5, s[6:7], s101
MV 40,168,224
RT 164,7,1568
RT 166,7,2336
MV 60,168,228
s_add_u32 m0, s37, 64000
s_add_u32 s36, s49, 110720
RT 194,29,192
MV 64,172,228
RT 168,7,12800
RT 170,7,13568
MV 44,172,224
WL 8
v_add_u32 v29, v29, v19
RT 196,29,0
MV 48,144,224
RT 172,7,12808
RT 174,7,13576
MV 68,144,228
buffer_load_dwordx4 v1, s[12:15], s36 offen offset:0  lds
RT 198,29,160
MV 92,148,228
RT 144,7,12816
RT 146,7,13584
MV 72,148,224
RT 200,29,8
RT 202,29,168
RT 204,29,16
MV 76,152,224
RT 148,7,12824
RT 150,7,13592
MV 96,152,228
RT 206,29,176
RT 208,29,24
RT 210,29,184
MV 100,156,228
RT 152,7,12832
RT 154,7,13600
MV 80,156,224
WL 13
s_nop 0
RT 212,29,32
RT 214,29,192
MV 84,160,224
RT 156,7,14336
RT 158,7,15104
MV 104,160,228
buffer_load_dwordx4 v2, s[12:15], s36 offen offset:1024  lds
v_add_u32_e64 v29, v29, v19
MV 108,164,228
RT 160,7,14344
RT 162,7,15112
MV 88,164,224
RT 216,29,0
RT 218,29,160
RT 220,29,8
MV 32,168,232
RT 164,7,14352
RT 166,7,15120
MV 52,168,236
RT 222,29,168
RT 224,29,16
RT 226,29,176
MV 56,172,236
RT 168,7,14360
RT 170,7,15128
MV 36,172,232
WL 12
s_nop 0
RT 228,29,24
RT 230,29,184
MV 40,144,232
RT 172,7,14368
RT 174,7,15136
MV 60,144,236
s_waitcnt vmcnt(5)
s_barrier
MV 64,148,236
RT 144,7,25600
RT 146,7,26368
MV 44,148,232
buffer_load_dwordx4 v3, s[12:15], s36 offen offset:2048  lds
RT 232,29,32
MV 48,152,232
RT 148,7,25608
RT 150,7,26376
MV 68,152,236
s_add_u32 m0, s37, 76800
s_add_u32 s36, s49, 221312
RT 234,29,192
MV 92,156,236
RT 152,7,25616
RT 154,7,26384
MV 72,156,232
WL 8
s_nop 0
MV 76,160,232
RT 156,7,25624
RT 158,7,26392
MV 96,160,236
buffer_load_dwordx4 v1, s[12:15], s36 offen offset:0  lds
MV 100,164,236
RT 160,7,25632
RT 162,7,26400
MV 80,164,232
MV 84,168,232
RT 164,7,27136
RT 166,7,27904
MV 104,168,236
buffer_load_dwordx4 v2, s[12:15], s36 offen offset:1024  lds
MV 108,172,236
RT 168,7,27144
RT 170,7,27912
MV 88,172,232
WL 6
s_nop 0
MV 32,144,240
RT 172,7,27152
RT 174,7,27920
MV 52,144,244
buffer_load_dwordx4 v3, s[12:15], s36 offen offset:2048  lds
MV 56,148,244
RT 144,7,27160
RT 146,7,27928
MV 36,148,240
s_add_u32 m0, s37, 0
s_nop 0
s_add_u32 s36, s49, 331904
MV 40,152,240
RT 148,7,27168
RT 150,7,27936
MV 60,152,244
MV 64,156,244
RT 152,7,38400
RT 154,7,39168
MV 44,156,240
WL 6
s_nop 0
MV 48,160,240
RT 156,7,38408
RT 158,7,39176
MV 68,160,244
buffer_load_dwordx4 v1, s[12:15], s36 offen offset:0  lds
MV 92,164,244
RT 160,7,38416
RT 162,7,39184
MV 72,164,240
MV 76,168,240
RT 164,7,38424
RT 166,7,39192
MV 96,168,244
MV 100,172,244
RT 168,7,38432
RT 170,7,39200
MV 80,172,240
WL 6
s_nop 0
MV 84,144,240
RT 172,7,39936
RT 174,7,40704
MV 104,144,244
buffer_load_dwordx4 v2, s[12:15], s36 offen offset:1024  lds
MV 108,148,244
RT 144,7,39944
RT 146,7,40712
MV 88,148,240
MV 32,152,248
RT 148,7,39952
RT 150,7,40720
MV 52,152,252
MV 56,156,252
RT 152,7,39960
RT 154,7,40728
MV 36,156,248
WL 6
s_nop 0
MV 40,160,248
RT 156,7,39968
RT 158,7,40736
MV 60,160,252
buffer_load_dwordx4 v3, s[12:15], s36 offen offset:2048  lds
MV 64,164,252
MV 44,164,248
MV 48,168,248
MV 68,168,252
MV 92,172,252
MV 72,172,248
WL 0
s_nop 0
MV 76,144,248
MV 96,144,252
MV 100,148,252
MV 80,148,248
MV 84,152,248
MV 104,152,252
MV 108,156,252
MV 88,156,248
s_lshl_b32 s96, s32, 6
v_add_u32 v28, s96, v0
v_cmp_gt_u32 vcc, 16, v28
v_lshlrev_b32 v250, 2, v0
v_mov_b32 v28, 0x40000000
v_cndmask_b32 v250, v28, v250, vcc
buffer_load_dword v13, v250, s[20:23], s52 offen sc1
buffer_load_dword v13, v250, s[20:23], s46 offen sc1
buffer_load_dword v13, v250, s[20:23], s44 offen sc1
buffer_load_dword v251, v250, s[24:27], 0 offen sc1
buffer_load_dword v13, v9, s[12:15], s50 offen offset:0
s_waitcnt vmcnt(11)
s_barrier
RT 160,7,51216
RT 162,7,51984
RT 164,7,51224
RT 166,7,51992
RT 168,7,51232
RT 170,7,52000
RT 172,7,51240
RT 174,7,52008
RT 144,7,51248
RT 146,7,52016
RT 148,7,52752
RT 150,7,53520
RT 152,7,52760
RT 154,7,53528
s_nop 3
v_mov_b32 v122, 0
v_mov_b32 v123, 0
v_mov_b32 v134, 0
v_mov_b32_e64 v135, 0
CV 112,32,33
CV 113,34,35
CV 114,36,37
CV 115,38,39
CV 116,40,41
CV 117,42,43
CV 118,44,45
CV 119,46,47
CV 120,48,49
CV 121,50,51
CV 124,52,53
CV 125,54,55
CV 126,56,57
CV 127,58,59
CV 128,60,61
CV 129,62,63
CV 130,64,65
CV 131,66,67
CV 132,68,69
CV 133,70,71
WL 15
s_nop 0
v_pk_mul_f32 v[72:73], v[72:73], v[16:17] op_sel:[0,0] op_sel_hi:[1,0]
v_pk_mul_f32 v[74:75], v[74:75], v[16:17] op_sel:[0,0] op_sel_hi:[1,0]
v_pk_mul_f32 v[76:77], v[76:77], v[16:17] op_sel:[0,0] op_sel_hi:[1,0]
v_pk_mul_f32 v[78:79], v[78:79], v[16:17] op_sel:[0,0] op_sel_hi:[1,0]
v_pk_mul_f32 v[80:81], v[80:81], v[16:17] op_sel:[0,0] op_sel_hi:[1,0]
v_pk_mul_f32 v[82:83], v[82:83], v[16:17] op_sel:[0,0] op_sel_hi:[1,0]
v_pk_mul_f32 v[84:85], v[84:85], v[16:17] op_sel:[0,0] op_sel_hi:[1,0]
v_pk_mul_f32 v[86:87], v[86:87], v[16:17] op_sel:[0,0] op_sel_hi:[1,0]
v_pk_mul_f32 v[88:89], v[88:89], v[16:17] op_sel:[0,0] op_sel_hi:[1,0]
v_pk_mul_f32 v[90:91], v[90:91], v[16:17] op_sel:[0,0] op_sel_hi:[1,0]
v_pk_mul_f32 v[92:93], v[92:93], v[16:17] op_sel:[0,1] op_sel_hi:[1,1]
v_pk_mul_f32 v[94:95], v[94:95], v[16:17] op_sel:[0,1] op_sel_hi:[1,1]
v_pk_mul_f32 v[96:97], v[96:97], v[16:17] op_sel:[0,1] op_sel_hi:[1,1]
v_pk_mul_f32 v[98:99], v[98:99], v[16:17] op_sel:[0,1] op_sel_hi:[1,1]
v_pk_mul_f32 v[100:101], v[100:101], v[16:17] op_sel:[0,1] op_sel_hi:[1,1]
v_pk_mul_f32 v[102:103], v[102:103], v[16:17] op_sel:[0,1] op_sel_hi:[1,1]
v_pk_mul_f32 v[104:105], v[104:105], v[16:17] op_sel:[0,1] op_sel_hi:[1,1]
v_pk_mul_f32 v[106:107], v[106:107], v[16:17] op_sel:[0,1] op_sel_hi:[1,1]
v_pk_mul_f32 v[108:109], v[108:109], v[16:17] op_sel:[0,1] op_sel_hi:[1,1]
v_pk_mul_f32 v[110:111], v[110:111], v[16:17] op_sel:[0,1] op_sel_hi:[1,1]
s_nop 0
s_nop 0
v_mfma_f32_16x16x32_bf16 v[136:139], a[176:179], v[112:115], 0
v_mov_b32 v28, 0x3f80
CV 194,72,73
v_mfma_f32_16x16x32_bf16 v[156:159], a[176:179], v[124:127], 0
CV 195,74,75
CV 196,76,77
v_mfma_f32_16x16x32_bf16 v[140:143], a[180:183], v[112:115], 0
CV 197,78,79
CV 198,80,81
v_mfma_f32_16x16x32_bf16 v[160:163], a[180:183], v[124:127], 0
CV 199,82,83
CV 200,84,85
v_mfma_f32_16x16x32_bf16 v[144:147], a[184:187], v[112:115], 0
CV 201,86,87
CV 202,88,89
v_mfma_f32_16x16x32_bf16 v[164:167], a[184:187], v[124:127], 0
CV 203,90,91
v_cndmask_b32 v194, v194, v28, s[42:43]
v_mfma_f32_16x16x32_bf16 v[148:151], a[188:191], v[112:115], 0
v_cndmask_b32 v203, v28, v203, s[42:43]
CV 222,92,93
v_mfma_f32_16x16x32_bf16 v[168:171], a[188:191], v[124:127], 0
CV 223,94,95
CV 224,96,97
v_mfma_f32_16x16x32_bf16 v[152:155], a[192:195], v[112:115], 0
CV 225,98,99
CV 226,100,101
v_mfma_f32_16x16x32_bf16 v[172:175], a[192:195], v[124:127], 0
CV 227,102,103
CV 228,104,105
MV 136,196,116
CV 229,106,107
CV 230,108,109
MV 156,196,128
CV 231,110,111
v_cndmask_b32 v222, v222, v28, s[42:43]
MV 140,200,116
v_cndmask_b32 v231, v28, v231, s[42:43]
MV 160,200,128
MV 144,204,116
MV 164,204,128
MV 148,208,116
MV 168,208,128
MV 152,212,116
MV 172,212,128
MV 136,216,120
MV 156,216,132
MV 140,220,120
MV 160,220,132
MV 144,224,120
MV 164,224,132
MV 148,228,120
MV 168,228,132
MV 152,232,120
MV 172,232,132
WL 6
s_nop 0
v_mfma_f32_16x16x32_bf16 v[32:35], a[160:163], a[0:3], 0
RT 156,7,52768
RT 158,7,53536
v_mfma_f32_16x16x32_bf16 v[52:55], a[160:163], a[4:7], 0
s_add_u32 m0, s37, 12800
s_add_u32 s36, s49, 442496
v_mfma_f32_16x16x32_bf16 v[56:59], a[164:167], a[4:7], 0
RT 160,7,52776
RT 162,7,53544
v_mfma_f32_16x16x32_bf16 v[36:39], a[164:167], a[0:3], 0
v_mfma_f32_16x16x32_bf16 v[40:43], a[168:171], a[0:3], 0
RT 164,7,52784
RT 166,7,53552
v_mfma_f32_16x16x32_bf16 v[60:63], a[168:171], a[4:7], 0
v_max3_f32 v24, v136, v137, v138
v_min3_f32 v25, v136, v137, v138
v_mfma_f32_16x16x32_bf16 v[64:67], a[172:175], a[4:7], 0
RT 168,7,64016
RT 170,7,64784
v_mfma_f32_16x16x32_bf16 v[44:47], a[172:175], a[0:3], 0
WL 6
s_nop 0
v_max3_f32 v24, v24, v139, v140
v_min3_f32 v25, v25, v139, v140
v_max3_f32 v24, v24, v141, v142
v_mfma_f32_16x16x32_bf16 v[48:51], a[144:147], a[0:3], 0
RT 172,7,64024
RT 174,7,64792
v_mfma_f32_16x16x32_bf16 v[68:71], a[144:147], a[4:7], 0
v_min3_f32 v25, v25, v141, v142
v_max3_f32 v24, v24, v143, v144
v_min3_f32 v25, v25, v143, v144
v_max3_f32 v24, v24, v145, v146
v_mfma_f32_16x16x32_bf16 v[92:95], a[148:151], a[4:7], 0
RT 144,7,64032
RT 146,7,64800
v_mfma_f32_16x16x32_bf16 v[72:75], a[148:151], a[0:3], 0
s_getpc_b64 s[6:7]
s_nop 0
s_load_dword s5, s[6:7], s101
v_mfma_f32_16x16x32_bf16 v[76:79], a[152:155], a[0:3], 0
RT 148,7,64040
RT 150,7,64808
v_mfma_f32_16x16x32_bf16 v[96:99], a[152:155], a[4:7], 0
v_min3_f32 v25, v25, v145, v146
v_max3_f32 v24, v24, v147, v148
v_min3_f32 v25, v25, v147, v148
v_max3_f32 v24, v24, v149, v150
v_mfma_f32_16x16x32_bf16 v[100:103], a[156:159], a[4:7], 0
RT 152,7,64048
RT 154,7,64816
v_mfma_f32_16x16x32_bf16 v[80:83], a[156:159], a[0:3], 0
WL 6
s_nop 0
v_min3_f32 v25, v25, v149, v150
v_max3_f32 v24, v24, v151, v152
v_min3_f32 v25, v25, v151, v152
v_mfma_f32_16x16x32_bf16 v[84:87], a[160:163], a[0:3], 0
RT 156,8,16
RT 158,8,784
v_mfma_f32_16x16x32_bf16 v[104:107], a[160:163], a[4:7], 0
v_max_f32 v24, v24, v153
v_min_f32 v25, v25, v153
v_pk_mul_f32 v[24:25], v[24:25], v[14:15] op_sel:[0,0] op_sel_hi:[1,0]
v_pk_fma_f32 v[232:233], v[136:137], v[14:15], v[24:25] op_sel:[0,0,0] op_sel_hi:[1,0,0] neg_lo:[0,0,1] neg_hi:[0,0,1]
v_pk_fma_f32 v[136:137], v[136:137], v[14:15], v[24:25] op_sel:[0,0,1] op_sel_hi:[1,0,1] neg_lo:[0,1,0] neg_hi:[0,1,0]
v_pk_fma_f32 v[234:235], v[138:139], v[14:15], v[24:25] op_sel:[0,0,0] op_sel_hi:[1,0,0] neg_lo:[0,0,1] neg_hi:[0,0,1]
v_pk_fma_f32 v[138:139], v[138:139], v[14:15], v[24:25] op_sel:[0,0,1] op_sel_hi:[1,0,1] neg_lo:[0,1,0] neg_hi:[0,1,0]
v_pk_fma_f32 v[236:237], v[140:141], v[14:15], v[24:25] op_sel:[0,0,0] op_sel_hi:[1,0,0] neg_lo:[0,0,1] neg_hi:[0,0,1]
v_pk_fma_f32 v[140:141], v[140:141], v[14:15], v[24:25] op_sel:[0,0,1] op_sel_hi:[1,0,1] neg_lo:[0,1,0] neg_hi:[0,1,0]
v_pk_fma_f32 v[238:239], v[142:143], v[14:15], v[24:25] op_sel:[0,0,0] op_sel_hi:[1,0,0] neg_lo:[0,0,1] neg_hi:[0,0,1]
v_pk_fma_f32 v[142:143], v[142:143], v[14:15], v[24:25] op_sel:[0,0,1] op_sel_hi:[1,0,1] neg_lo:[0,1,0] neg_hi:[0,1,0]
v_pk_fma_f32 v[240:241], v[144:145], v[14:15], v[24:25] op_sel:[0,0,0] op_sel_hi:[1,0,0] neg_lo:[0,0,1] neg_hi:[0,0,1]
v_pk_fma_f32 v[144:145], v[144:145], v[14:15], v[24:25] op_sel:[0,0,1] op_sel_hi:[1,0,1] neg_lo:[0,1,0] neg_hi:[0,1,0]
v_pk_fma_f32 v[242:243], v[146:147], v[14:15], v[24:25] op_sel:[0,0,0] op_sel_hi:[1,0,0] neg_lo:[0,0,1] neg_hi:[0,0,1]
v_pk_fma_f32 v[146:147], v[146:147], v[14:15], v[24:25] op_sel:[0,0,1] op_sel_hi:[1,0,1] neg_lo:[0,1,0] neg_hi:[0,1,0]
v_pk_fma_f32 v[244:245], v[148:149], v[14:15], v[24:25] op_sel:[0,0,0] op_sel_hi:[1,0,0] neg_lo:[0,0,1] neg_hi:[0,0,1]
v_pk_fma_f32 v[148:149], v[148:149], v[14:15], v[24:25] op_sel:[0,0,1] op_sel_hi:[1,0,1] neg_lo:[0,1,0] neg_hi:[0,1,0]
v_pk_fma_f32 v[246:247], v[150:151], v[14:15], v[24:25] op_sel:[0,0,0] op_sel_hi:[1,0,0] neg_lo:[0,0,1] neg_hi:[0,0,1]
v_pk_fma_f32 v[150:151], v[150:151], v[14:15], v[24:25] op_sel:[0,0,1] op_sel_hi:[1,0,1] neg_lo:[0,1,0] neg_hi:[0,1,0]
v_pk_fma_f32 v[248:249], v[152:153], v[14:15], v[24:25] op_sel:[0,0,0] op_sel_hi:[1,0,0] neg_lo:[0,0,1] neg_hi:[0,0,1]
v_pk_fma_f32 v[152:153], v[152:153], v[14:15], v[24:25] op_sel:[0,0,1] op_sel_hi:[1,0,1] neg_lo:[0,1,0] neg_hi:[0,1,0]
s_nop 0
s_nop 0
v_mfma_f32_16x16x32_bf16 v[108:111], a[164:167], a[4:7], 0
RT 160,8,24
RT 162,8,792
v_mfma_f32_16x16x32_bf16 v[88:91], a[164:167], a[0:3], 0
v_exp_f32 v232, v232
v_exp_f32 v136, v136
MA 32,168,8
RT 164,8,32
RT 166,8,800
MA 52,168,12
v_exp_f32 v233, v233
v_exp_f32 v137, v137
MA 56,172,12
RT 168,8,40
RT 170,8,808
MA 36,172,8
WL 6
v_exp_f32 v234, v234
MA 40,144,8
RT 172,8,48
RT 174,8,816
MA 60,144,12
s_waitcnt vmcnt(5)
s_barrier
MA 64,148,12
RT 144,8,11280
RT 146,8,12048
MA 44,148,8
v_exp_f32 v138, v138
v_exp_f32 v235, v235
MA 48,152,8
RT 148,8,11288
RT 150,8,12056
MA 68,152,12
v_exp_f32 v139, v139
v_exp_f32 v236, v236
MA 92,156,12
RT 152,8,11296
RT 154,8,12064
MA 72,156,8
WL 6
v_exp_f32 v140, v140
MA 76,160,8
RT 156,8,11304
RT 158,8,12072
MA 96,160,12
buffer_load_dwordx4 v1, s[12:15], s36 offen offset:0  lds
v_exp_f32_e64 v237, v237
MA 100,164,12
RT 160,8,11312
RT 162,8,12080
MA 80,164,8
v_exp_f32 v141, v141
v_exp_f32 v238, v238
MA 84,168,8
RT 164,8,12816
RT 166,8,13584
MA 104,168,12
buffer_load_dwordx4 v2, s[12:15], s36 offen offset:1024  lds
v_exp_f32_e64 v142, v142
MA 108,172,12
RT 168,8,12824
RT 170,8,13592
MA 88,172,8
WL 6
v_exp_f32 v239, v239
MA 32,144,16
RT 172,8,12832
RT 174,8,13600
MA 52,144,20
buffer_load_dwordx4 v3, s[12:15], s36 offen offset:2048  lds
v_exp_f32_e64 v143, v143
MA 56,148,20
RT 144,8,12840
RT 146,8,13608
MA 36,148,16
s_add_u32 m0, s37, 25600
s_add_u32 s36, s49, 553088
v_exp_f32_e64 v240, v240
MA 40,152,16
RT 148,8,12848
RT 150,8,13616
MA 60,152,20
buffer_load_dwordx4 v1, s[12:15], s36 offen offset:0  lds
v_exp_f32_e64 v144, v144
MA 64,156,20
RT 152,7,16
RT 154,7,784
MA 44,156,16
WL 6
v_exp_f32 v241, v241
MA 48,160,16
RT 156,7,24
RT 158,7,792
MA 68,160,20
buffer_load_dwordx4 v2, s[12:15], s36 offen offset:1024  lds
v_exp_f32_e64 v145, v145
MA 92,164,20
RT 160,7,32
RT 162,7,800
MA 72,164,16
v_exp_f32 v242, v242
v_exp_f32 v146, v146
MA 76,168,16
RT 164,7,40
RT 166,7,808
MA 96,168,20
buffer_load_dwordx4 v3, s[12:15], s36 offen offset:2048  lds
v_exp_f32_e64 v243, v243
MA 100,172,20
RT 168,7,48
RT 170,7,816
MA 80,172,16
WL 6
s_add_u32 m0, s37, 38400
s_add_u32 s36, s49, 663680
v_exp_f32 v147, v147
MA 84,144,16
RT 172,7,1552
RT 174,7,2320
MA 104,144,20
buffer_load_dwordx4 v1, s[12:15], s36 offen offset:0  lds
v_exp_f32_e64 v244, v244
MA 108,148,20
RT 144,7,1560
RT 146,7,2328
MA 88,148,16
v_exp_f32 v148, v148
v_exp_f32 v245, v245
MA 32,152,24
RT 148,7,1568
RT 150,7,2336
MA 52,152,28
buffer_load_dwordx4 v2, s[12:15], s36 offen offset:1024  lds
v_exp_f32_e64 v149, v149
MA 56,156,28
RT 152,7,1576
RT 154,7,2344
MA 36,156,24
WL 6
v_exp_f32 v246, v246
MA 40,160,24
RT 156,7,1584
RT 158,7,2352
MA 60,160,28
s_waitcnt vmcnt(2)
s_barrier
MA 64,164,28
RT 160,7,12816
RT 162,7,13584
MA 44,164,24
s_getpc_b64 s[6:7]
s_nop 0
s_load_dword s5, s[6:7], s101
MA 48,168,24
RT 164,7,12824
RT 166,7,13592
MA 68,168,28
buffer_load_dwordx4 v3, s[12:15], s36 offen offset:2048  lds
v_exp_f32_e64 v150, v150
MA 92,172,28
RT 168,7,12832
RT 170,7,13600
MA 72,172,24
WL 6
s_add_u32 m0, s37, 51200
s_add_u32 s36, s49, 774272
v_exp_f32 v247, v247
MA 76,144,24
RT 172,7,12840
RT 174,7,13608
MA 96,144,28
buffer_load_dwordx4 v1, s[12:15], s36 offen offset:0  lds
v_exp_f32_e64 v151, v151
MA 100,148,28
RT 144,7,12848
RT 146,7,13616
MA 80,148,24
v_exp_f32 v248, v248
v_exp_f32 v152, v152
MA 84,152,24
RT 148,7,14352
RT 150,7,15120
MA 104,152,28
buffer_load_dwordx4 v2, s[12:15], s36 offen offset:1024  lds
v_exp_f32_e64 v249, v249
MA 108,156,28
RT 152,7,14360
RT 154,7,15128
MA 88,156,24
WL 6
v_exp_f32 v153, v153
MA 32,160,32
RT 156,7,14368
RT 158,7,15136
MA 52,160,36
buffer_load_dwordx4 v3, s[12:15], s36 offen offset:2048  lds
v_pk_add_f32 v[24:25], v[232:233], v[234:235]
v_pk_add_f32 v[26:27], v[136:137], v[138:139]
v_pk_add_f32 v[24:25], v[24:25], v[236:237]
v_pk_add_f32 v[26:27], v[26:27], v[140:141]
v_pk_add_f32 v[24:25], v[24:25], v[238:239]
v_pk_add_f32 v[26:27], v[26:27], v[142:143]
v_pk_add_f32 v[24:25], v[24:25], v[240:241]
v_pk_add_f32 v[26:27], v[26:27], v[144:145]
v_pk_add_f32 v[24:25], v[24:25], v[242:243]
v_pk_add_f32 v[26:27], v[26:27], v[146:147]
v_pk_add_f32 v[24:25], v[24:25], v[244:245]
v_pk_add_f32 v[26:27], v[26:27], v[148:149]
v_pk_add_f32 v[24:25], v[24:25], v[246:247]
v_pk_add_f32 v[26:27], v[26:27], v[150:151]
v_pk_add_f32 v[24:25], v[24:25], v[248:249]
v_pk_add_f32 v[26:27], v[26:27], v[152:153]
s_nop 0
s_nop 0
MA 56,164,36
RT 160,7,14376
RT 162,7,15144
MA 36,164,32
s_add_u32 m0, s37, 64000
s_add_u32 s36, s49, 884864
v_add_f32 v24, v24, v25
v_add_f32 v25, v26, v27
MA 40,168,32
RT 164,7,14384
RT 166,7,15152
MA 60,168,36
buffer_load_dwordx4 v1, s[12:15], s36 offen offset:0  lds
v_rcp_f32_e64 v24, v24
MA 64,172,36
RT 168,7,25616
RT 170,7,26384
MA 44,172,32
WL 6
v_rcp_f32 v25, v25
s_nop 0
s_nop 0
MA 48,144,32
RT 172,7,25624
RT 174,7,26392
MA 68,144,36
buffer_load_dwordx4 v2, s[12:15], s36 offen offset:1024  lds
v_pk_mul_f32 v[232:233], v[232:233], v[24:25] op_sel:[0,0] op_sel_hi:[1,0]
v_pk_mul_f32 v[136:137], v[136:137], v[24:25] op_sel:[0,1] op_sel_hi:[1,1]
v_pk_mul_f32 v[234:235], v[234:235], v[24:25] op_sel:[0,0] op_sel_hi:[1,0]
v_pk_mul_f32 v[138:139], v[138:139], v[24:25] op_sel:[0,1] op_sel_hi:[1,1]
v_pk_mul_f32 v[236:237], v[236:237], v[24:25] op_sel:[0,0] op_sel_hi:[1,0]
v_pk_mul_f32 v[140:141], v[140:141], v[24:25] op_sel:[0,1] op_sel_hi:[1,1]
v_pk_mul_f32 v[238:239], v[238:239], v[24:25] op_sel:[0,0] op_sel_hi:[1,0]
v_pk_mul_f32 v[142:143], v[142:143], v[24:25] op_sel:[0,1] op_sel_hi:[1,1]
v_pk_mul_f32 v[240:241], v[240:241], v[24:25] op_sel:[0,0] op_sel_hi:[1,0]
v_pk_mul_f32 v[144:145], v[144:145], v[24:25] op_sel:[0,1] op_sel_hi:[1,1]
v_pk_mul_f32 v[242:243], v[242:243], v[24:25] op_sel:[0,0] op_sel_hi:[1,0]
v_pk_mul_f32 v[146:147], v[146:147], v[24:25] op_sel:[0,1] op_sel_hi:[1,1]
v_pk_mul_f32 v[244:245], v[244:245], v[24:25] op_sel:[0,0] op_sel_hi:[1,0]
v_pk_mul_f32 v[148:149], v[148:149], v[24:25] op_sel:[0,1] op_sel_hi:[1,1]
v_pk_mul_f32 v[246:247], v[246:247], v[24:25] op_sel:[0,0] op_sel_hi:[1,0]
v_pk_mul_f32 v[150:151], v[150:151], v[24:25] op_sel:[0,1] op_sel_hi:[1,1]
v_pk_mul_f32 v[248:249], v[248:249], v[24:25] op_sel:[0,0] op_sel_hi:[1,0]
v_pk_mul_f32 v[152:153], v[152:153], v[24:25] op_sel:[0,1] op_sel_hi:[1,1]
s_nop 0
s_nop 0
MA 92,148,36
RT 144,7,25632
RT 146,7,26400
MA 72,148,32
CV 193,152,153
CV 192,150,151
CV 191,148,149
CV 190,146,147
MA 76,152,32
RT 148,7,25640
RT 150,7,26408
MA 96,152,36
buffer_load_dwordx4 v3, s[12:15], s36 offen offset:2048  lds
CV 189,144,145
CV 188,142,143
MA 100,156,36
RT 152,7,25648
RT 154,7,26416
MA 80,156,32
WL 6
s_nop 0
s_add_u32 m0, s37, 76800
s_add_u32 s36, s49, 995456
CV 187,140,141
CV 186,138,139
MA 84,160,32
RT 156,7,27152
RT 158,7,27920
MA 104,160,36
CV 185,136,137
CV 176,232,233
CV 177,234,235
CV 178,236,237
MA 108,164,36
RT 160,7,27160
RT 162,7,27928
MA 88,164,32
buffer_load_dwordx4 v1, s[12:15], s36 offen offset:0  lds
CV 179,238,239
CV 180,240,241
MA 32,168,40
RT 164,7,27168
RT 166,7,27936
MA 52,168,44
CV 181,242,243
CV 182,244,245
CV 183,246,247
CV 184,248,249
MA 56,172,44
RT 168,7,27176
RT 170,7,27944
MA 36,172,40
WL 6
s_nop 0
ds_write_b128 v10, v[176:179] offset:0
ds_write_b128 v10, v[180:183] offset:16
ds_write_b128 v10, v[184:187] offset:32
MA 40,144,40
RT 172,7,27184
RT 174,7,27952
MA 60,144,44
s_waitcnt vmcnt(4)
s_barrier
MA 64,148,44
RT 144,7,38416
RT 146,7,39184
MA 44,148,40
buffer_load_dwordx4 v2, s[12:15], s36 offen offset:1024  lds
ds_write_b128 v10, v[188:191] offset:48
ds_write_b128 v10, v[192:195] offset:64
MA 48,152,40
RT 148,7,38424
RT 150,7,39192
MA 68,152,44
ds_write_b128 v10, v[196:199] offset:80
ds_write_b128 v10, v[200:203] offset:96
v_max3_f32 v24, v156, v157, v158
v_min3_f32 v25, v156, v157, v158
MA 92,156,44
RT 152,7,38432
RT 154,7,39200
MA 72,156,40
WL 10
s_nop 0
v_max3_f32 v24, v24, v159, v160
v_min3_f32 v25, v25, v159, v160
v_max3_f32 v24, v24, v161, v162
MA 76,160,40
RT 156,7,38440
RT 158,7,39208
MA 96,160,44
buffer_load_dwordx4 v3, s[12:15], s36 offen offset:2048  lds
v_min3_f32 v25, v25, v161, v162
v_max3_f32 v24, v24, v163, v164
MA 100,164,44
RT 160,7,38448
RT 162,7,39216
MA 80,164,40
s_getpc_b64 s[6:7]
s_nop 0
s_load_dword s5, s[6:7], s101
MA 84,168,40
RT 164,7,39952
RT 166,7,40720
MA 104,168,44
s_add_u32 m0, s37, 0
s_nop 0
s_add_u32 s36, s49, 1106048
v_min3_f32 v25, v25, v163, v164
v_max3_f32 v24, v24, v165, v166
MA 108,172,44
RT 168,7,39960
RT 170,7,40728
MA 88,172,40
WL 6
s_nop 0
v_min3_f32 v25, v25, v165, v166
v_max3_f32 v24, v24, v167, v168
v_min3_f32 v25, v25, v167, v168
MA 32,144,48
RT 172,7,39968
RT 174,7,40736
MA 52,144,52
buffer_load_dwordx4 v1, s[12:15], s36 offen offset:0  lds
v_max3_f32 v24, v24, v169, v170
v_min3_f32 v25, v25, v169, v170
MA 56,148,52
RT 144,7,39976
RT 146,7,40744
MA 36,148,48
v_max3_f32 v24, v24, v171, v172
v_min3_f32 v25, v25, v171, v172
v_max_f32 v24, v24, v173
v_min_f32 v25, v25, v173
MA 40,152,48
RT 148,7,39984
RT 150,7,40752
MA 60,152,52
buffer_load_dwordx4 v2, s[12:15], s36 offen offset:1024  lds
v_pk_mul_f32 v[24:25], v[24:25], v[14:15] op_sel:[0,1] op_sel_hi:[1,1]
v_pk_fma_f32 v[232:233], v[156:157], v[14:15], v[24:25] op_sel:[0,1,0] op_sel_hi:[1,1,0] neg_lo:[0,0,1] neg_hi:[0,0,1]
v_pk_fma_f32 v[156:157], v[156:157], v[14:15], v[24:25] op_sel:[0,1,1] op_sel_hi:[1,1,1] neg_lo:[0,1,0] neg_hi:[0,1,0]
v_pk_fma_f32 v[234:235], v[158:159], v[14:15], v[24:25] op_sel:[0,1,0] op_sel_hi:[1,1,0] neg_lo:[0,0,1] neg_hi:[0,0,1]
v_pk_fma_f32 v[158:159], v[158:159], v[14:15], v[24:25] op_sel:[0,1,1] op_sel_hi:[1,1,1] neg_lo:[0,1,0] neg_hi:[0,1,0]
v_pk_fma_f32 v[236:237], v[160:161], v[14:15], v[24:25] op_sel:[0,1,0] op_sel_hi:[1,1,0] neg_lo:[0,0,1] neg_hi:[0,0,1]
v_pk_fma_f32 v[160:161], v[160:161], v[14:15], v[24:25] op_sel:[0,1,1] op_sel_hi:[1,1,1] neg_lo:[0,1,0] neg_hi:[0,1,0]
v_pk_fma_f32 v[238:239], v[162:163], v[14:15], v[24:25] op_sel:[0,1,0] op_sel_hi:[1,1,0] neg_lo:[0,0,1] neg_hi:[0,0,1]
v_pk_fma_f32 v[162:163], v[162:163], v[14:15], v[24:25] op_sel:[0,1,1] op_sel_hi:[1,1,1] neg_lo:[0,1,0] neg_hi:[0,1,0]
v_pk_fma_f32 v[240:241], v[164:165], v[14:15], v[24:25] op_sel:[0,1,0] op_sel_hi:[1,1,0] neg_lo:[0,0,1] neg_hi:[0,0,1]
v_pk_fma_f32 v[164:165], v[164:165], v[14:15], v[24:25] op_sel:[0,1,1] op_sel_hi:[1,1,1] neg_lo:[0,1,0] neg_hi:[0,1,0]
v_pk_fma_f32 v[242:243], v[166:167], v[14:15], v[24:25] op_sel:[0,1,0] op_sel_hi:[1,1,0] neg_lo:[0,0,1] neg_hi:[0,0,1]
v_pk_fma_f32 v[166:167], v[166:167], v[14:15], v[24:25] op_sel:[0,1,1] op_sel_hi:[1,1,1] neg_lo:[0,1,0] neg_hi:[0,1,0]
v_pk_fma_f32 v[244:245], v[168:169], v[14:15], v[24:25] op_sel:[0,1,0] op_sel_hi:[1,1,0] neg_lo:[0,0,1] neg_hi:[0,0,1]
v_pk_fma_f32 v[168:169], v[168:169], v[14:15], v[24:25] op_sel:[0,1,1] op_sel_hi:[1,1,1] neg_lo:[0,1,0] neg_hi:[0,1,0]
v_pk_fma_f32 v[246:247], v[170:171], v[14:15], v[24:25] op_sel:[0,1,0] op_sel_hi:[1,1,0] neg_lo:[0,0,1] neg_hi:[0,0,1]
v_pk_fma_f32 v[170:171], v[170:171], v[14:15], v[24:25] op_sel:[0,1,1] op_sel_hi:[1,1,1] neg_lo:[0,1,0] neg_hi:[0,1,0]
v_pk_fma_f32 v[248:249], v[172:173], v[14:15], v[24:25] op_sel:[0,1,0] op_sel_hi:[1,1,0] neg_lo:[0,0,1] neg_hi:[0,0,1]
v_pk_fma_f32 v[172:173], v[172:173], v[14:15], v[24:25] op_sel:[0,1,1] op_sel_hi:[1,1,1] neg_lo:[0,1,0] neg_hi:[0,1,0]
s_nop 0
s_nop 0
MA 64,156,52
RT 152,7,51216
RT 154,7,51984
MA 44,156,48
WL 6
v_exp_f32 v232, v232
MA 48,160,48
RT 156,7,51224
RT 158,7,51992
MA 68,160,52
buffer_load_dwordx4 v3, s[12:15], s36 offen offset:2048  lds
v_exp_f32_e64 v156, v156
MA 92,164,52
RT 160,7,51232
RT 162,7,52000
MA 72,164,48
s_add_u32 m0, s37, 12800
s_add_u32 s36, s49, 1216640
v_exp_f32_e64 v233, v233
MA 76,168,48
RT 164,7,51240
RT 166,7,52008
MA 96,168,52
v_exp_f32 v157, v157
v_exp_f32 v234, v234
MA 100,172,52
RT 168,7,51248
RT 170,7,52016
MA 80,172,48
WL 6
v_exp_f32 v158, v158
MA 84,144,48
RT 172,7,52752
RT 174,7,53520
MA 104,144,52
buffer_load_dwordx4 v1, s[12:15], s36 offen offset:0  lds
v_exp_f32_e64 v235, v235
MA 108,148,52
RT 144,7,52760
RT 146,7,53528
MA 88,148,48
v_exp_f32 v159, v159
v_exp_f32 v236, v236
MA 32,152,56
RT 148,7,52768
RT 150,7,53536
MA 52,152,60
v_exp_f32 v160, v160
v_exp_f32 v237, v237
MA 56,156,60
RT 152,7,52776
RT 154,7,53544
MA 36,156,56
WL 6
v_exp_f32 v161, v161
MA 40,160,56
RT 156,7,52784
RT 158,7,53552
MA 60,160,60
s_waitcnt vmcnt(4)
s_barrier
MA 64,164,60
RT 160,7,64016
RT 162,7,64784
MA 44,164,56
buffer_load_dwordx4 v2, s[12:15], s36 offen offset:1024  lds
v_exp_f32_e64 v238, v238
MA 48,168,56
RT 164,7,64024
RT 166,7,64792
MA 68,168,60
v_exp_f32 v162, v162
v_exp_f32 v239, v239
MA 92,172,60
RT 168,7,64032
RT 170,7,64800
MA 72,172,56
WL 6
v_exp_f32 v163, v163
MA 76,144,56
RT 172,7,64040
RT 174,7,64808
MA 96,144,60
buffer_load_dwordx4 v3, s[12:15], s36 offen offset:2048  lds
v_exp_f32_e64 v240, v240
MA 100,148,60
RT 144,7,64048
RT 146,7,64816
MA 80,148,56
s_add_u32 m0, s37, 25600
s_add_u32 s36, s49, 1327232
v_exp_f32_e64 v164, v164
MA 84,152,56
RT 148,8,16
RT 150,8,784
MA 104,152,60
buffer_load_dwordx4 v1, s[12:15], s36 offen offset:0  lds
v_exp_f32_e64 v241, v241
MA 108,156,60
RT 152,8,24
RT 154,8,792
MA 88,156,56
WL 6
v_exp_f32 v165, v165
MA 32,160,64
RT 156,8,32
RT 158,8,800
MA 52,160,68
buffer_load_dwordx4 v2, s[12:15], s36 offen offset:1024  lds
v_exp_f32_e64 v242, v242
MA 56,164,68
RT 160,8,40
RT 162,8,808
MA 36,164,64
v_exp_f32 v166, v166
v_exp_f32 v243, v243
MA 40,168,64
RT 164,8,48
RT 166,8,816
MA 60,168,68
buffer_load_dwordx4 v3, s[12:15], s36 offen offset:2048  lds
v_exp_f32_e64 v167, v167
MA 64,172,68
RT 168,8,11280
RT 170,8,12048
MA 44,172,64
WL 6
s_add_u32 m0, s37, 38400
s_add_u32 s36, s49, 1437824
v_exp_f32 v244, v244
MA 48,144,64
RT 172,8,11288
RT 174,8,12056
MA 68,144,68
s_getpc_b64 s[6:7]
s_nop 0
s_load_dword s5, s[6:7], s101
MA 92,148,68
RT 144,8,11296
RT 146,8,12064
MA 72,148,64
buffer_load_dwordx4 v1, s[12:15], s36 offen offset:0  lds
v_exp_f32_e64 v168, v168
MA 76,152,64
RT 148,8,11304
RT 150,8,12072
MA 96,152,68
v_exp_f32 v245, v245
v_exp_f32 v169, v169
MA 100,156,68
RT 152,8,11312
RT 154,8,12080
MA 80,156,64
WL 6
v_exp_f32 v246, v246
MA 84,160,64
RT 156,8,12816
RT 158,8,13584
MA 104,160,68
buffer_load_dwordx4 v2, s[12:15], s36 offen offset:1024  lds
v_exp_f32_e64 v170, v170
MA 108,164,68
RT 160,8,12824
RT 162,8,13592
MA 88,164,64
v_exp_f32 v247, v247
v_exp_f32 v171, v171
MA 32,168,72
RT 164,8,12832
RT 166,8,13600
MA 52,168,76
v_exp_f32 v248, v248
v_exp_f32 v172, v172
MA 56,172,76
RT 168,8,12840
RT 170,8,13608
MA 36,172,72
WL 6
v_exp_f32 v249, v249
MA 40,144,72
RT 172,8,12848
RT 174,8,13616
MA 60,144,76
s_waitcnt vmcnt(5)
s_barrier
MA 64,148,76
RT 144,7,16
RT 146,7,784
MA 44,148,72
buffer_load_dwordx4 v3, s[12:15], s36 offen offset:2048  lds
v_exp_f32_e64 v173, v173
MA 48,152,72
RT 148,7,24
RT 150,7,792
MA 68,152,76
s_add_u32 m0, s37, 51200
s_add_u32 s36, s49, 1548416
v_pk_add_f32 v[24:25], v[232:233], v[234:235]
v_pk_add_f32 v[26:27], v[156:157], v[158:159]
v_pk_add_f32 v[24:25], v[24:25], v[236:237]
v_pk_add_f32 v[26:27], v[26:27], v[160:161]
v_pk_add_f32 v[24:25], v[24:25], v[238:239]
v_pk_add_f32 v[26:27], v[26:27], v[162:163]
v_pk_add_f32 v[24:25], v[24:25], v[240:241]
v_pk_add_f32 v[26:27], v[26:27], v[164:165]
v_pk_add_f32 v[24:25], v[24:25], v[242:243]
v_pk_add_f32 v[26:27], v[26:27], v[166:167]
v_pk_add_f32 v[24:25], v[24:25], v[244:245]
v_pk_add_f32 v[26:27], v[26:27], v[168:169]
v_pk_add_f32 v[24:25], v[24:25], v[246:247]
v_pk_add_f32 v[26:27], v[26:27], v[170:171]
v_pk_add_f32 v[24:25], v[24:25], v[248:249]
v_pk_add_f32 v[26:27], v[26:27], v[172:173]
s_nop 0
s_nop 0
MA 92,156,76
RT 152,7,32
RT 154,7,800
MA 72,156,72
WL 6
v_add_f32 v24, v24, v25
v_add_f32_e64 v25, v26, v27
MA 76,160,72
RT 156,7,40
RT 158,7,808
MA 96,160,76
buffer_load_dwordx4 v1, s[12:15], s36 offen offset:0  lds
v_rcp_f32_e64 v24, v24
MA 100,164,76
RT 160,7,48
RT 162,7,816
MA 80,164,72
v_rcp_f32 v25, v25
s_nop 0
MA 84,168,72
RT 164,7,1552
RT 166,7,2320
MA 104,168,76
buffer_load_dwordx4 v2, s[12:15], s36 offen offset:1024  lds
v_pk_mul_f32 v[232:233], v[232:233], v[24:25] op_sel:[0,0] op_sel_hi:[1,0]
v_pk_mul_f32 v[156:157], v[156:157], v[24:25] op_sel:[0,1] op_sel_hi:[1,1]
v_pk_mul_f32 v[234:235], v[234:235], v[24:25] op_sel:[0,0] op_sel_hi:[1,0]
v_pk_mul_f32 v[158:159], v[158:159], v[24:25] op_sel:[0,1] op_sel_hi:[1,1]
v_pk_mul_f32 v[236:237], v[236:237], v[24:25] op_sel:[0,0] op_sel_hi:[1,0]
v_pk_mul_f32 v[160:161], v[160:161], v[24:25] op_sel:[0,1] op_sel_hi:[1,1]
v_pk_mul_f32 v[238:239], v[238:239], v[24:25] op_sel:[0,0] op_sel_hi:[1,0]
v_pk_mul_f32 v[162:163], v[162:163], v[24:25] op_sel:[0,1] op_sel_hi:[1,1]
v_pk_mul_f32 v[240:241], v[240:241], v[24:25] op_sel:[0,0] op_sel_hi:[1,0]
v_pk_mul_f32 v[164:165], v[164:165], v[24:25] op_sel:[0,1] op_sel_hi:[1,1]
v_pk_mul_f32 v[242:243], v[242:243], v[24:25] op_sel:[0,0] op_sel_hi:[1,0]
v_pk_mul_f32 v[166:167], v[166:167], v[24:25] op_sel:[0,1] op_sel_hi:[1,1]
v_pk_mul_f32 v[244:245], v[244:245], v[24:25] op_sel:[0,0] op_sel_hi:[1,0]
v_pk_mul_f32 v[168:169], v[168:169], v[24:25] op_sel:[0,1] op_sel_hi:[1,1]
v_pk_mul_f32 v[246:247], v[246:247], v[24:25] op_sel:[0,0] op_sel_hi:[1,0]
v_pk_mul_f32 v[170:171], v[170:171], v[24:25] op_sel:[0,1] op_sel_hi:[1,1]
v_pk_mul_f32 v[248:249], v[248:249], v[24:25] op_sel:[0,0] op_sel_hi:[1,0]
v_pk_mul_f32 v[172:173], v[172:173], v[24:25] op_sel:[0,1] op_sel_hi:[1,1]
s_nop 0
s_nop 0
MA 108,172,76
RT 168,7,1560
RT 170,7,2328
MA 88,172,72
WL 6
s_nop 0
CV 221,172,173
CV 220,170,171
CV 219,168,169
MA 32,144,80
RT 172,7,1568
RT 174,7,2336
MA 52,144,84
buffer_load_dwordx4 v3, s[12:15], s36 offen offset:2048  lds
CV 218,166,167
CV 217,164,165
MA 56,148,84
RT 144,7,1576
RT 146,7,2344
MA 36,148,80
s_add_u32 m0, s37, 64000
s_add_u32 s36, s49, 1659008
CV 216,162,163
CV 215,160,161
MA 40,152,80
RT 148,7,1584
RT 150,7,2352
MA 60,152,84
CV 214,158,159
CV 213,156,157
CV 204,232,233
CV 205,234,235
MA 64,156,84
RT 152,7,12816
RT 154,7,13584
MA 44,156,80
WL 6
s_nop 0
CV 206,236,237
CV 207,238,239
CV 208,240,241
MA 48,160,80
RT 156,7,12824
RT 158,7,13592
MA 68,160,84
buffer_load_dwordx4 v1, s[12:15], s36 offen offset:0  lds
CV 209,242,243
CV 210,244,245
MA 92,164,84
RT 160,7,12832
RT 162,7,13600
MA 72,164,80
CV 211,246,247
CV 212,248,249
ds_write_b128 v10, v[204:207] offset:1792
ds_write_b128 v10, v[208:211] offset:1808
MA 76,168,80
RT 164,7,12840
RT 166,7,13608
MA 96,168,84
ds_write_b128 v10, v[212:215] offset:1824
ds_write_b128 v10, v[216:219] offset:1840
ds_write_b128 v10, v[220:223] offset:1856
ds_write_b128 v10, v[224:227] offset:1872
MA 100,172,84
RT 168,7,12848
RT 170,7,13616
MA 80,172,80
WL 12
ds_write_b128 v10, v[228:231] offset:1888
v_cmp_eq_u32 vcc, 0, v22
v_cmp_gt_u32 s[54:55], 4, v23
MA 84,144,80
RT 172,7,14352
RT 174,7,15120
MA 104,144,84
buffer_load_dwordx4 v2, s[12:15], s36 offen offset:1024  lds
v_mov_b32 v28, 0x40000000
s_add_u32 s35, s51, 0
MA 108,148,84
RT 144,7,14360
RT 146,7,15128
MA 88,148,80
s_getpc_b64 s[6:7]
s_nop 0
s_load_dword s5, s[6:7], s101
MA 32,152,88
RT 148,7,14368
RT 150,7,15136
MA 52,152,92
v_cndmask_b32_e64 v25, v28, v12, vcc
v_lshl_add_u32 v26, v22, 2, v23
v_lshlrev_b32 v26, 4, v26
v_cmp_gt_u32 vcc, 2, v22
MA 56,156,92
RT 152,7,14376
RT 154,7,15144
MA 36,156,88
WL 6
v_cndmask_b32 v26, v28, v26, s[54:55]
s_nop 0
v_cndmask_b32_e64 v27, v28, v26, vcc
MA 40,160,88
RT 156,7,14384
RT 158,7,15152
MA 60,160,92
WL 10
s_waitcnt vmcnt(5)
s_barrier
s_nop 0
MA 64,164,92
RT 160,7,25616
RT 162,7,26384
MA 44,164,88
buffer_load_dwordx4 v3, s[12:15], s36 offen offset:2048  lds
ds_read_b64_tr_b16 v[136:137], v11 offset:0
ds_read_b64_tr_b16 v[138:139], v11 offset:448
MA 48,168,88
RT 164,7,25624
RT 166,7,26392
MA 68,168,92
s_add_u32 m0, s37, 76800
s_add_u32 s36, s49, 1769600
ds_read_b64_tr_b16 v[140:141], v11 offset:32
ds_read_b64_tr_b16 v[142:143], v11 offset:480
MA 92,172,92
RT 168,7,25632
RT 170,7,26400
MA 72,172,88
WL 10
s_nop 0
ds_read_b64_tr_b16 v[144:145], v11 offset:64
ds_read_b64_tr_b16 v[146:147], v11 offset:512
ds_read_b64_tr_b16 v[148:149], v11 offset:72
MA 76,144,88
RT 172,7,25640
RT 174,7,26408
MA 96,144,92
buffer_load_dwordx4 v1, s[12:15], s36 offen offset:0  lds
ds_read_b64_tr_b16 v[150:151], v11 offset:520
ds_read_b64_tr_b16 v[152:153], v11 offset:104
MA 100,148,92
RT 144,7,25648
RT 146,7,26416
MA 80,148,88
ds_read_b64_tr_b16 v[154:155], v11 offset:552
ds_read_b64_tr_b16 v[156:157], v11 offset:3584
ds_read_b64_tr_b16 v[158:159], v11 offset:4032
ds_read_b64_tr_b16 v[160:161], v11 offset:3616
MA 84,152,88
RT 148,7,27152
RT 150,7,27920
MA 104,152,92
buffer_load_dwordx4 v2, s[12:15], s36 offen offset:1024  lds
ds_read_b64_tr_b16 v[162:163], v11 offset:4064
ds_read_b64_tr_b16 v[164:165], v11 offset:3648
MA 108,156,92
RT 152,7,27160
RT 154,7,27928
MA 88,156,88
WL 14
s_nop 0
ds_read_b64_tr_b16 v[166:167], v11 offset:4096
ds_read_b64_tr_b16 v[168:169], v11 offset:3656
ds_read_b64_tr_b16 v[170:171], v11 offset:4104
MA 32,160,96
RT 156,7,27168
RT 158,7,27936
MA 52,160,100
buffer_load_dwordx4 v3, s[12:15], s36 offen offset:2048  lds
ds_read_b64_tr_b16 v[172:173], v11 offset:3688
ds_read_b64_tr_b16 v[174:175], v11 offset:4136
MA 56,164,100
RT 160,7,27176
RT 162,7,27944
MA 36,164,96
s_add_u32 m0, s37, 0
s_nop 0
s_add_u32 s36, s49, 1880192
ds_read_b64_tr_b16 v[176:177], v11 offset:7168
ds_read_b64_tr_b16 v[178:179], v11 offset:7616
MA 40,168,96
RT 164,7,27184
RT 166,7,27952
MA 60,168,100
ds_read_b64_tr_b16 v[180:181], v11 offset:7200
ds_read_b64_tr_b16 v[182:183], v11 offset:7648
ds_read_b64_tr_b16 v[184:185], v11 offset:7232
ds_read_b64_tr_b16 v[186:187], v11 offset:7680
MA 64,172,100
RT 168,7,38416
RT 170,7,39184
MA 44,172,96
WL 14
s_nop 0
ds_read_b64_tr_b16 v[188:189], v11 offset:7240
ds_read_b64_tr_b16 v[190:191], v11 offset:7688
ds_read_b64_tr_b16 v[192:193], v11 offset:7272
MA 48,144,96
RT 172,7,38424
RT 174,7,39192
MA 68,144,100
buffer_load_dwordx4 v1, s[12:15], s36 offen offset:0  lds
ds_read_b64_tr_b16 v[194:195], v11 offset:7720
ds_read_b64_tr_b16 v[196:197], v11 offset:10752
MA 92,148,100
RT 144,7,38432
RT 146,7,39200
MA 72,148,96
ds_read_b64_tr_b16 v[198:199], v11 offset:11200
ds_read_b64_tr_b16 v[200:201], v11 offset:10784
ds_read_b64_tr_b16 v[202:203], v11 offset:11232
ds_read_b64_tr_b16 v[204:205], v11 offset:10816
MA 76,152,96
RT 148,7,38440
RT 150,7,39208
MA 96,152,100
ds_read_b64_tr_b16 v[206:207], v11 offset:11264
ds_read_b64_tr_b16 v[208:209], v11 offset:10824
ds_read_b64_tr_b16 v[210:211], v11 offset:11272
ds_read_b64_tr_b16 v[212:213], v11 offset:10856
MA 100,156,100
RT 152,7,38448
RT 154,7,39216
MA 80,156,96
WL 15
s_nop 0
ds_read_b64_tr_b16 v[214:215], v11 offset:11304
MA 84,160,96
RT 156,7,39952
RT 158,7,40720
MA 104,160,100
buffer_load_dwordx4 v2, s[12:15], s36 offen offset:1024  lds
MA 108,164,100
RT 160,7,39960
RT 162,7,40728
MA 88,164,96
WL 4
s_nop 0
v_mfma_f32_16x16x32_bf16 v[112:115], v[136:139], v[148:151], 0
MA 32,168,104
RT 164,7,39968
RT 166,7,40736
MA 52,168,108
v_mfma_f32_16x16x32_bf16 v[116:119], v[136:139], v[152:155], 0
v_mfma_f32_16x16x32_bf16 v[120:123], v[140:143], v[148:151], 0
MA 56,172,108
RT 168,7,39976
RT 170,7,40744
MA 36,172,104
WL 6
s_nop 0
v_mfma_f32_16x16x32_bf16 v[124:127], v[140:143], v[152:155], 0
MA 40,144,104
RT 172,7,39984
RT 174,7,40752
MA 60,144,108
s_waitcnt vmcnt(5)
s_barrier
MA 64,148,108
RT 144,7,51216
RT 146,7,51984
MA 44,148,104
buffer_load_dwordx4 v3, s[12:15], s36 offen offset:2048  lds
v_mfma_f32_16x16x32_bf16 v[128:131], v[144:147], v[148:151], 0
MA 48,152,104
RT 148,7,51224
RT 150,7,51992
MA 68,152,108
s_add_u32 m0, s37, 12800
s_add_u32 s36, s47, 0
s_nop 0
v_mfma_f32_16x16x32_bf16 v[132:135], v[144:147], v[152:155], 0
MA 92,156,108
RT 152,7,51232
RT 154,7,52000
MA 72,156,104
WL 6
s_nop 0
v_mfma_f32_16x16x32_bf16 v[112:115], v[156:159], v[168:171], v[112:115]
MA 76,160,104
RT 156,7,51240
RT 158,7,52008
MA 96,160,108
s_getpc_b64 s[6:7]
s_nop 0
s_load_dword s5, s[6:7], s101
MA 100,164,108
RT 160,7,51248
RT 162,7,52016
MA 80,164,104
buffer_load_dwordx4 v4, s[12:15], s36 offen offset:0  lds
v_mfma_f32_16x16x32_bf16 v[116:119], v[156:159], v[172:175], v[116:119]
MA 84,168,104
RT 164,7,52752
RT 166,7,53520
MA 104,168,108
v_mfma_f32_16x16x32_bf16 v[120:123], v[160:163], v[168:171], v[120:123]
v_mfma_f32_16x16x32_bf16 v[124:127], v[160:163], v[172:175], v[124:127]
MA 108,172,108
RT 168,7,52760
RT 170,7,53528
MA 88,172,104
WL 6
s_nop 0
v_mfma_f32_16x16x32_bf16 v[128:131], v[164:167], v[168:171], v[128:131]
MA 32,144,112
RT 172,7,52768
RT 174,7,53536
MA 52,144,116
buffer_load_dwordx4 v5, s[12:15], s36 offen offset:1024  lds
v_mfma_f32_16x16x32_bf16 v[132:135], v[164:167], v[172:175], v[132:135]
MA 56,148,116
RT 144,7,52776
RT 146,7,53544
MA 36,148,112
v_mfma_f32_16x16x32_bf16 v[112:115], v[176:179], v[188:191], v[112:115]
v_mfma_f32_16x16x32_bf16 v[116:119], v[176:179], v[192:195], v[116:119]
MA 40,152,112
RT 148,7,52784
RT 150,7,53552
MA 60,152,116
buffer_load_dwordx4 v6, s[12:15], s36 offen offset:2048  lds
v_mfma_f32_16x16x32_bf16 v[120:123], v[180:183], v[188:191], v[120:123]
MA 64,156,116
RT 152,7,64016
RT 154,7,64784
MA 44,156,112
WL 6
s_nop 0
s_add_u32 m0, s37, 25600
s_add_u32 s36, s47, 110592
v_mfma_f32_16x16x32_bf16 v[124:127], v[180:183], v[192:195], v[124:127]
MA 48,160,112
RT 156,7,64024
RT 158,7,64792
MA 68,160,116
v_mfma_f32_16x16x32_bf16 v[128:131], v[184:187], v[188:191], v[128:131]
v_mfma_f32_16x16x32_bf16 v[132:135], v[184:187], v[192:195], v[132:135]
MA 92,164,116
RT 160,7,64032
RT 162,7,64800
MA 72,164,112
buffer_load_dwordx4 v4, s[12:15], s36 offen offset:0  lds
v_mfma_f32_16x16x32_bf16 v[112:115], v[196:199], v[208:211], v[112:115]
MA 76,168,112
RT 164,7,64040
RT 166,7,64808
MA 96,168,116
v_mfma_f32_16x16x32_bf16 v[116:119], v[196:199], v[212:215], v[116:119]
v_mfma_f32_16x16x32_bf16 v[120:123], v[200:203], v[208:211], v[120:123]
MA 100,172,116
RT 168,7,64048
RT 170,7,64816
MA 80,172,112
WL 6
s_nop 0
v_mfma_f32_16x16x32_bf16 v[124:127], v[200:203], v[212:215], v[124:127]
MA 84,144,112
RT 172,8,16
RT 174,8,784
MA 104,144,116
buffer_load_dwordx4 v5, s[12:15], s36 offen offset:1024  lds
v_mfma_f32_16x16x32_bf16 v[128:131], v[204:207], v[208:211], v[128:131]
MA 108,148,116
RT 144,8,24
RT 146,8,792
MA 88,148,112
v_mfma_f32_16x16x32_bf16 v[132:135], v[204:207], v[212:215], v[132:135]
MA 32,152,120
RT 148,8,32
RT 150,8,800
MA 52,152,124
MA 56,156,124
RT 152,8,40
RT 154,8,808
MA 36,156,120
WL 6
s_nop 0
MA 40,160,120
RT 156,8,48
RT 158,8,816
MA 60,160,124
s_waitcnt vmcnt(5)
s_barrier
MA 64,164,124
RT 160,8,11280
RT 162,8,12048
MA 44,164,120
buffer_load_dwordx4 v6, s[12:15], s36 offen offset:2048  lds
s_nop 0
s_nop 0
MA 48,168,120
RT 164,8,11288
RT 166,8,12056
MA 68,168,124
s_add_u32 m0, s37, 38400
s_add_u32 s36, s47, 221184
buffer_store_dwordx4 v[112:115], v12, s[20:23], s35 offen offset:0 sc1
MA 92,172,124
RT 168,8,11296
RT 170,8,12064
MA 72,172,120
WL 6
s_nop 0
buffer_store_dwordx4 v[116:119], v26, s[20:23], s35 offen offset:2304 sc1
MA 76,144,120
RT 172,8,11304
RT 174,8,12072
MA 96,144,124
buffer_load_dwordx4 v4, s[12:15], s36 offen offset:0  lds
buffer_store_dwordx4 v[120:123], v12, s[20:23], s35 offen offset:1024 sc1
MA 100,148,124
RT 144,8,11312
RT 146,8,12080
MA 80,148,120
buffer_store_dwordx4 v[124:127], v26, s[20:23], s35 offen offset:2560 sc1
buffer_store_dwordx4 v[128:131], v25, s[20:23], s35 offen offset:2048 sc1
MA 84,152,120
RT 148,8,12816
RT 150,8,13584
MA 104,152,124
buffer_load_dwordx4 v5, s[12:15], s36 offen offset:1024  lds
buffer_store_dwordx4 v[132:135], v27, s[20:23], s35 offen offset:2816 sc1
MA 108,156,124
RT 152,8,12824
RT 154,8,13592
MA 88,156,120
WL 6
s_nop 0
v_mad_u32_u24 v29, v19, 12, v18
RT 176,29,0
RT 178,29,160
MA 32,160,128
RT 156,8,12832
RT 158,8,13600
MA 52,160,132
buffer_load_dwordx4 v6, s[12:15], s36 offen offset:2048  lds
RT 180,29,8
RT 182,29,168
MA 56,164,132
RT 160,8,12840
RT 162,8,13608
MA 36,164,128
s_add_u32 m0, s37, 51200
s_add_u32 s36, s47, 331776
RT 184,29,16
RT 186,29,176
MA 40,168,128
RT 164,8,12848
RT 166,8,13616
MA 60,168,132
RT 188,29,24
RT 190,29,184
RT 192,29,32
RT 194,29,192
MA 64,172,132
RT 168,7,16
RT 170,7,784
MA 44,172,128
WL 14
v_add_u32 v29, v29, v19
RT 196,29,0
RT 198,29,160
MA 48,144,128
RT 172,7,24
RT 174,7,792
MA 68,144,132
buffer_load_dwordx4 v4, s[12:15], s36 offen offset:0  lds
RT 200,29,8
RT 202,29,168
MA 92,148,132
RT 144,7,32
RT 146,7,800
MA 72,148,128
RT 204,29,16
RT 206,29,176
RT 208,29,24
RT 210,29,184
MA 76,152,128
RT 148,7,40
RT 150,7,808
MA 96,152,132
RT 212,29,32
RT 214,29,192
v_add_u32_e64 v29, v29, v19
RT 216,29,0
MA 100,156,132
RT 152,7,48
RT 154,7,816
MA 80,156,128
WL 15
s_nop 0
RT 218,29,160
RT 220,29,8
RT 222,29,168
MA 84,160,128
RT 156,7,1552
RT 158,7,2320
MA 104,160,132
buffer_load_dwordx4 v5, s[12:15], s36 offen offset:1024  lds
RT 224,29,16
RT 226,29,176
MA 108,164,132
RT 160,7,1560
RT 162,7,2328
MA 88,164,128
RT 228,29,24
RT 230,29,184
RT 232,29,32
RT 234,29,192
MA 32,168,136
RT 164,7,1568
RT 166,7,2336
MA 52,168,140
MA 56,172,140
RT 168,7,1576
RT 170,7,2344
MA 36,172,136
WL 12
s_nop 0
MA 40,144,136
RT 172,7,1584
RT 174,7,2352
MA 60,144,140
buffer_load_dwordx4 v6, s[12:15], s36 offen offset:2048  lds
MA 64,148,140
MA 44,148,136
MA 48,152,136
MA 68,152,140
MA 92,156,140
MA 72,156,136
WL 0
s_nop 0
MA 76,160,136
MA 96,160,140
MA 100,164,140
MA 80,164,136
MA 84,168,136
MA 104,168,140
MA 108,172,140
MA 88,172,136
s_cmp_lg_u32 s32, 0
s_cbranch_scc1 L_polld_20
s_mov_b32 s89, 0x20000
s_waitcnt vmcnt(61)
s_branch L_pollc_21
L_poll_19:
buffer_load_dword v251, v250, s[24:27], 0 offen sc1
s_waitcnt vmcnt(0)
L_pollc_21:
v_readfirstlane_b32 s97, v251
s_sub_u32 s89, s89, 1
s_cmp_lg_u32 s97, 0
s_cbranch_scc1 L_polld_20
s_sleep 4
s_cmp_lg_u32 s89, 0
s_cbranch_scc1 L_poll_19
L_polld_20:
s_waitcnt vmcnt(12)
s_barrier
RT 144,7,12800
RT 146,7,13568
RT 148,7,12808
RT 150,7,13576
RT 152,7,12816
RT 154,7,13584
RT 156,7,12824
RT 158,7,13592
RT 160,7,12832
RT 162,7,13600
RT 164,7,14352
RT 166,7,15120
RT 168,7,14360
RT 170,7,15128
s_nop 3
v_mov_b32 v122, 0
v_mov_b32 v123, 0
v_mov_b32 v134, 0
v_mov_b32_e64 v135, 0
CV 112,32,33
CV 113,34,35
CV 114,36,37
CV 115,38,39
CV 116,40,41
CV 117,42,43
CV 118,44,45
CV 119,46,47
CV 120,48,49
CV 121,50,51
CV 124,52,53
CV 125,54,55
CV 126,56,57
CV 127,58,59
CV 128,60,61
CV 129,62,63
CV 130,64,65
CV 131,66,67
CV 132,68,69
CV 133,70,71
WL 15
s_nop 0
v_pk_mul_f32 v[72:73], v[72:73], v[16:17] op_sel:[0,0] op_sel_hi:[1,0]
v_pk_mul_f32 v[74:75], v[74:75], v[16:17] op_sel:[0,0] op_sel_hi:[1,0]
v_pk_mul_f32 v[76:77], v[76:77], v[16:17] op_sel:[0,0] op_sel_hi:[1,0]
v_pk_mul_f32 v[78:79], v[78:79], v[16:17] op_sel:[0,0] op_sel_hi:[1,0]
v_pk_mul_f32 v[80:81], v[80:81], v[16:17] op_sel:[0,0] op_sel_hi:[1,0]
v_pk_mul_f32 v[82:83], v[82:83], v[16:17] op_sel:[0,0] op_sel_hi:[1,0]
v_pk_mul_f32 v[84:85], v[84:85], v[16:17] op_sel:[0,0] op_sel_hi:[1,0]
v_pk_mul_f32 v[86:87], v[86:87], v[16:17] op_sel:[0,0] op_sel_hi:[1,0]
v_pk_mul_f32 v[88:89], v[88:89], v[16:17] op_sel:[0,0] op_sel_hi:[1,0]
v_pk_mul_f32 v[90:91], v[90:91], v[16:17] op_sel:[0,0] op_sel_hi:[1,0]
v_pk_mul_f32 v[92:93], v[92:93], v[16:17] op_sel:[0,1] op_sel_hi:[1,1]
v_pk_mul_f32 v[94:95], v[94:95], v[16:17] op_sel:[0,1] op_sel_hi:[1,1]
v_pk_mul_f32 v[96:97], v[96:97], v[16:17] op_sel:[0,1] op_sel_hi:[1,1]
v_pk_mul_f32 v[98:99], v[98:99], v[16:17] op_sel:[0,1] op_sel_hi:[1,1]
v_pk_mul_f32 v[100:101], v[100:101], v[16:17] op_sel:[0,1] op_sel_hi:[1,1]
v_pk_mul_f32 v[102:103], v[102:103], v[16:17] op_sel:[0,1] op_sel_hi:[1,1]
v_pk_mul_f32 v[104:105], v[104:105], v[16:17] op_sel:[0,1] op_sel_hi:[1,1]
v_pk_mul_f32 v[106:107], v[106:107], v[16:17] op_sel:[0,1] op_sel_hi:[1,1]
v_pk_mul_f32 v[108:109], v[108:109], v[16:17] op_sel:[0,1] op_sel_hi:[1,1]
v_pk_mul_f32 v[110:111], v[110:111], v[16:17] op_sel:[0,1] op_sel_hi:[1,1]
s_nop 0
s_nop 0
v_mfma_f32_16x16x32_bf16 v[136:139], a[176:179], v[112:115], 0
v_mov_b32 v28, 0x3f80
CV 194,72,73
v_mfma_f32_16x16x32_bf16 v[156:159], a[176:179], v[124:127], 0
CV 195,74,75
CV 196,76,77
v_mfma_f32_16x16x32_bf16 v[140:143], a[180:183], v[112:115], 0
CV 197,78,79
CV 198,80,81
v_mfma_f32_16x16x32_bf16 v[160:163], a[180:183], v[124:127], 0
CV 199,82,83
CV 200,84,85
v_mfma_f32_16x16x32_bf16 v[144:147], a[184:187], v[112:115], 0
CV 201,86,87
CV 202,88,89
v_mfma_f32_16x16x32_bf16 v[164:167], a[184:187], v[124:127], 0
CV 203,90,91
v_cndmask_b32 v194, v194, v28, s[42:43]
v_mfma_f32_16x16x32_bf16 v[148:151], a[188:191], v[112:115], 0
v_cndmask_b32 v203, v28, v203, s[42:43]
CV 222,92,93
v_mfma_f32_16x16x32_bf16 v[168:171], a[188:191], v[124:127], 0
CV 223,94,95
CV 224,96,97
v_mfma_f32_16x16x32_bf16 v[152:155], a[192:195], v[112:115], 0
CV 225,98,99
CV 226,100,101
v_mfma_f32_16x16x32_bf16 v[172:175], a[192:195], v[124:127], 0
CV 227,102,103
CV 228,104,105
MV 136,196,116
CV 229,106,107
CV 230,108,109
MV 156,196,128
CV 231,110,111
v_cndmask_b32 v222, v222, v28, s[42:43]
MV 140,200,116
v_cndmask_b32 v231, v28, v231, s[42:43]
MV 160,200,128
MV 144,204,116
MV 164,204,128
MV 148,208,116
MV 168,208,128
MV 152,212,116
MV 172,212,128
MV 136,216,120
MV 156,216,132
MV 140,220,120
MV 160,220,132
MV 144,224,120
MV 164,224,132
MV 148,228,120
MV 168,228,132
MV 152,232,120
MV 172,232,132
WL 6
s_nop 0
v_mfma_f32_16x16x32_bf16 v[32:35], a[144:147], a[0:3], 0
RT 172,7,14368
RT 174,7,15136
v_mfma_f32_16x16x32_bf16 v[52:55], a[144:147], a[4:7], 0
s_add_u32 m0, s37, 64000
s_add_u32 s36, s47, 442368
v_mfma_f32_16x16x32_bf16 v[56:59], a[148:151], a[4:7], 0
RT 144,7,14376
RT 146,7,15144
v_mfma_f32_16x16x32_bf16 v[36:39], a[148:151], a[0:3], 0
buffer_load_dwordx4 v4, s[12:15], s36 offen offset:0  lds
v_mfma_f32_16x16x32_bf16 v[40:43], a[152:155], a[0:3], 0
RT 148,7,14384
RT 150,7,15152
v_mfma_f32_16x16x32_bf16 v[60:63], a[152:155], a[4:7], 0
v_max3_f32 v24, v136, v137, v138
v_min3_f32 v25, v136, v137, v138
v_mfma_f32_16x16x32_bf16 v[64:67], a[156:159], a[4:7], 0
RT 152,7,25600
RT 154,7,26368
v_mfma_f32_16x16x32_bf16 v[44:47], a[156:159], a[0:3], 0
WL 6
s_nop 0
v_max3_f32 v24, v24, v139, v140
v_min3_f32 v25, v25, v139, v140
v_max3_f32 v24, v24, v141, v142
v_min3_f32 v25, v25, v141, v142
v_max3_f32 v24, v24, v143, v144
v_min3_f32 v25, v25, v143, v144
v_max3_f32 v24, v24, v145, v146
v_min3_f32 v25, v25, v145, v146
v_max3_f32 v24, v24, v147, v148
v_min3_f32 v25, v25, v147, v148
v_max3_f32 v24, v24, v149, v150
v_min3_f32 v25, v25, v149, v150
v_max3_f32 v24, v24, v151, v152
v_mfma_f32_16x16x32_bf16 v[48:51], a[160:163], a[0:3], 0
RT 156,7,25608
RT 158,7,26376
v_mfma_f32_16x16x32_bf16 v[68:71], a[160:163], a[4:7], 0
buffer_load_dwordx4 v5, s[12:15], s36 offen offset:1024  lds
v_min3_f32 v25, v25, v151, v152
v_max_f32 v24, v24, v153
v_min_f32 v25, v25, v153
v_pk_mul_f32 v[24:25], v[24:25], v[14:15] op_sel:[0,0] op_sel_hi:[1,0]
v_pk_fma_f32 v[232:233], v[136:137], v[14:15], v[24:25] op_sel:[0,0,0] op_sel_hi:[1,0,0] neg_lo:[0,0,1] neg_hi:[0,0,1]
v_pk_fma_f32 v[136:137], v[136:137], v[14:15], v[24:25] op_sel:[0,0,1] op_sel_hi:[1,0,1] neg_lo:[0,1,0] neg_hi:[0,1,0]
v_pk_fma_f32 v[234:235], v[138:139], v[14:15], v[24:25] op_sel:[0,0,0] op_sel_hi:[1,0,0] neg_lo:[0,0,1] neg_hi:[0,0,1]
v_pk_fma_f32 v[138:139], v[138:139], v[14:15], v[24:25] op_sel:[0,0,1] op_sel_hi:[1,0,1] neg_lo:[0,1,0] neg_hi:[0,1,0]
v_pk_fma_f32 v[236:237], v[140:141], v[14:15], v[24:25] op_sel:[0,0,0] op_sel_hi:[1,0,0] neg_lo:[0,0,1] neg_hi:[0,0,1]
v_pk_fma_f32 v[140:141], v[140:141], v[14:15], v[24:25] op_sel:[0,0,1] op_sel_hi:[1,0,1] neg_lo:[0,1,0] neg_hi:[0,1,0]
v_pk_fma_f32 v[238:239], v[142:143], v[14:15], v[24:25] op_sel:[0,0,0] op_sel_hi:[1,0,0] neg_lo:[0,0,1] neg_hi:[0,0,1]
v_pk_fma_f32 v[142:143], v[142:143], v[14:15], v[24:25] op_sel:[0,0,1] op_sel_hi:[1,0,1] neg_lo:[0,1,0] neg_hi:[0,1,0]
v_pk_fma_f32 v[240:241], v[144:145], v[14:15], v[24:25] op_sel:[0,0,0] op_sel_hi:[1,0,0] neg_lo:[0,0,1] neg_hi:[0,0,1]
v_pk_fma_f32 v[144:145], v[144:145], v[14:15], v[24:25] op_sel:[0,0,1] op_sel_hi:[1,0,1] neg_lo:[0,1,0] neg_hi:[0,1,0]
v_pk_fma_f32 v[242:243], v[146:147], v[14:15], v[24:25] op_sel:[0,0,0] op_sel_hi:[1,0,0] neg_lo:[0,0,1] neg_hi:[0,0,1]
v_pk_fma_f32 v[146:147], v[146:147], v[14:15], v[24:25] op_sel:[0,0,1] op_sel_hi:[1,0,1] neg_lo:[0,1,0] neg_hi:[0,1,0]
v_pk_fma_f32 v[244:245], v[148:149], v[14:15], v[24:25] op_sel:[0,0,0] op_sel_hi:[1,0,0] neg_lo:[0,0,1] neg_hi:[0,0,1]
v_pk_fma_f32 v[148:149], v[148:149], v[14:15], v[24:25] op_sel:[0,0,1] op_sel_hi:[1,0,1] neg_lo:[0,1,0] neg_hi:[0,1,0]
v_pk_fma_f32 v[246:247], v[150:151], v[14:15], v[24:25] op_sel:[0,0,0] op_sel_hi:[1,0,0] neg_lo:[0,0,1] neg_hi:[0,0,1]
v_pk_fma_f32 v[150:151], v[150:151], v[14:15], v[24:25] op_sel:[0,0,1] op_sel_hi:[1,0,1] neg_lo:[0,1,0] neg_hi:[0,1,0]
v_pk_fma_f32 v[248:249], v[152:153], v[14:15], v[24:25] op_sel:[0,0,0] op_sel_hi:[1,0,0] neg_lo:[0,0,1] neg_hi:[0,0,1]
v_pk_fma_f32 v[152:153], v[152:153], v[14:15], v[24:25] op_sel:[0,0,1] op_sel_hi:[1,0,1] neg_lo:[0,1,0] neg_hi:[0,1,0]
s_nop 0
v_exp_f32 v232, v232
v_exp_f32 v136, v136
v_exp_f32 v233, v233
v_mfma_f32_16x16x32_bf16 v[92:95], a[164:167], a[4:7], 0
RT 160,7,25616
RT 162,7,26384
v_mfma_f32_16x16x32_bf16 v[72:75], a[164:167], a[0:3], 0
s_getpc_b64 s[6:7]
s_nop 0
s_load_dword s5, s[6:7], s101
v_mfma_f32_16x16x32_bf16 v[76:79], a[168:171], a[0:3], 0
RT 164,7,25624
RT 166,7,26392
v_mfma_f32_16x16x32_bf16 v[96:99], a[168:171], a[4:7], 0
buffer_load_dwordx4 v6, s[12:15], s36 offen offset:2048  lds
v_exp_f32 v137, v137
v_exp_f32 v234, v234
v_exp_f32 v138, v138
v_exp_f32 v235, v235
v_exp_f32 v139, v139
v_exp_f32 v236, v236
v_mfma_f32_16x16x32_bf16 v[100:103], a[172:175], a[4:7], 0
RT 168,7,25632
RT 170,7,26400
v_mfma_f32_16x16x32_bf16 v[80:83], a[172:175], a[0:3], 0
WL 6
s_add_u32 m0, s37, 76800
s_add_u32 s36, s47, 552960
v_exp_f32 v140, v140
v_exp_f32 v237, v237
v_exp_f32 v141, v141
v_exp_f32 v238, v238
v_exp_f32 v142, v142
v_exp_f32_e64 v239, v239
v_mfma_f32_16x16x32_bf16 v[84:87], a[144:147], a[0:3], 0
RT 172,7,27152
RT 174,7,27920
v_mfma_f32_16x16x32_bf16 v[104:107], a[144:147], a[4:7], 0
buffer_load_dwordx4 v4, s[12:15], s36 offen offset:0  lds
v_exp_f32 v143, v143
v_exp_f32 v240, v240
v_exp_f32 v144, v144
v_exp_f32 v241, v241
v_exp_f32 v145, v145
v_exp_f32 v242, v242
v_mfma_f32_16x16x32_bf16 v[108:111], a[148:151], a[4:7], 0
RT 144,7,27160
RT 146,7,27928
v_mfma_f32_16x16x32_bf16 v[88:91], a[148:151], a[0:3], 0
v_exp_f32 v146, v146
v_exp_f32 v243, v243
v_exp_f32 v147, v147
v_exp_f32 v244, v244
v_exp_f32 v148, v148
v_exp_f32 v245, v245
v_exp_f32_e64 v149, v149
MA 32,152,8
RT 148,7,27168
RT 150,7,27936
MA 52,152,12
buffer_load_dwordx4 v5, s[12:15], s36 offen offset:1024  lds
v_exp_f32 v246, v246
v_exp_f32 v150, v150
v_exp_f32 v247, v247
v_exp_f32 v151, v151
v_exp_f32 v248, v248
v_exp_f32 v152, v152
MA 56,156,12
RT 152,7,27176
RT 154,7,27944
MA 36,156,8
WL 6
v_exp_f32 v249, v249
v_exp_f32_e64 v153, v153
v_pk_add_f32 v[24:25], v[232:233], v[234:235]
v_pk_add_f32 v[26:27], v[136:137], v[138:139]
v_pk_add_f32 v[24:25], v[24:25], v[236:237]
v_pk_add_f32 v[26:27], v[26:27], v[140:141]
v_pk_add_f32 v[24:25], v[24:25], v[238:239]
v_pk_add_f32 v[26:27], v[26:27], v[142:143]
v_pk_add_f32 v[24:25], v[24:25], v[240:241]
v_pk_add_f32 v[26:27], v[26:27], v[144:145]
v_pk_add_f32 v[24:25], v[24:25], v[242:243]
v_pk_add_f32 v[26:27], v[26:27], v[146:147]
v_pk_add_f32 v[24:25], v[24:25], v[244:245]
v_pk_add_f32 v[26:27], v[26:27], v[148:149]
v_pk_add_f32 v[24:25], v[24:25], v[246:247]
v_pk_add_f32 v[26:27], v[26:27], v[150:151]
v_pk_add_f32 v[24:25], v[24:25], v[248:249]
v_pk_add_f32 v[26:27], v[26:27], v[152:153]
s_nop 0
v_add_f32 v24, v24, v25
v_add_f32 v25, v26, v27
v_rcp_f32 v24, v24
v_rcp_f32 v25, v25
s_nop 0
MA 40,160,8
RT 156,7,27184
RT 158,7,27952
MA 60,160,12
s_waitcnt vmcnt(5)
s_barrier
MA 64,164,12
RT 160,7,38400
RT 162,7,39168
MA 44,164,8
buffer_load_dwordx4 v6, s[12:15], s36 offen offset:2048  lds
v_pk_mul_f32 v[232:233], v[232:233], v[24:25] op_sel:[0,0] op_sel_hi:[1,0]
v_pk_mul_f32 v[136:137], v[136:137], v[24:25] op_sel:[0,1] op_sel_hi:[1,1]
v_pk_mul_f32 v[234:235], v[234:235], v[24:25] op_sel:[0,0] op_sel_hi:[1,0]
v_pk_mul_f32 v[138:139], v[138:139], v[24:25] op_sel:[0,1] op_sel_hi:[1,1]
v_pk_mul_f32 v[236:237], v[236:237], v[24:25] op_sel:[0,0] op_sel_hi:[1,0]
v_pk_mul_f32 v[140:141], v[140:141], v[24:25] op_sel:[0,1] op_sel_hi:[1,1]
v_pk_mul_f32 v[238:239], v[238:239], v[24:25] op_sel:[0,0] op_sel_hi:[1,0]
v_pk_mul_f32 v[142:143], v[142:143], v[24:25] op_sel:[0,1] op_sel_hi:[1,1]
v_pk_mul_f32 v[240:241], v[240:241], v[24:25] op_sel:[0,0] op_sel_hi:[1,0]
v_pk_mul_f32 v[144:145], v[144:145], v[24:25] op_sel:[0,1] op_sel_hi:[1,1]
v_pk_mul_f32 v[242:243], v[242:243], v[24:25] op_sel:[0,0] op_sel_hi:[1,0]
v_pk_mul_f32 v[146:147], v[146:147], v[24:25] op_sel:[0,1] op_sel_hi:[1,1]
v_pk_mul_f32 v[244:245], v[244:245], v[24:25] op_sel:[0,0] op_sel_hi:[1,0]
v_pk_mul_f32 v[148:149], v[148:149], v[24:25] op_sel:[0,1] op_sel_hi:[1,1]
v_pk_mul_f32 v[246:247], v[246:247], v[24:25] op_sel:[0,0] op_sel_hi:[1,0]
v_pk_mul_f32 v[150:151], v[150:151], v[24:25] op_sel:[0,1] op_sel_hi:[1,1]
v_pk_mul_f32 v[248:249], v[248:249], v[24:25] op_sel:[0,0] op_sel_hi:[1,0]
v_pk_mul_f32 v[152:153], v[152:153], v[24:25] op_sel:[0,1] op_sel_hi:[1,1]
s_nop 0
s_nop 0
CV 193,152,153
CV 192,150,151
CV 191,148,149
CV 190,146,147
CV 189,144,145
CV 188,142,143
CV 187,140,141
CV 186,138,139
CV 185,136,137
CV 176,232,233
MA 48,168,8
RT 164,7,38408
RT 166,7,39176
MA 68,168,12
s_add_u32 m0, s37, 0
s_nop 0
s_add_u32 s36, s47, 663552
CV 177,234,235
CV 178,236,237
CV 179,238,239
CV 180,240,241
CV 181,242,243
CV 182,244,245
CV 183,246,247
CV 184,248,249
ds_write_b128 v10, v[176:179] offset:0
ds_write_b128 v10, v[180:183] offset:16
ds_write_b128 v10, v[184:187] offset:32
ds_write_b128 v10, v[188:191] offset:48
MA 92,172,12
RT 168,7,38416
RT 170,7,39184
MA 72,172,8
WL 10
s_nop 0
ds_write_b128 v10, v[192:195] offset:64
ds_write_b128 v10, v[196:199] offset:80
ds_write_b128 v10, v[200:203] offset:96
v_max3_f32 v24, v156, v157, v158
v_min3_f32 v25, v156, v157, v158
v_max3_f32 v24, v24, v159, v160
v_min3_f32 v25, v25, v159, v160
v_max3_f32 v24, v24, v161, v162
v_min3_f32 v25, v25, v161, v162
v_max3_f32 v24, v24, v163, v164
v_min3_f32 v25, v25, v163, v164
v_max3_f32 v24, v24, v165, v166
v_min3_f32 v25, v25, v165, v166
MA 76,144,8
RT 172,7,38424
RT 174,7,39192
MA 96,144,12
buffer_load_dwordx4 v4, s[12:15], s36 offen offset:0  lds
v_max3_f32 v24, v24, v167, v168
v_min3_f32 v25, v25, v167, v168
v_max3_f32 v24, v24, v169, v170
v_min3_f32 v25, v25, v169, v170
v_max3_f32 v24, v24, v171, v172
v_min3_f32 v25, v25, v171, v172
v_max_f32 v24, v24, v173
v_min_f32 v25, v25, v173
v_pk_mul_f32 v[24:25], v[24:25], v[14:15] op_sel:[0,1] op_sel_hi:[1,1]
v_pk_fma_f32 v[232:233], v[156:157], v[14:15], v[24:25] op_sel:[0,1,0] op_sel_hi:[1,1,0] neg_lo:[0,0,1] neg_hi:[0,0,1]
v_pk_fma_f32 v[156:157], v[156:157], v[14:15], v[24:25] op_sel:[0,1,1] op_sel_hi:[1,1,1] neg_lo:[0,1,0] neg_hi:[0,1,0]
v_pk_fma_f32 v[234:235], v[158:159], v[14:15], v[24:25] op_sel:[0,1,0] op_sel_hi:[1,1,0] neg_lo:[0,0,1] neg_hi:[0,0,1]
v_pk_fma_f32 v[158:159], v[158:159], v[14:15], v[24:25] op_sel:[0,1,1] op_sel_hi:[1,1,1] neg_lo:[0,1,0] neg_hi:[0,1,0]
v_pk_fma_f32 v[236:237], v[160:161], v[14:15], v[24:25] op_sel:[0,1,0] op_sel_hi:[1,1,0] neg_lo:[0,0,1] neg_hi:[0,0,1]
v_pk_fma_f32 v[160:161], v[160:161], v[14:15], v[24:25] op_sel:[0,1,1] op_sel_hi:[1,1,1] neg_lo:[0,1,0] neg_hi:[0,1,0]
v_pk_fma_f32 v[238:239], v[162:163], v[14:15], v[24:25] op_sel:[0,1,0] op_sel_hi:[1,1,0] neg_lo:[0,0,1] neg_hi:[0,0,1]
v_pk_fma_f32 v[162:163], v[162:163], v[14:15], v[24:25] op_sel:[0,1,1] op_sel_hi:[1,1,1] neg_lo:[0,1,0] neg_hi:[0,1,0]
v_pk_fma_f32 v[240:241], v[164:165], v[14:15], v[24:25] op_sel:[0,1,0] op_sel_hi:[1,1,0] neg_lo:[0,0,1] neg_hi:[0,0,1]
v_pk_fma_f32 v[164:165], v[164:165], v[14:15], v[24:25] op_sel:[0,1,1] op_sel_hi:[1,1,1] neg_lo:[0,1,0] neg_hi:[0,1,0]
v_pk_fma_f32 v[242:243], v[166:167], v[14:15], v[24:25] op_sel:[0,1,0] op_sel_hi:[1,1,0] neg_lo:[0,0,1] neg_hi:[0,0,1]
v_pk_fma_f32 v[166:167], v[166:167], v[14:15], v[24:25] op_sel:[0,1,1] op_sel_hi:[1,1,1] neg_lo:[0,1,0] neg_hi:[0,1,0]
v_pk_fma_f32 v[244:245], v[168:169], v[14:15], v[24:25] op_sel:[0,1,0] op_sel_hi:[1,1,0] neg_lo:[0,0,1] neg_hi:[0,0,1]
v_pk_fma_f32 v[168:169], v[168:169], v[14:15], v[24:25] op_sel:[0,1,1] op_sel_hi:[1,1,1] neg_lo:[0,1,0] neg_hi:[0,1,0]
v_pk_fma_f32 v[246:247], v[170:171], v[14:15], v[24:25] op_sel:[0,1,0] op_sel_hi:[1,1,0] neg_lo:[0,0,1] neg_hi:[0,0,1]
v_pk_fma_f32 v[170:171], v[170:171], v[14:15], v[24:25] op_sel:[0,1,1] op_sel_hi:[1,1,1] neg_lo:[0,1,0] neg_hi:[0,1,0]
v_pk_fma_f32 v[248:249], v[172:173], v[14:15], v[24:25] op_sel:[0,1,0] op_sel_hi:[1,1,0] neg_lo:[0,0,1] neg_hi:[0,0,1]
v_pk_fma_f32 v[172:173], v[172:173], v[14:15], v[24:25] op_sel:[0,1,1] op_sel_hi:[1,1,1] neg_lo:[0,1,0] neg_hi:[0,1,0]
s_nop 0
v_exp_f32 v232, v232
MA 100,148,12
RT 144,7,38432
RT 146,7,39200
MA 80,148,8
s_getpc_b64 s[6:7]
s_nop 0
s_load_dword s5, s[6:7], s101
MA 84,152,8
RT 148,7,39952
RT 150,7,40720
MA 104,152,12
buffer_load_dwordx4 v5, s[12:15], s36 offen offset:1024  lds
v_exp_f32 v156, v156
v_exp_f32 v233, v233
v_exp_f32 v157, v157
v_exp_f32 v234, v234
v_exp_f32 v158, v158
v_exp_f32 v235, v235
MA 108,156,12
RT 152,7,39960
RT 154,7,40728
MA 88,156,8
WL 6
v_exp_f32 v159, v159
v_exp_f32 v236, v236
v_exp_f32 v160, v160
v_exp_f32 v237, v237
v_exp_f32 v161, v161
v_exp_f32_e64 v238, v238
MA 32,160,16
RT 156,7,39968
RT 158,7,40736
MA 52,160,20
buffer_load_dwordx4 v6, s[12:15], s36 offen offset:2048  lds
v_exp_f32 v162, v162
v_exp_f32 v239, v239
v_exp_f32 v163, v163
v_exp_f32 v240, v240
v_exp_f32 v164, v164
v_exp_f32 v241, v241
MA 56,164,20
RT 160,7,39976
RT 162,7,40744
MA 36,164,16
s_add_u32 m0, s37, 12800
s_add_u32 s36, s47, 774144
v_exp_f32 v165, v165
v_exp_f32 v242, v242
v_exp_f32 v166, v166
v_exp_f32 v243, v243
v_exp_f32 v167, v167
v_exp_f32 v244, v244
MA 40,168,16
RT 164,7,39984
RT 166,7,40752
MA 60,168,20
v_exp_f32 v168, v168
v_exp_f32 v245, v245
v_exp_f32 v169, v169
v_exp_f32 v246, v246
v_exp_f32 v170, v170
v_exp_f32 v247, v247
v_exp_f32_e64 v171, v171
MA 64,172,20
RT 168,7,51200
RT 170,7,51968
MA 44,172,16
WL 6
v_exp_f32 v248, v248
v_exp_f32 v172, v172
v_exp_f32 v249, v249
v_exp_f32_e64 v173, v173
v_pk_add_f32 v[24:25], v[232:233], v[234:235]
v_pk_add_f32 v[26:27], v[156:157], v[158:159]
v_pk_add_f32 v[24:25], v[24:25], v[236:237]
v_pk_add_f32 v[26:27], v[26:27], v[160:161]
v_pk_add_f32 v[24:25], v[24:25], v[238:239]
v_pk_add_f32 v[26:27], v[26:27], v[162:163]
v_pk_add_f32 v[24:25], v[24:25], v[240:241]
v_pk_add_f32 v[26:27], v[26:27], v[164:165]
v_pk_add_f32 v[24:25], v[24:25], v[242:243]
v_pk_add_f32 v[26:27], v[26:27], v[166:167]
v_pk_add_f32 v[24:25], v[24:25], v[244:245]
v_pk_add_f32 v[26:27], v[26:27], v[168:169]
v_pk_add_f32 v[24:25], v[24:25], v[246:247]
v_pk_add_f32 v[26:27], v[26:27], v[170:171]
v_pk_add_f32 v[24:25], v[24:25], v[248:249]
v_pk_add_f32 v[26:27], v[26:27], v[172:173]
s_nop 0
v_add_f32 v24, v24, v25
v_add_f32_e64 v25, v26, v27
MA 48,144,16
RT 172,7,51208
RT 174,7,51976
MA 68,144,20
buffer_load_dwordx4 v4, s[12:15], s36 offen offset:0  lds
v_rcp_f32 v24, v24
v_rcp_f32 v25, v25
s_nop 0
s_nop 0
v_pk_mul_f32 v[232:233], v[232:233], v[24:25] op_sel:[0,0] op_sel_hi:[1,0]
v_pk_mul_f32 v[156:157], v[156:157], v[24:25] op_sel:[0,1] op_sel_hi:[1,1]
v_pk_mul_f32 v[234:235], v[234:235], v[24:25] op_sel:[0,0] op_sel_hi:[1,0]
v_pk_mul_f32 v[158:159], v[158:159], v[24:25] op_sel:[0,1] op_sel_hi:[1,1]
v_pk_mul_f32 v[236:237], v[236:237], v[24:25] op_sel:[0,0] op_sel_hi:[1,0]
v_pk_mul_f32 v[160:161], v[160:161], v[24:25] op_sel:[0,1] op_sel_hi:[1,1]
v_pk_mul_f32 v[238:239], v[238:239], v[24:25] op_sel:[0,0] op_sel_hi:[1,0]
v_pk_mul_f32 v[162:163], v[162:163], v[24:25] op_sel:[0,1] op_sel_hi:[1,1]
v_pk_mul_f32 v[240:241], v[240:241], v[24:25] op_sel:[0,0] op_sel_hi:[1,0]
v_pk_mul_f32 v[164:165], v[164:165], v[24:25] op_sel:[0,1] op_sel_hi:[1,1]
v_pk_mul_f32 v[242:243], v[242:243], v[24:25] op_sel:[0,0] op_sel_hi:[1,0]
v_pk_mul_f32 v[166:167], v[166:167], v[24:25] op_sel:[0,1] op_sel_hi:[1,1]
v_pk_mul_f32 v[244:245], v[244:245], v[24:25] op_sel:[0,0] op_sel_hi:[1,0]
v_pk_mul_f32 v[168:169], v[168:169], v[24:25] op_sel:[0,1] op_sel_hi:[1,1]
v_pk_mul_f32 v[246:247], v[246:247], v[24:25] op_sel:[0,0] op_sel_hi:[1,0]
v_pk_mul_f32 v[170:171], v[170:171], v[24:25] op_sel:[0,1] op_sel_hi:[1,1]
v_pk_mul_f32 v[248:249], v[248:249], v[24:25] op_sel:[0,0] op_sel_hi:[1,0]
v_pk_mul_f32 v[172:173], v[172:173], v[24:25] op_sel:[0,1] op_sel_hi:[1,1]
s_nop 0
s_nop 0
CV 221,172,173
CV 220,170,171
CV 219,168,169
CV 218,166,167
CV 217,164,165
MA 92,148,20
RT 144,7,51216
RT 146,7,51984
MA 72,148,16
CV 216,162,163
CV 215,160,161
CV 214,158,159
CV 213,156,157
CV 204,232,233
CV 205,234,235
CV 206,236,237
CV 207,238,239
CV 208,240,241
CV 209,242,243
CV 210,244,245
CV 211,246,247
CV 212,248,249
ds_write_b128 v10, v[204:207] offset:1792
MA 76,152,16
RT 148,7,51224
RT 150,7,51992
MA 96,152,20
ds_write_b128 v10, v[208:211] offset:1808
ds_write_b128 v10, v[212:215] offset:1824
ds_write_b128 v10, v[216:219] offset:1840
ds_write_b128 v10, v[220:223] offset:1856
ds_write_b128 v10, v[224:227] offset:1872
ds_write_b128 v10, v[228:231] offset:1888
v_cmp_eq_u32_e64 vcc, 0, v22
v_cmp_gt_u32 s[54:55], 4, v23
v_mov_b32_e64 v28, 0x40000000
s_add_u32 s35, s51, 188416
v_cndmask_b32_e64 v25, v28, v12, vcc
v_lshl_add_u32 v26, v22, 2, v23
v_lshlrev_b32 v26, 4, v26
v_cmp_gt_u32 vcc, 2, v22
MA 100,156,20
RT 152,7,51232
RT 154,7,52000
MA 80,156,16
WL 13
v_cndmask_b32 v26, v28, v26, s[54:55]
s_nop 0
v_cndmask_b32_e64 v27, v28, v26, vcc
MA 84,160,16
RT 156,7,52752
RT 158,7,53520
MA 104,160,20
buffer_load_dwordx4 v5, s[12:15], s36 offen offset:1024  lds
MA 108,164,20
RT 160,7,52760
RT 162,7,53528
MA 88,164,16
s_getpc_b64 s[6:7]
s_nop 0
s_load_dword s5, s[6:7], s101
MA 32,168,24
RT 164,7,52768
RT 166,7,53536
MA 52,168,28
MA 56,172,28
RT 168,7,52776
RT 170,7,53544
MA 36,172,24
WL 6
s_nop 0
MA 40,144,24
RT 172,7,52784
RT 174,7,53552
MA 60,144,28
WL 12
s_waitcnt vmcnt(5)
s_barrier
s_nop 0
MA 64,148,28
RT 144,7,64000
RT 146,7,64768
MA 44,148,24
buffer_load_dwordx4 v6, s[12:15], s36 offen offset:2048  lds
ds_read_b64_tr_b16 v[136:137], v11 offset:0
ds_read_b64_tr_b16 v[138:139], v11 offset:448
ds_read_b64_tr_b16 v[140:141], v11 offset:32
ds_read_b64_tr_b16 v[142:143], v11 offset:480
ds_read_b64_tr_b16 v[144:145], v11 offset:64
ds_read_b64_tr_b16 v[146:147], v11 offset:512
ds_read_b64_tr_b16 v[148:149], v11 offset:72
ds_read_b64_tr_b16 v[150:151], v11 offset:520
ds_read_b64_tr_b16 v[152:153], v11 offset:104
ds_read_b64_tr_b16 v[154:155], v11 offset:552
ds_read_b64_tr_b16 v[156:157], v11 offset:3584
ds_read_b64_tr_b16 v[158:159], v11 offset:4032
MA 48,152,24
RT 148,7,64008
RT 150,7,64776
MA 68,152,28
s_add_u32 m0, s37, 25600
s_add_u32 s36, s47, 884736
ds_read_b64_tr_b16 v[160:161], v11 offset:3616
ds_read_b64_tr_b16 v[162:163], v11 offset:4064
ds_read_b64_tr_b16 v[164:165], v11 offset:3648
ds_read_b64_tr_b16 v[166:167], v11 offset:4096
ds_read_b64_tr_b16 v[168:169], v11 offset:3656
ds_read_b64_tr_b16 v[170:171], v11 offset:4104
ds_read_b64_tr_b16 v[172:173], v11 offset:3688
ds_read_b64_tr_b16 v[174:175], v11 offset:4136
ds_read_b64_tr_b16 v[176:177], v11 offset:7168
ds_read_b64_tr_b16 v[178:179], v11 offset:7616
ds_read_b64_tr_b16 v[180:181], v11 offset:7200
ds_read_b64_tr_b16 v[182:183], v11 offset:7648
MA 92,156,28
RT 152,7,64016
RT 154,7,64784
MA 72,156,24
WL 15
s_nop 0
ds_read_b64_tr_b16 v[184:185], v11 offset:7232
ds_read_b64_tr_b16 v[186:187], v11 offset:7680
ds_read_b64_tr_b16 v[188:189], v11 offset:7240
ds_read_b64_tr_b16 v[190:191], v11 offset:7688
ds_read_b64_tr_b16 v[192:193], v11 offset:7272
ds_read_b64_tr_b16 v[194:195], v11 offset:7720
ds_read_b64_tr_b16 v[196:197], v11 offset:10752
ds_read_b64_tr_b16 v[198:199], v11 offset:11200
ds_read_b64_tr_b16 v[200:201], v11 offset:10784
ds_read_b64_tr_b16 v[202:203], v11 offset:11232
ds_read_b64_tr_b16 v[204:205], v11 offset:10816
ds_read_b64_tr_b16 v[206:207], v11 offset:11264
ds_read_b64_tr_b16 v[208:209], v11 offset:10824
MA 76,160,24
RT 156,7,64024
RT 158,7,64792
MA 96,160,28
buffer_load_dwordx4 v4, s[12:15], s36 offen offset:0  lds
ds_read_b64_tr_b16 v[210:211], v11 offset:11272
ds_read_b64_tr_b16 v[212:213], v11 offset:10856
ds_read_b64_tr_b16 v[214:215], v11 offset:11304
MA 100,164,28
RT 160,7,64032
RT 162,7,64800
MA 80,164,24
MA 84,168,24
RT 164,8,16
RT 166,8,784
MA 104,168,28
buffer_load_dwordx4 v5, s[12:15], s36 offen offset:1024  lds
WL 4
s_nop 0
v_mfma_f32_16x16x32_bf16 v[112:115], v[136:139], v[148:151], 0
v_mfma_f32_16x16x32_bf16 v[116:119], v[136:139], v[152:155], 0
v_mfma_f32_16x16x32_bf16 v[120:123], v[140:143], v[148:151], 0
v_mfma_f32_16x16x32_bf16 v[124:127], v[140:143], v[152:155], 0
v_mfma_f32_16x16x32_bf16 v[128:131], v[144:147], v[148:151], 0
MA 108,172,28
RT 168,8,24
RT 170,8,792
MA 88,172,24
WL 9
s_nop 0
v_mfma_f32_16x16x32_bf16 v[132:135], v[144:147], v[152:155], 0
v_mfma_f32_16x16x32_bf16 v[112:115], v[156:159], v[168:171], v[112:115]
v_mfma_f32_16x16x32_bf16 v[116:119], v[156:159], v[172:175], v[116:119]
v_mfma_f32_16x16x32_bf16 v[120:123], v[160:163], v[168:171], v[120:123]
v_mfma_f32_16x16x32_bf16 v[124:127], v[160:163], v[172:175], v[124:127]
v_mfma_f32_16x16x32_bf16 v[128:131], v[164:167], v[168:171], v[128:131]
MA 32,144,32
RT 172,8,32
RT 174,8,800
MA 52,144,36
buffer_load_dwordx4 v6, s[12:15], s36 offen offset:2048  lds
v_mfma_f32_16x16x32_bf16 v[132:135], v[164:167], v[172:175], v[132:135]
v_mfma_f32_16x16x32_bf16 v[112:115], v[176:179], v[188:191], v[112:115]
v_mfma_f32_16x16x32_bf16 v[116:119], v[176:179], v[192:195], v[116:119]
v_mfma_f32_16x16x32_bf16 v[120:123], v[180:183], v[188:191], v[120:123]
v_mfma_f32_16x16x32_bf16 v[124:127], v[180:183], v[192:195], v[124:127]
v_mfma_f32_16x16x32_bf16 v[128:131], v[184:187], v[188:191], v[128:131]
MA 56,148,36
RT 144,8,40
RT 146,8,808
MA 36,148,32
s_getpc_b64 s[6:7]
s_nop 0
s_load_dword s5, s[6:7], s101
MA 40,152,32
RT 148,8,48
RT 150,8,816
MA 60,152,36
s_add_u32 m0, s37, 38400
s_add_u32 s36, s47, 995328
v_mfma_f32_16x16x32_bf16 v[132:135], v[184:187], v[192:195], v[132:135]
v_mfma_f32_16x16x32_bf16 v[112:115], v[196:199], v[208:211], v[112:115]
v_mfma_f32_16x16x32_bf16 v[116:119], v[196:199], v[212:215], v[116:119]
v_mfma_f32_16x16x32_bf16 v[120:123], v[200:203], v[208:211], v[120:123]
v_mfma_f32_16x16x32_bf16 v[124:127], v[200:203], v[212:215], v[124:127]
v_mfma_f32_16x16x32_bf16 v[128:131], v[204:207], v[208:211], v[128:131]
MA 64,156,36
RT 152,8,11264
RT 154,8,12032
MA 44,156,32
WL 6
s_nop 0
v_mfma_f32_16x16x32_bf16 v[132:135], v[204:207], v[212:215], v[132:135]
MA 48,160,32
RT 156,8,11272
RT 158,8,12040
MA 68,160,36
buffer_load_dwordx4 v4, s[12:15], s36 offen offset:0  lds
MA 92,164,36
RT 160,8,11280
RT 162,8,12048
MA 72,164,32
MA 76,168,32
RT 164,8,11288
RT 166,8,12056
MA 96,168,36
s_nop 0
s_nop 0
buffer_store_dwordx4 v[112:115], v12, s[20:23], s35 offen offset:0 sc1
buffer_store_dwordx4 v[116:119], v26, s[20:23], s35 offen offset:2304 sc1
buffer_store_dwordx4 v[120:123], v12, s[20:23], s35 offen offset:1024 sc1
buffer_store_dwordx4 v[124:127], v26, s[20:23], s35 offen offset:2560 sc1
buffer_store_dwordx4 v[128:131], v25, s[20:23], s35 offen offset:2048 sc1
buffer_store_dwordx4 v[132:135], v27, s[20:23], s35 offen offset:2816 sc1
s_mul_i32 s96, s32, 25
s_nop 0
MA 100,172,36
RT 168,8,11296
RT 170,8,12064
MA 80,172,32
WL 6
v_add_u32 v28, s96, v0
v_mul_u32_u24 v31, 3277, v28
v_lshrrev_b32_e64 v31, 16, v31
MA 84,144,32
RT 172,8,12816
RT 174,8,13584
MA 104,144,36
buffer_load_dwordx4 v5, s[12:15], s36 offen offset:1024  lds
v_mul_u32_u24 v29, 20, v31
v_sub_u32 v29, v28, v29
MA 108,148,36
RT 144,8,12824
RT 146,8,13592
MA 88,148,32
s_and_b32 s96, s33, 1
s_mul_i32 s96, s96, 5
v_add_u32 v31, s96, v31
v_cmp_gt_u32 vcc, 25, v0
MA 32,152,40
RT 148,8,12832
RT 150,8,13600
MA 52,152,44
v_cmp_gt_u32 s[54:55], 9, v31
v_cmp_gt_u32 s[56:57], 16, v29
v_lshlrev_b32 v24, 8, v31
v_lshlrev_b32 v25, 6, v31
MA 56,156,44
RT 152,8,12840
RT 154,8,13608
MA 36,156,40
WL 6
s_nop 0
v_add_u32 v25, 2048, v25
v_cndmask_b32 v24, v25, v24, s[56:57]
v_lshl_add_u32 v24, v29, 4, v24
MA 40,160,40
RT 156,8,12848
RT 158,8,13616
MA 60,160,44
s_waitcnt vmcnt(11)
s_barrier
MA 64,164,44
RT 160,7,0
RT 162,7,768
MA 44,164,40
s_getpc_b64 s[6:7]
s_nop 0
s_load_dword s5, s[6:7], s101
MA 48,168,40
RT 164,7,8
RT 166,7,776
MA 68,168,44
buffer_load_dwordx4 v6, s[12:15], s36 offen offset:2048  lds
v_mul_u32_u24 v25, 160, v31
v_lshl_add_u32 v25, v29, 3, v25
MA 92,172,44
RT 168,7,16
RT 170,7,784
MA 72,172,40
WL 6
s_add_u32 m0, s37, 51200
s_add_u32 s36, s47, 1105920
v_mov_b32 v28, 0x40000000
v_cndmask_b32_e64 v24, v28, v24, vcc
MA 76,144,40
RT 172,7,24
RT 174,7,792
MA 96,144,44
buffer_load_dwordx4 v4, s[12:15], s36 offen offset:0  lds
v_cndmask_b32 v24, v28, v24, s[54:55]
v_cndmask_b32_e64 v12, v28, v25, vcc
MA 100,148,44
RT 144,7,32
RT 146,7,800
MA 80,148,40
s_lshl_b32 s96, s34, 3
s_lshr_b32 s95, s33, 1
s_add_u32 s96, s96, s95
s_nop 0
s_mul_i32 s35, s96, 47104
MA 84,152,40
RT 148,7,1552
RT 150,7,2320
MA 104,152,44
buffer_load_dwordx4 v5, s[12:15], s36 offen offset:1024  lds
s_add_u32 s35, s35, 0x2510000
s_mul_i32 s95, s96, 1600
MA 108,156,44
RT 152,7,1560
RT 154,7,2328
MA 88,156,40
WL 6
s_nop 0
s_add_u32 s95, s95, 0x2700000
MA 32,160,48
RT 156,7,1568
RT 158,7,2336
MA 52,160,52
buffer_load_dwordx4 v6, s[12:15], s36 offen offset:2048  lds
MA 56,164,52
RT 160,7,1576
RT 162,7,2344
MA 36,164,48
s_add_u32 m0, s37, 64000
s_add_u32 s36, s47, 1216512
MA 40,168,48
RT 164,7,1584
RT 166,7,2352
MA 60,168,52
MA 64,172,52
RT 168,7,12800
RT 170,7,13568
MA 44,172,48
WL 6
s_nop 0
MA 48,144,48
RT 172,7,12808
RT 174,7,13576
MA 68,144,52
buffer_load_dwordx4 v4, s[12:15], s36 offen offset:0  lds
MA 92,148,52
RT 144,7,12816
RT 146,7,13584
MA 72,148,48
s_getpc_b64 s[6:7]
s_nop 0
s_load_dword s5, s[6:7], s101
MA 76,152,48
RT 148,7,12824
RT 150,7,13592
MA 96,152,52
MA 100,156,52
RT 152,7,12832
RT 154,7,13600
MA 80,156,48
WL 6
s_nop 0
MA 84,160,48
RT 156,7,14352
RT 158,7,15120
MA 104,160,52
buffer_load_dwordx4 v5, s[12:15], s36 offen offset:1024  lds
MA 108,164,52
RT 160,7,14360
RT 162,7,15128
MA 88,164,48
MA 32,168,56
RT 164,7,14368
RT 166,7,15136
MA 52,168,60
MA 56,172,60
RT 168,7,14376
RT 170,7,15144
MA 36,172,56
WL 6
s_nop 0
MA 40,144,56
RT 172,7,14384
RT 174,7,15152
MA 60,144,60
s_waitcnt vmcnt(7)
s_waitcnt vmcnt(5)
s_barrier
v_mov_b32 v28, s97
buffer_store_dword v28, v20, s[20:23], s63 offen offset:0 sc1
MA 64,148,60
RT 144,7,25600
RT 146,7,26368
MA 44,148,56
buffer_load_dwordx4 v6, s[12:15], s36 offen offset:2048  lds
MA 48,152,56
RT 148,7,25608
RT 150,7,26376
MA 68,152,60
s_add_u32 m0, s37, 76800
s_add_u32 s36, s47, 1327104
MA 92,156,60
RT 152,7,25616
RT 154,7,26384
MA 72,156,56
WL 6
v_mov_b32 v29, v18
MA 76,160,56
RT 156,7,25624
RT 158,7,26392
MA 96,160,60
buffer_load_dwordx4 v4, s[12:15], s36 offen offset:0  lds
RT 176,29,0
MA 100,164,60
RT 160,7,25632
RT 162,7,26400
MA 80,164,56
s_getpc_b64 s[6:7]
s_nop 0
s_load_dword s5, s[6:7], s101
MA 84,168,56
RT 164,7,27152
RT 166,7,27920
MA 104,168,60
buffer_load_dwordx4 v5, s[12:15], s36 offen offset:1024  lds
RT 178,29,160
MA 108,172,60
RT 168,7,27160
RT 170,7,27928
MA 88,172,56
WL 8
s_nop 0
RT 180,29,8
RT 182,29,168
MA 32,144,64
RT 172,7,27168
RT 174,7,27936
MA 52,144,68
buffer_load_dwordx4 v6, s[12:15], s36 offen offset:2048  lds
RT 184,29,16
MA 56,148,68
RT 144,7,27176
RT 146,7,27944
MA 36,148,64
s_add_u32 m0, s37, 0
s_nop 0
s_add_u32 s36, s47, 1437696
RT 186,29,176
MA 40,152,64
RT 148,7,27184
RT 150,7,27952
MA 60,152,68
RT 188,29,24
RT 190,29,184
RT 192,29,32
MA 64,156,68
RT 152,7,38400
RT 154,7,39168
MA 44,156,64
WL 11
RT 194,29,192
v_add_u32 v29, v29, v19
MA 48,160,64
RT 156,7,38408
RT 158,7,39176
MA 68,160,68
buffer_load_dwordx4 v4, s[12:15], s36 offen offset:0  lds
RT 196,29,0
MA 92,164,68
RT 160,7,38416
RT 162,7,39184
MA 72,164,64
RT 198,29,160
RT 200,29,8
RT 202,29,168
MA 76,168,64
RT 164,7,38424
RT 166,7,39192
MA 96,168,68
RT 204,29,16
RT 206,29,176
RT 208,29,24
MA 100,172,68
RT 168,7,38432
RT 170,7,39200
MA 80,172,64
WL 13
s_nop 0
RT 210,29,184
RT 212,29,32
MA 84,144,64
RT 172,7,39952
RT 174,7,40720
MA 104,144,68
buffer_load_dwordx4 v5, s[12:15], s36 offen offset:1024  lds
RT 214,29,192
MA 108,148,68
RT 144,7,39960
RT 146,7,40728
MA 88,148,64
s_getpc_b64 s[6:7]
s_nop 0
s_load_dword s5, s[6:7], s101
MA 32,152,72
RT 148,7,39968
RT 150,7,40736
MA 52,152,76
v_add_u32_e64 v29, v29, v19
RT 216,29,0
RT 218,29,160
MA 56,156,76
RT 152,7,39976
RT 154,7,40744
MA 36,156,72
WL 9
s_nop 0
RT 220,29,8
RT 222,29,168
MA 40,160,72
RT 156,7,39984
RT 158,7,40752
MA 60,160,76
s_waitcnt vmcnt(5)
s_barrier
MA 64,164,76
RT 160,7,51200
RT 162,7,51968
MA 44,164,72
buffer_load_dwordx4 v6, s[12:15], s36 offen offset:2048  lds
RT 224,29,16
MA 48,168,72
RT 164,7,51208
RT 166,7,51976
MA 68,168,76
s_add_u32 m0, s37, 12800
s_add_u32 s36, s47, 1548288
RT 226,29,176
MA 92,172,76
RT 168,7,51216
RT 170,7,51984
MA 72,172,72
WL 8
s_nop 0
RT 228,29,24
RT 230,29,184
MA 76,144,72
RT 172,7,51224
RT 174,7,51992
MA 96,144,76
buffer_load_dwordx4 v4, s[12:15], s36 offen offset:0  lds
RT 232,29,32
MA 100,148,76
RT 144,7,51232
RT 146,7,52000
MA 80,148,72
RT 234,29,192
buffer_load_dword v251, v250, s[20:23], s52 offen sc1
MA 84,152,72
RT 148,7,52752
RT 150,7,53520
MA 104,152,76
buffer_load_dwordx4 v5, s[12:15], s36 offen offset:1024  lds
MA 108,156,76
RT 152,7,52760
RT 154,7,53528
MA 88,156,72
WL 8
s_nop 0
MA 32,160,80
RT 156,7,52768
RT 158,7,53536
MA 52,160,84
buffer_load_dwordx4 v6, s[12:15], s36 offen offset:2048  lds
MA 56,164,84
RT 160,7,52776
RT 162,7,53544
MA 36,164,80
s_getpc_b64 s[6:7]
s_nop 0
s_load_dword s5, s[6:7], s101
MA 40,168,80
RT 164,7,52784
RT 166,7,53552
MA 60,168,84
s_add_u32 m0, s37, 25600
s_add_u32 s36, s47, 1658880
MA 64,172,84
RT 168,7,64000
RT 170,7,64768
MA 44,172,80
WL 6
s_nop 0
MA 48,144,80
RT 172,7,64008
RT 174,7,64776
MA 68,144,84
buffer_load_dwordx4 v4, s[12:15], s36 offen offset:0  lds
MA 92,148,84
RT 144,7,64016
RT 146,7,64784
MA 72,148,80
MA 76,152,80
RT 148,7,64024
RT 150,7,64792
MA 96,152,84
MA 100,156,84
RT 152,7,64032
RT 154,7,64800
MA 80,156,80
WL 6
s_nop 0
MA 84,160,80
RT 156,8,16
RT 158,8,784
MA 104,160,84
buffer_load_dwordx4 v5, s[12:15], s36 offen offset:1024  lds
MA 108,164,84
RT 160,8,24
RT 162,8,792
MA 88,164,80
MA 32,168,88
RT 164,8,32
RT 166,8,800
MA 52,168,92
MA 56,172,92
RT 168,8,40
RT 170,8,808
MA 36,172,88
WL 6
s_nop 0
MA 40,144,88
RT 172,8,48
RT 174,8,816
MA 60,144,92
s_waitcnt vmcnt(6)
s_barrier
MA 64,148,92
RT 144,8,11264
RT 146,8,12032
MA 44,148,88
s_getpc_b64 s[6:7]
s_nop 0
s_load_dword s5, s[6:7], s101
MA 48,152,88
RT 148,8,11272
RT 150,8,12040
MA 68,152,92
buffer_load_dwordx4 v6, s[12:15], s36 offen offset:2048  lds
MA 92,156,92
RT 152,8,11280
RT 154,8,12048
MA 72,156,88
WL 6
s_nop 0
s_add_u32 m0, s37, 38400
s_add_u32 s36, s47, 1769472
MA 76,160,88
RT 156,8,11288
RT 158,8,12056
MA 96,160,92
buffer_load_dwordx4 v4, s[12:15], s36 offen offset:0  lds
MA 100,164,92
RT 160,8,11296
RT 162,8,12064
MA 80,164,88
MA 84,168,88
RT 164,8,12816
RT 166,8,13584
MA 104,168,92
buffer_load_dwordx4 v5, s[12:15], s36 offen offset:1024  lds
MA 108,172,92
RT 168,8,12824
RT 170,8,13592
MA 88,172,88
WL 6
s_nop 0
MA 32,144,96
RT 172,8,12832
RT 174,8,13600
MA 52,144,100
buffer_load_dwordx4 v6, s[12:15], s36 offen offset:2048  lds
MA 56,148,100
RT 144,8,12840
RT 146,8,13608
MA 36,148,96
s_add_u32 m0, s37, 51200
s_add_u32 s36, s47, 1880064
MA 40,152,96
RT 148,8,12848
RT 150,8,13616
MA 60,152,100
MA 64,156,100
RT 152,7,0
RT 154,7,768
MA 44,156,96
WL 6
s_nop 0
MA 48,160,96
RT 156,7,8
RT 158,7,776
MA 68,160,100
buffer_load_dwordx4 v4, s[12:15], s36 offen offset:0  lds
MA 92,164,100
RT 160,7,16
RT 162,7,784
MA 72,164,96
s_getpc_b64 s[6:7]
s_nop 0
s_load_dword s5, s[6:7], s101
MA 76,168,96
RT 164,7,24
RT 166,7,792
MA 96,168,100
MA 100,172,100
RT 168,7,32
RT 170,7,800
MA 80,172,96
WL 6
s_nop 0
MA 84,144,96
RT 172,7,1552
RT 174,7,2320
MA 104,144,100
buffer_load_dwordx4 v5, s[12:15], s36 offen offset:1024  lds
MA 108,148,100
RT 144,7,1560
RT 146,7,2328
MA 88,148,96
MA 32,152,104
RT 148,7,1568
RT 150,7,2336
MA 52,152,108
MA 56,156,108
RT 152,7,1576
RT 154,7,2344
MA 36,156,104
WL 6
s_nop 0
MA 40,160,104
RT 156,7,1584
RT 158,7,2352
MA 60,160,108
s_cmp_lg_u32 s32, 0
s_cbranch_scc1 L_polld_23
s_mov_b32 s89, 0x20000
s_waitcnt vmcnt(10)
s_branch L_pollc_24
L_poll_22:
buffer_load_dword v251, v250, s[20:23], s52 offen sc1
s_waitcnt vmcnt(0)
L_pollc_24:
v_cmp_eq_u32 s[98:99], s97, v251
s_sub_u32 s89, s89, 1
s_and_b32 s98, s98, 0xffff
s_cmp_eq_u32 s98, 0xffff
s_cbranch_scc1 L_polld_23
s_sleep 4
s_cmp_lg_u32 s89, 0
s_cbranch_scc1 L_poll_22
L_polld_23:
s_waitcnt vmcnt(5)
s_barrier
MA 64,164,108
RT 160,7,12800
RT 162,7,13568
MA 44,164,104
buffer_load_dwordx4 v6, s[12:15], s36 offen offset:2048  lds
MA 48,168,104
RT 164,7,12808
RT 166,7,13576
MA 68,168,108
buffer_load_dwordx4 v[160:163], v24, s[20:23], s35 offen sc1
s_add_u32 s35, s35, 2944
MA 92,172,108
RT 168,7,12816
RT 170,7,13584
MA 72,172,104
WL 6
s_nop 0
buffer_load_dwordx4 v[164:167], v24, s[20:23], s35 offen sc1
s_add_u32 s35, s35, 2944
MA 76,144,104
RT 172,7,12824
RT 174,7,13592
MA 96,144,108
buffer_load_dwordx4 v[168:171], v24, s[20:23], s35 offen sc1
s_add_u32 s35, s35, 2944
MA 100,148,108
RT 144,7,12832
RT 146,7,13600
MA 80,148,104
s_getpc_b64 s[6:7]
s_nop 0
s_load_dword s5, s[6:7], s101
MA 84,152,104
RT 148,7,14352
RT 150,7,15120
MA 104,152,108
buffer_load_dwordx4 v[172:175], v24, s[20:23], s35 offen sc1
s_add_u32 s35, s35, 2944
MA 108,156,108
RT 152,7,14360
RT 154,7,15128
MA 88,156,104
WL 6
s_nop 0
buffer_load_dwordx4 v[176:179], v24, s[20:23], s35 offen sc1
s_add_u32 s35, s35, 2944
MA 32,160,112
RT 156,7,14368
RT 158,7,15136
MA 52,160,116
buffer_load_dwordx4 v[180:183], v24, s[20:23], s35 offen sc1
s_add_u32 s35, s35, 2944
MA 56,164,116
RT 160,7,14376
RT 162,7,15144
MA 36,164,112
buffer_load_dwordx4 v[184:187], v24, s[20:23], s35 offen sc1
s_add_u32 s35, s35, 2944
MA 40,168,112
RT 164,7,14384
RT 166,7,15152
MA 60,168,116
buffer_load_dwordx4 v[188:191], v24, s[20:23], s35 offen sc1
s_add_u32 s35, s35, 2944
MA 64,172,116
RT 168,7,25600
RT 170,7,26368
MA 44,172,112
WL 6
s_nop 0
buffer_load_dwordx4 v[192:195], v24, s[20:23], s35 offen sc1
s_add_u32 s35, s35, 2944
MA 48,144,112
RT 172,7,25608
RT 174,7,26376
MA 68,144,116
buffer_load_dwordx4 v[196:199], v24, s[20:23], s35 offen sc1
s_add_u32 s35, s35, 2944
MA 92,148,116
RT 144,7,25616
RT 146,7,26384
MA 72,148,112
buffer_load_dwordx4 v[200:203], v24, s[20:23], s35 offen sc1
s_add_u32 s35, s35, 2944
MA 76,152,112
RT 148,7,25624
RT 150,7,26392
MA 96,152,116
buffer_load_dwordx4 v[204:207], v24, s[20:23], s35 offen sc1
s_add_u32 s35, s35, 2944
MA 100,156,116
RT 152,7,25632
RT 154,7,26400
MA 80,156,112
WL 6
s_nop 0
buffer_load_dwordx4 v[208:211], v24, s[20:23], s35 offen sc1
s_add_u32 s35, s35, 2944
MA 84,160,112
RT 156,7,27152
RT 158,7,27920
MA 104,160,116
buffer_load_dwordx4 v[212:215], v24, s[20:23], s35 offen sc1
s_add_u32 s35, s35, 2944
MA 108,164,116
RT 160,7,27160
RT 162,7,27928
MA 88,164,112
s_getpc_b64 s[6:7]
s_nop 0
s_load_dword s5, s[6:7], s101
MA 32,168,120
RT 164,7,27168
RT 166,7,27936
MA 52,168,124
buffer_load_dwordx4 v[216:219], v24, s[20:23], s35 offen sc1
s_add_u32 s35, s35, 2944
MA 56,172,124
RT 168,7,27176
RT 170,7,27944
MA 36,172,120
WL 6
buffer_load_dwordx4 v[220:223], v24, s[20:23], s35 offen sc1
s_lshl_b32 s96, s32, 6
MA 40,144,120
RT 172,7,27184
RT 174,7,27952
MA 60,144,124
s_waitcnt vmcnt(16)
s_barrier
MA 64,148,124
RT 144,7,38400
RT 146,7,39168
MA 44,148,120
v_add_u32 v28, s96, v0
v_lshlrev_b32 v224, 4, v28
v_lshlrev_b32_e64 v225, 3, v28
v_add_u32 v225, 111616, v225
MA 48,152,120
RT 148,7,38408
RT 150,7,39176
MA 68,152,124
v_mov_b32 v226, 0
v_mov_b32 v227, 0
ds_write_b64 v225, v[226:227]
v_cmp_gt_u32_e64 vcc, 32, v28
MA 92,156,124
RT 152,7,38416
RT 154,7,39184
MA 72,156,120
WL 7
v_mov_b32 v230, 0x40000000
s_mov_b32 s41, 98304
v_cndmask_b32_e64 v230, v230, v224, vcc
MA 76,160,120
RT 156,7,38424
RT 158,7,39192
MA 96,160,124
v_add_u32_e64 v29, 0, v28
v_mul_u32_u24 v31, 6554, v29
v_lshrrev_b32 v31, 16, v31
v_mul_u32_u24 v252, 10, v31
MA 100,164,124
RT 160,7,38432
RT 162,7,39200
MA 80,164,120
v_sub_u32_e64 v252, v29, v252
v_mul_u32_u24 v252, 160, v252
v_lshl_add_u32 v252, v31, 3, v252
v_mul_u32_u24 v31, 6554, v31
MA 84,168,120
RT 164,7,39952
RT 166,7,40720
MA 104,168,124
v_lshrrev_b32_e64 v31, 16, v31
v_mul_u32_u24 v31, 1520, v31
v_add3_u32 v252, v252, v31, s41
v_add_u32 v29, 256, v28
MA 108,172,124
RT 168,7,39960
RT 170,7,40728
MA 88,172,120
WL 6
v_mul_u32_u24 v31, 6554, v29
v_lshrrev_b32 v31, 16, v31
v_mul_u32_u24_e64 v253, 10, v31
MA 32,144,128
RT 172,7,39968
RT 174,7,40736
MA 52,144,132
v_sub_u32_e64 v253, v29, v253
v_mul_u32_u24 v253, 160, v253
v_lshl_add_u32 v253, v31, 3, v253
v_mul_u32_u24 v31, 6554, v31
MA 56,148,132
RT 144,7,39976
RT 146,7,40744
MA 36,148,128
v_lshrrev_b32_e64 v31, 16, v31
v_mul_u32_u24 v31, 1520, v31
v_add3_u32 v253, v253, v31, s41
v_add_u32 v29, 512, v28
MA 40,152,128
RT 148,7,39984
RT 150,7,40752
MA 60,152,132
v_mul_u32_u24 v31, 6554, v29
v_lshrrev_b32 v31, 16, v31
v_mul_u32_u24 v254, 10, v31
v_sub_u32_e64 v254, v29, v254
MA 64,156,132
RT 152,7,51200
RT 154,7,51968
MA 44,156,128
WL 6
s_nop 0
v_mul_u32_u24 v254, 160, v254
v_lshl_add_u32 v254, v31, 3, v254
v_mul_u32_u24 v31, 6554, v31
MA 48,160,128
RT 156,7,51208
RT 158,7,51976
MA 68,160,132
v_lshrrev_b32_e64 v31, 16, v31
v_mul_u32_u24 v31, 1520, v31
v_add3_u32 v254, v254, v31, s41
v_add_u32 v29, 768, v28
MA 92,164,132
RT 160,7,51216
RT 162,7,51984
MA 72,164,128
v_mul_u32_u24 v31, 6554, v29
v_lshrrev_b32 v31, 16, v31
v_mul_u32_u24 v255, 10, v31
v_sub_u32_e64 v255, v29, v255
MA 76,168,128
RT 164,7,51224
RT 166,7,51992
MA 96,168,132
v_mul_u32_u24 v255, 160, v255
v_lshl_add_u32 v255, v31, 3, v255
v_mul_u32_u24 v31, 6554, v31
v_lshrrev_b32_e64 v31, 16, v31
MA 100,172,132
RT 168,7,51232
RT 170,7,52000
MA 80,172,128
WL 6
s_nop 0
v_mul_u32_u24 v31, 1520, v31
v_add3_u32 v255, v255, v31, s41
v_add_u32 v29, 8192, v255
MA 84,144,128
RT 172,7,52752
RT 174,7,53520
MA 104,144,132
v_cndmask_b32_e64 v255, v29, v255, vcc
s_mul_i32 s41, s34, 12800
s_add_u32 s41, s41, 0x2700000
v_lshrrev_b32_e64 v28, 2, v23
MA 108,148,132
RT 144,7,52760
RT 146,7,53528
MA 88,148,128
v_cmp_eq_u32 s[54:55], v28, v22
v_mul_u32_u24 v228, 1600, v22
v_and_b32_e64 v28, 3, v23
v_mul_u32_u24 v28, 80, v28
MA 32,152,136
RT 148,7,52768
RT 150,7,53536
MA 52,152,140
v_add_u32_e64 v228, v228, v28
v_add_u32 v228, 98304, v228
v_add_u32 v229, 6400, v228
v_mov_b32 v28, 111616
MA 56,156,140
RT 152,7,52776
RT 154,7,53544
MA 36,156,136
WL 6
s_nop 0
v_cndmask_b32 v228, v28, v228, s[54:55]
v_cndmask_b32 v229, v28, v229, s[54:55]
MA 40,160,136
RT 156,7,52784
RT 158,7,53552
MA 60,160,140
s_waitcnt vmcnt(0)
v_add_f32 v160, v160, v164
v_add_f32_e64 v161, v161, v165
MA 64,164,140
MA 44,164,136
v_add_f32 v162, v162, v166
v_add_f32 v163, v163, v167
v_add_f32 v160, v160, v168
v_add_f32 v161, v161, v169
MA 48,168,136
MA 68,168,140
v_add_f32 v162, v162, v170
v_add_f32 v163, v163, v171
v_add_f32 v160, v160, v172
v_add_f32 v161, v161, v173
MA 92,172,140
MA 72,172,136
WL 0
v_add_f32 v162, v162, v174
v_add_f32 v163, v163, v175
v_add_f32 v160, v160, v176
MA 76,144,136
MA 96,144,140
v_add_f32 v161, v161, v177
v_add_f32 v162, v162, v178
v_add_f32 v163, v163, v179
v_add_f32 v160, v160, v180
MA 100,148,140
MA 80,148,136
v_add_f32 v161, v161, v181
v_add_f32 v162, v162, v182
v_add_f32 v163, v163, v183
v_add_f32 v160, v160, v184
MA 84,152,136
MA 104,152,140
v_add_f32 v161, v161, v185
v_add_f32 v162, v162, v186
v_add_f32 v163, v163, v187
v_add_f32 v160, v160, v188
MA 108,156,140
MA 88,156,136
v_add_f32 v161, v161, v189
v_add_f32 v162, v162, v190
v_add_f32 v163, v163, v191
v_add_f32 v160, v160, v192
v_add_f32 v161, v161, v193
v_add_f32 v162, v162, v194
v_add_f32 v163, v163, v195
v_add_f32 v160, v160, v196
v_add_f32 v161, v161, v197
v_add_f32 v162, v162, v198
v_add_f32 v163, v163, v199
v_add_f32 v160, v160, v200
v_add_f32 v161, v161, v201
v_add_f32 v162, v162, v202
v_add_f32 v163, v163, v203
v_add_f32 v160, v160, v204
v_add_f32 v161, v161, v205
v_add_f32 v162, v162, v206
v_add_f32 v163, v163, v207
v_add_f32 v160, v160, v208
v_add_f32 v161, v161, v209
v_add_f32 v162, v162, v210
v_add_f32 v163, v163, v211
v_add_f32 v160, v160, v212
v_add_f32 v161, v161, v213
v_add_f32 v162, v162, v214
v_add_f32 v163, v163, v215
v_add_f32 v160, v160, v216
v_add_f32 v161, v161, v217
v_add_f32 v162, v162, v218
v_add_f32 v163, v163, v219
v_add_f32 v160, v160, v220
v_add_f32 v161, v161, v221
v_add_f32 v162, v162, v222
v_add_f32_e64 v163, v163, v223
CV 160,160,161
CV 161,162,163
buffer_store_dwordx2 v[160:161], v12, s[20:23], s95 offen sc1
v_mad_u32_u24 v29, v19, 12, v18
RT 0,29,0
RT 2,29,160
RT 4,29,8
RT 6,29,168
RT 8,29,16
RT 10,29,176
RT 12,29,24
RT 14,29,184
RT 16,29,32
RT 18,29,192
v_add_u32_e64 v29, v29, v19
RT 20,29,0
RT 22,29,160
RT 24,29,8
RT 26,29,168
RT 28,29,16
RT 30,29,176
RT 32,29,24
RT 34,29,184
RT 36,29,32
RT 38,29,192
v_add_u32_e64 v29, v29, v19
RT 40,29,0
RT 42,29,160
RT 44,29,8
RT 46,29,168
RT 48,29,16
RT 50,29,176
RT 52,29,24
RT 54,29,184
RT 56,29,32
RT 58,29,192
v_mov_b32 v122, 0
v_mov_b32 v123, 0
CV 112,32,33
CV 113,34,35
CV 114,36,37
CV 115,38,39
CV 116,40,41
CV 117,42,43
CV 118,44,45
CV 119,46,47
CV 120,48,49
CV 121,50,51
v_mov_b32 v134, 0
v_mov_b32 v135, 0
CV 124,52,53
CV 125,54,55
CV 126,56,57
CV 127,58,59
CV 128,60,61
CV 129,62,63
CV 130,64,65
CV 131,66,67
CV 132,68,69
CV 133,70,71
WL 15
v_mfma_f32_16x16x32_bf16 v[32:35], a[176:179], v[112:115], 0
v_mov_b32 v146, 0
v_mov_b32_e64 v147, 0
v_mfma_f32_16x16x32_bf16 v[52:55], a[176:179], v[124:127], 0
CV 136,72,73
CV 137,74,75
v_mfma_f32_16x16x32_bf16 v[36:39], a[180:183], v[112:115], 0
CV 138,76,77
CV 139,78,79
v_mfma_f32_16x16x32_bf16 v[56:59], a[180:183], v[124:127], 0
CV 140,80,81
CV 141,82,83
v_mfma_f32_16x16x32_bf16 v[40:43], a[184:187], v[112:115], 0
CV 142,84,85
CV 143,86,87
v_mfma_f32_16x16x32_bf16 v[60:63], a[184:187], v[124:127], 0
CV 144,88,89
CV 145,90,91
v_mfma_f32_16x16x32_bf16 v[44:47], a[188:191], v[112:115], 0
v_mov_b32 v158, 0
v_mov_b32 v159, 0
v_mfma_f32_16x16x32_bf16 v[64:67], a[188:191], v[124:127], 0
CV 148,92,93
CV 149,94,95
v_mfma_f32_16x16x32_bf16 v[48:51], a[192:195], v[112:115], 0
CV 150,96,97
CV 151,98,99
v_mfma_f32_16x16x32_bf16 v[68:71], a[192:195], v[124:127], 0
CV 152,100,101
CV 153,102,103
MV 32,196,116
CV 154,104,105
CV 155,106,107
MV 52,196,128
CV 156,108,109
CV 157,110,111
MV 36,200,116
WL 0
s_nop 0
MV 56,200,128
MV 40,204,116
MV 60,204,128
MV 44,208,116
MV 64,208,128
MV 48,212,116
MV 68,212,128
MV 32,216,120
MV 52,216,132
MV 36,220,120
MV 56,220,132
MV 40,224,120
MV 60,224,132
MV 44,228,120
MV 64,228,132
MV 48,232,120
MV 68,232,132
s_nop 6
s_nop 0
v_max3_f32 v24, v32, v33, v34
v_min3_f32 v25, v32, v33, v34
v_max3_f32 v24, v24, v35, v36
v_min3_f32 v25, v25, v35, v36
v_max3_f32 v24, v24, v37, v38
v_min3_f32 v25, v25, v37, v38
v_max3_f32 v24, v24, v39, v40
v_min3_f32 v25, v25, v39, v40
v_max3_f32 v24, v24, v41, v42
v_min3_f32 v25, v25, v41, v42
v_max3_f32 v24, v24, v43, v44
v_min3_f32 v25, v25, v43, v44
v_max3_f32 v24, v24, v45, v46
v_min3_f32 v25, v25, v45, v46
v_max3_f32 v24, v24, v47, v48
v_min3_f32 v25, v25, v47, v48
v_max_f32 v24, v24, v49
v_min_f32 v25, v25, v49
v_pk_mul_f32 v[24:25], v[24:25], v[14:15] op_sel:[0,0] op_sel_hi:[1,0]
v_pk_fma_f32 v[164:165], v[32:33], v[14:15], v[24:25] op_sel:[0,0,0] op_sel_hi:[1,0,0] neg_lo:[0,0,1] neg_hi:[0,0,1]
v_pk_fma_f32 v[32:33], v[32:33], v[14:15], v[24:25] op_sel:[0,0,1] op_sel_hi:[1,0,1] neg_lo:[0,1,0] neg_hi:[0,1,0]
v_pk_fma_f32 v[166:167], v[34:35], v[14:15], v[24:25] op_sel:[0,0,0] op_sel_hi:[1,0,0] neg_lo:[0,0,1] neg_hi:[0,0,1]
v_pk_fma_f32 v[34:35], v[34:35], v[14:15], v[24:25] op_sel:[0,0,1] op_sel_hi:[1,0,1] neg_lo:[0,1,0] neg_hi:[0,1,0]
v_pk_fma_f32 v[168:169], v[36:37], v[14:15], v[24:25] op_sel:[0,0,0] op_sel_hi:[1,0,0] neg_lo:[0,0,1] neg_hi:[0,0,1]
v_pk_fma_f32 v[36:37], v[36:37], v[14:15], v[24:25] op_sel:[0,0,1] op_sel_hi:[1,0,1] neg_lo:[0,1,0] neg_hi:[0,1,0]
v_pk_fma_f32 v[170:171], v[38:39], v[14:15], v[24:25] op_sel:[0,0,0] op_sel_hi:[1,0,0] neg_lo:[0,0,1] neg_hi:[0,0,1]
v_pk_fma_f32 v[38:39], v[38:39], v[14:15], v[24:25] op_sel:[0,0,1] op_sel_hi:[1,0,1] neg_lo:[0,1,0] neg_hi:[0,1,0]
v_pk_fma_f32 v[172:173], v[40:41], v[14:15], v[24:25] op_sel:[0,0,0] op_sel_hi:[1,0,0] neg_lo:[0,0,1] neg_hi:[0,0,1]
v_pk_fma_f32 v[40:41], v[40:41], v[14:15], v[24:25] op_sel:[0,0,1] op_sel_hi:[1,0,1] neg_lo:[0,1,0] neg_hi:[0,1,0]
v_pk_fma_f32 v[174:175], v[42:43], v[14:15], v[24:25] op_sel:[0,0,0] op_sel_hi:[1,0,0] neg_lo:[0,0,1] neg_hi:[0,0,1]
v_pk_fma_f32 v[42:43], v[42:43], v[14:15], v[24:25] op_sel:[0,0,1] op_sel_hi:[1,0,1] neg_lo:[0,1,0] neg_hi:[0,1,0]
v_pk_fma_f32 v[176:177], v[44:45], v[14:15], v[24:25] op_sel:[0,0,0] op_sel_hi:[1,0,0] neg_lo:[0,0,1] neg_hi:[0,0,1]
v_pk_fma_f32 v[44:45], v[44:45], v[14:15], v[24:25] op_sel:[0,0,1] op_sel_hi:[1,0,1] neg_lo:[0,1,0] neg_hi:[0,1,0]
v_pk_fma_f32 v[178:179], v[46:47], v[14:15], v[24:25] op_sel:[0,0,0] op_sel_hi:[1,0,0] neg_lo:[0,0,1] neg_hi:[0,0,1]
v_pk_fma_f32 v[46:47], v[46:47], v[14:15], v[24:25] op_sel:[0,0,1] op_sel_hi:[1,0,1] neg_lo:[0,1,0] neg_hi:[0,1,0]
v_pk_fma_f32 v[180:181], v[48:49], v[14:15], v[24:25] op_sel:[0,0,0] op_sel_hi:[1,0,0] neg_lo:[0,0,1] neg_hi:[0,0,1]
v_pk_fma_f32 v[48:49], v[48:49], v[14:15], v[24:25] op_sel:[0,0,1] op_sel_hi:[1,0,1] neg_lo:[0,1,0] neg_hi:[0,1,0]
s_nop 0
v_exp_f32 v164, v164
v_mfma_f32_16x16x32_bf16 v[72:75], a[0:3], v[136:139], 0
v_exp_f32_e64 v32, v32
v_mfma_f32_16x16x32_bf16 v[92:95], a[0:3], v[148:151], 0
v_exp_f32_e64 v165, v165
v_mfma_f32_16x16x32_bf16 v[76:79], a[4:7], v[136:139], 0
v_exp_f32_e64 v33, v33
v_mfma_f32_16x16x32_bf16 v[96:99], a[4:7], v[148:151], 0
v_exp_f32_e64 v166, v166
v_mfma_f32_16x16x32_bf16 v[80:83], a[8:11], v[136:139], 0
v_exp_f32_e64 v34, v34
v_mfma_f32_16x16x32_bf16 v[100:103], a[8:11], v[148:151], 0
v_exp_f32_e64 v167, v167
v_mfma_f32_16x16x32_bf16 v[84:87], a[12:15], v[136:139], 0
v_exp_f32_e64 v35, v35
v_mfma_f32_16x16x32_bf16 v[104:107], a[12:15], v[148:151], 0
v_exp_f32_e64 v168, v168
v_mfma_f32_16x16x32_bf16 v[88:91], a[16:19], v[136:139], 0
v_exp_f32_e64 v36, v36
v_mfma_f32_16x16x32_bf16 v[108:111], a[16:19], v[148:151], 0
v_exp_f32_e64 v169, v169
MV 72,20,140
v_exp_f32_e64 v37, v37
MV 92,20,152
v_exp_f32_e64 v170, v170
MV 76,24,140
v_exp_f32_e64 v38, v38
MV 96,24,152
v_exp_f32_e64 v171, v171
MV 80,28,140
v_exp_f32_e64 v39, v39
MV 100,28,152
v_exp_f32_e64 v172, v172
MV 84,32,140
v_exp_f32_e64 v40, v40
MV 104,32,152
v_exp_f32_e64 v173, v173
MV 88,36,140
v_exp_f32_e64 v41, v41
MV 108,36,152
v_exp_f32_e64 v174, v174
MV 72,40,144
v_exp_f32_e64 v42, v42
MV 92,40,156
v_exp_f32_e64 v175, v175
MV 76,44,144
v_exp_f32_e64 v43, v43
MV 96,44,156
v_exp_f32_e64 v176, v176
MV 80,48,144
v_exp_f32_e64 v44, v44
MV 100,48,156
v_exp_f32_e64 v177, v177
MV 84,52,144
v_exp_f32_e64 v45, v45
MV 104,52,156
v_exp_f32_e64 v178, v178
MV 88,56,144
v_exp_f32_e64 v46, v46
MV 108,56,156
v_exp_f32 v179, v179
v_exp_f32 v47, v47
v_exp_f32 v180, v180
v_exp_f32 v48, v48
v_exp_f32 v181, v181
v_exp_f32 v49, v49
v_pk_add_f32 v[24:25], v[164:165], v[166:167]
v_pk_add_f32 v[26:27], v[32:33], v[34:35]
v_pk_add_f32 v[24:25], v[24:25], v[168:169]
v_pk_add_f32 v[26:27], v[26:27], v[36:37]
v_pk_add_f32 v[24:25], v[24:25], v[170:171]
v_pk_add_f32 v[26:27], v[26:27], v[38:39]
v_pk_add_f32 v[24:25], v[24:25], v[172:173]
v_pk_add_f32 v[26:27], v[26:27], v[40:41]
v_pk_add_f32 v[24:25], v[24:25], v[174:175]
v_pk_add_f32 v[26:27], v[26:27], v[42:43]
v_pk_add_f32 v[24:25], v[24:25], v[176:177]
v_pk_add_f32 v[26:27], v[26:27], v[44:45]
v_pk_add_f32 v[24:25], v[24:25], v[178:179]
v_pk_add_f32 v[26:27], v[26:27], v[46:47]
v_pk_add_f32 v[24:25], v[24:25], v[180:181]
v_pk_add_f32 v[26:27], v[26:27], v[48:49]
s_nop 0
v_add_f32 v24, v24, v25
v_add_f32 v25, v26, v27
v_rcp_f32 v24, v24
v_rcp_f32 v25, v25
s_nop 0
v_pk_mul_f32 v[164:165], v[164:165], v[24:25] op_sel:[0,0] op_sel_hi:[1,0]
v_pk_mul_f32 v[32:33], v[32:33], v[24:25] op_sel:[0,1] op_sel_hi:[1,1]
v_pk_mul_f32 v[166:167], v[166:167], v[24:25] op_sel:[0,0] op_sel_hi:[1,0]
v_pk_mul_f32 v[34:35], v[34:35], v[24:25] op_sel:[0,1] op_sel_hi:[1,1]
v_pk_mul_f32 v[168:169], v[168:169], v[24:25] op_sel:[0,0] op_sel_hi:[1,0]
v_pk_mul_f32 v[36:37], v[36:37], v[24:25] op_sel:[0,1] op_sel_hi:[1,1]
v_pk_mul_f32 v[170:171], v[170:171], v[24:25] op_sel:[0,0] op_sel_hi:[1,0]
v_pk_mul_f32 v[38:39], v[38:39], v[24:25] op_sel:[0,1] op_sel_hi:[1,1]
v_pk_mul_f32 v[172:173], v[172:173], v[24:25] op_sel:[0,0] op_sel_hi:[1,0]
v_pk_mul_f32 v[40:41], v[40:41], v[24:25] op_sel:[0,1] op_sel_hi:[1,1]
v_pk_mul_f32 v[174:175], v[174:175], v[24:25] op_sel:[0,0] op_sel_hi:[1,0]
v_pk_mul_f32 v[42:43], v[42:43], v[24:25] op_sel:[0,1] op_sel_hi:[1,1]
v_pk_mul_f32 v[176:177], v[176:177], v[24:25] op_sel:[0,0] op_sel_hi:[1,0]
v_pk_mul_f32 v[44:45], v[44:45], v[24:25] op_sel:[0,1] op_sel_hi:[1,1]
v_pk_mul_f32 v[178:179], v[178:179], v[24:25] op_sel:[0,0] op_sel_hi:[1,0]
v_pk_mul_f32 v[46:47], v[46:47], v[24:25] op_sel:[0,1] op_sel_hi:[1,1]
v_pk_mul_f32 v[180:181], v[180:181], v[24:25] op_sel:[0,0] op_sel_hi:[1,0]
v_pk_mul_f32 v[48:49], v[48:49], v[24:25] op_sel:[0,1] op_sel_hi:[1,1]
s_nop 0
s_nop 0
CV 49,48,49
CV 48,46,47
CV 47,44,45
CV 46,42,43
CV 45,40,41
CV 44,38,39
CV 43,36,37
CV 42,34,35
CV 41,32,33
CV 32,164,165
CV 33,166,167
CV 34,168,169
CV 35,170,171
CV 36,172,173
CV 37,174,175
CV 38,176,177
CV 39,178,179
CV 40,180,181
s_waitcnt vmcnt(0)
s_barrier
v_mov_b32_e64 v28, s97
buffer_store_dword v28, v20, s[20:23], s63 offen offset:512 sc1
v_max3_f32 v24, v52, v53, v54
v_min3_f32 v25, v52, v53, v54
v_max3_f32 v24, v24, v55, v56
v_min3_f32 v25, v25, v55, v56
v_max3_f32 v24, v24, v57, v58
v_min3_f32 v25, v25, v57, v58
v_max3_f32 v24, v24, v59, v60
v_min3_f32 v25, v25, v59, v60
v_max3_f32 v24, v24, v61, v62
v_min3_f32 v25, v25, v61, v62
v_max3_f32 v24, v24, v63, v64
v_min3_f32 v25, v25, v63, v64
v_max3_f32 v24, v24, v65, v66
v_min3_f32 v25, v25, v65, v66
v_max3_f32 v24, v24, v67, v68
v_min3_f32 v25, v25, v67, v68
v_max_f32 v24, v24, v69
v_min_f32 v25, v25, v69
v_pk_mul_f32 v[24:25], v[24:25], v[14:15] op_sel:[0,1] op_sel_hi:[1,1]
v_pk_fma_f32 v[164:165], v[52:53], v[14:15], v[24:25] op_sel:[0,1,0] op_sel_hi:[1,1,0] neg_lo:[0,0,1] neg_hi:[0,0,1]
v_pk_fma_f32 v[52:53], v[52:53], v[14:15], v[24:25] op_sel:[0,1,1] op_sel_hi:[1,1,1] neg_lo:[0,1,0] neg_hi:[0,1,0]
v_pk_fma_f32 v[166:167], v[54:55], v[14:15], v[24:25] op_sel:[0,1,0] op_sel_hi:[1,1,0] neg_lo:[0,0,1] neg_hi:[0,0,1]
v_pk_fma_f32 v[54:55], v[54:55], v[14:15], v[24:25] op_sel:[0,1,1] op_sel_hi:[1,1,1] neg_lo:[0,1,0] neg_hi:[0,1,0]
v_pk_fma_f32 v[168:169], v[56:57], v[14:15], v[24:25] op_sel:[0,1,0] op_sel_hi:[1,1,0] neg_lo:[0,0,1] neg_hi:[0,0,1]
v_pk_fma_f32 v[56:57], v[56:57], v[14:15], v[24:25] op_sel:[0,1,1] op_sel_hi:[1,1,1] neg_lo:[0,1,0] neg_hi:[0,1,0]
v_pk_fma_f32 v[170:171], v[58:59], v[14:15], v[24:25] op_sel:[0,1,0] op_sel_hi:[1,1,0] neg_lo:[0,0,1] neg_hi:[0,0,1]
v_pk_fma_f32 v[58:59], v[58:59], v[14:15], v[24:25] op_sel:[0,1,1] op_sel_hi:[1,1,1] neg_lo:[0,1,0] neg_hi:[0,1,0]
v_pk_fma_f32 v[172:173], v[60:61], v[14:15], v[24:25] op_sel:[0,1,0] op_sel_hi:[1,1,0] neg_lo:[0,0,1] neg_hi:[0,0,1]
v_pk_fma_f32 v[60:61], v[60:61], v[14:15], v[24:25] op_sel:[0,1,1] op_sel_hi:[1,1,1] neg_lo:[0,1,0] neg_hi:[0,1,0]
v_pk_fma_f32 v[174:175], v[62:63], v[14:15], v[24:25] op_sel:[0,1,0] op_sel_hi:[1,1,0] neg_lo:[0,0,1] neg_hi:[0,0,1]
v_pk_fma_f32 v[62:63], v[62:63], v[14:15], v[24:25] op_sel:[0,1,1] op_sel_hi:[1,1,1] neg_lo:[0,1,0] neg_hi:[0,1,0]
v_pk_fma_f32 v[176:177], v[64:65], v[14:15], v[24:25] op_sel:[0,1,0] op_sel_hi:[1,1,0] neg_lo:[0,0,1] neg_hi:[0,0,1]
v_pk_fma_f32 v[64:65], v[64:65], v[14:15], v[24:25] op_sel:[0,1,1] op_sel_hi:[1,1,1] neg_lo:[0,1,0] neg_hi:[0,1,0]
v_pk_fma_f32 v[178:179], v[66:67], v[14:15], v[24:25] op_sel:[0,1,0] op_sel_hi:[1,1,0] neg_lo:[0,0,1] neg_hi:[0,0,1]
v_pk_fma_f32 v[66:67], v[66:67], v[14:15], v[24:25] op_sel:[0,1,1] op_sel_hi:[1,1,1] neg_lo:[0,1,0] neg_hi:[0,1,0]
v_pk_fma_f32 v[180:181], v[68:69], v[14:15], v[24:25] op_sel:[0,1,0] op_sel_hi:[1,1,0] neg_lo:[0,0,1] neg_hi:[0,0,1]
v_pk_fma_f32 v[68:69], v[68:69], v[14:15], v[24:25] op_sel:[0,1,1] op_sel_hi:[1,1,1] neg_lo:[0,1,0] neg_hi:[0,1,0]
s_nop 0
v_exp_f32 v164, v164
v_exp_f32 v52, v52
v_exp_f32 v165, v165
v_exp_f32 v53, v53
v_exp_f32 v166, v166
v_exp_f32 v54, v54
v_exp_f32 v167, v167
v_exp_f32 v55, v55
v_exp_f32 v168, v168
v_exp_f32 v56, v56
v_exp_f32 v169, v169
v_exp_f32 v57, v57
v_exp_f32 v170, v170
v_exp_f32 v58, v58
v_exp_f32 v171, v171
v_exp_f32 v59, v59
v_exp_f32 v172, v172
v_exp_f32 v60, v60
v_exp_f32 v173, v173
v_exp_f32 v61, v61
v_exp_f32 v174, v174
v_exp_f32 v62, v62
v_exp_f32 v175, v175
v_exp_f32 v63, v63
v_exp_f32 v176, v176
v_exp_f32 v64, v64
v_exp_f32 v177, v177
v_exp_f32 v65, v65
v_exp_f32 v178, v178
v_exp_f32 v66, v66
v_exp_f32 v179, v179
v_exp_f32 v67, v67
v_exp_f32 v180, v180
v_exp_f32 v68, v68
v_exp_f32 v181, v181
v_exp_f32_e64 v69, v69
v_pk_add_f32 v[24:25], v[164:165], v[166:167]
v_pk_add_f32 v[26:27], v[52:53], v[54:55]
v_pk_add_f32 v[24:25], v[24:25], v[168:169]
v_pk_add_f32 v[26:27], v[26:27], v[56:57]
v_pk_add_f32 v[24:25], v[24:25], v[170:171]
v_pk_add_f32 v[26:27], v[26:27], v[58:59]
v_pk_add_f32 v[24:25], v[24:25], v[172:173]
v_pk_add_f32 v[26:27], v[26:27], v[60:61]
v_pk_add_f32 v[24:25], v[24:25], v[174:175]
v_pk_add_f32 v[26:27], v[26:27], v[62:63]
v_pk_add_f32 v[24:25], v[24:25], v[176:177]
v_pk_add_f32 v[26:27], v[26:27], v[64:65]
v_pk_add_f32 v[24:25], v[24:25], v[178:179]
v_pk_add_f32 v[26:27], v[26:27], v[66:67]
v_pk_add_f32 v[24:25], v[24:25], v[180:181]
v_pk_add_f32 v[26:27], v[26:27], v[68:69]
s_nop 0
v_add_f32 v24, v24, v25
v_add_f32 v25, v26, v27
v_rcp_f32 v24, v24
v_rcp_f32 v25, v25
s_nop 0
v_pk_mul_f32 v[164:165], v[164:165], v[24:25] op_sel:[0,0] op_sel_hi:[1,0]
v_pk_mul_f32 v[52:53], v[52:53], v[24:25] op_sel:[0,1] op_sel_hi:[1,1]
v_pk_mul_f32 v[166:167], v[166:167], v[24:25] op_sel:[0,0] op_sel_hi:[1,0]
v_pk_mul_f32 v[54:55], v[54:55], v[24:25] op_sel:[0,1] op_sel_hi:[1,1]
v_pk_mul_f32 v[168:169], v[168:169], v[24:25] op_sel:[0,0] op_sel_hi:[1,0]
v_pk_mul_f32 v[56:57], v[56:57], v[24:25] op_sel:[0,1] op_sel_hi:[1,1]
v_pk_mul_f32 v[170:171], v[170:171], v[24:25] op_sel:[0,0] op_sel_hi:[1,0]
v_pk_mul_f32 v[58:59], v[58:59], v[24:25] op_sel:[0,1] op_sel_hi:[1,1]
v_pk_mul_f32 v[172:173], v[172:173], v[24:25] op_sel:[0,0] op_sel_hi:[1,0]
v_pk_mul_f32 v[60:61], v[60:61], v[24:25] op_sel:[0,1] op_sel_hi:[1,1]
v_pk_mul_f32 v[174:175], v[174:175], v[24:25] op_sel:[0,0] op_sel_hi:[1,0]
v_pk_mul_f32 v[62:63], v[62:63], v[24:25] op_sel:[0,1] op_sel_hi:[1,1]
v_pk_mul_f32 v[176:177], v[176:177], v[24:25] op_sel:[0,0] op_sel_hi:[1,0]
v_pk_mul_f32 v[64:65], v[64:65], v[24:25] op_sel:[0,1] op_sel_hi:[1,1]
v_pk_mul_f32 v[178:179], v[178:179], v[24:25] op_sel:[0,0] op_sel_hi:[1,0]
v_pk_mul_f32 v[66:67], v[66:67], v[24:25] op_sel:[0,1] op_sel_hi:[1,1]
v_pk_mul_f32 v[180:181], v[180:181], v[24:25] op_sel:[0,0] op_sel_hi:[1,0]
v_pk_mul_f32 v[68:69], v[68:69], v[24:25] op_sel:[0,1] op_sel_hi:[1,1]
s_nop 0
s_nop 0
CV 69,68,69
CV 68,66,67
CV 67,64,65
CV 66,62,63
CV 65,60,61
CV 64,58,59
CV 63,56,57
CV 62,54,55
CV 61,52,53
CV 52,164,165
CV 53,166,167
CV 54,168,169
CV 55,170,171
CV 56,172,173
CV 57,174,175
CV 58,176,177
CV 59,178,179
CV 60,180,181
buffer_load_dword v251, v250, s[20:23], s46 offen sc1
v_max3_f32 v24, v72, v73, v74
v_min3_f32 v25, v72, v73, v74
v_max3_f32 v24, v24, v75, v76
v_min3_f32 v25, v25, v75, v76
v_max3_f32 v24, v24, v77, v78
v_min3_f32 v25, v25, v77, v78
v_max3_f32 v24, v24, v79, v80
v_min3_f32 v25, v25, v79, v80
v_max3_f32 v24, v24, v81, v82
v_min3_f32 v25, v25, v81, v82
v_max3_f32 v24, v24, v83, v84
v_min3_f32 v25, v25, v83, v84
v_max3_f32 v24, v24, v85, v86
v_min3_f32 v25, v25, v85, v86
v_max3_f32 v24, v24, v87, v88
v_min3_f32 v25, v25, v87, v88
v_max_f32 v24, v24, v89
v_min_f32 v25, v25, v89
v_pk_mul_f32 v[24:25], v[24:25], v[14:15] op_sel:[0,0] op_sel_hi:[1,0]
v_pk_fma_f32 v[164:165], v[72:73], v[14:15], v[24:25] op_sel:[0,0,0] op_sel_hi:[1,0,0] neg_lo:[0,0,1] neg_hi:[0,0,1]
v_pk_fma_f32 v[72:73], v[72:73], v[14:15], v[24:25] op_sel:[0,0,1] op_sel_hi:[1,0,1] neg_lo:[0,1,0] neg_hi:[0,1,0]
v_pk_fma_f32 v[166:167], v[74:75], v[14:15], v[24:25] op_sel:[0,0,0] op_sel_hi:[1,0,0] neg_lo:[0,0,1] neg_hi:[0,0,1]
v_pk_fma_f32 v[74:75], v[74:75], v[14:15], v[24:25] op_sel:[0,0,1] op_sel_hi:[1,0,1] neg_lo:[0,1,0] neg_hi:[0,1,0]
v_pk_fma_f32 v[168:169], v[76:77], v[14:15], v[24:25] op_sel:[0,0,0] op_sel_hi:[1,0,0] neg_lo:[0,0,1] neg_hi:[0,0,1]
v_pk_fma_f32 v[76:77], v[76:77], v[14:15], v[24:25] op_sel:[0,0,1] op_sel_hi:[1,0,1] neg_lo:[0,1,0] neg_hi:[0,1,0]
v_pk_fma_f32 v[170:171], v[78:79], v[14:15], v[24:25] op_sel:[0,0,0] op_sel_hi:[1,0,0] neg_lo:[0,0,1] neg_hi:[0,0,1]
v_pk_fma_f32 v[78:79], v[78:79], v[14:15], v[24:25] op_sel:[0,0,1] op_sel_hi:[1,0,1] neg_lo:[0,1,0] neg_hi:[0,1,0]
v_pk_fma_f32 v[172:173], v[80:81], v[14:15], v[24:25] op_sel:[0,0,0] op_sel_hi:[1,0,0] neg_lo:[0,0,1] neg_hi:[0,0,1]
v_pk_fma_f32 v[80:81], v[80:81], v[14:15], v[24:25] op_sel:[0,0,1] op_sel_hi:[1,0,1] neg_lo:[0,1,0] neg_hi:[0,1,0]
v_pk_fma_f32 v[174:175], v[82:83], v[14:15], v[24:25] op_sel:[0,0,0] op_sel_hi:[1,0,0] neg_lo:[0,0,1] neg_hi:[0,0,1]
v_pk_fma_f32 v[82:83], v[82:83], v[14:15], v[24:25] op_sel:[0,0,1] op_sel_hi:[1,0,1] neg_lo:[0,1,0] neg_hi:[0,1,0]
v_pk_fma_f32 v[176:177], v[84:85], v[14:15], v[24:25] op_sel:[0,0,0] op_sel_hi:[1,0,0] neg_lo:[0,0,1] neg_hi:[0,0,1]
v_pk_fma_f32 v[84:85], v[84:85], v[14:15], v[24:25] op_sel:[0,0,1] op_sel_hi:[1,0,1] neg_lo:[0,1,0] neg_hi:[0,1,0]
v_pk_fma_f32 v[178:179], v[86:87], v[14:15], v[24:25] op_sel:[0,0,0] op_sel_hi:[1,0,0] neg_lo:[0,0,1] neg_hi:[0,0,1]
v_pk_fma_f32 v[86:87], v[86:87], v[14:15], v[24:25] op_sel:[0,0,1] op_sel_hi:[1,0,1] neg_lo:[0,1,0] neg_hi:[0,1,0]
v_pk_fma_f32 v[180:181], v[88:89], v[14:15], v[24:25] op_sel:[0,0,0] op_sel_hi:[1,0,0] neg_lo:[0,0,1] neg_hi:[0,0,1]
v_pk_fma_f32 v[88:89], v[88:89], v[14:15], v[24:25] op_sel:[0,0,1] op_sel_hi:[1,0,1] neg_lo:[0,1,0] neg_hi:[0,1,0]
s_nop 0
v_exp_f32 v164, v164
v_exp_f32 v72, v72
v_exp_f32 v165, v165
v_exp_f32 v73, v73
v_exp_f32 v166, v166
v_exp_f32 v74, v74
v_exp_f32 v167, v167
v_exp_f32 v75, v75
v_exp_f32 v168, v168
v_exp_f32 v76, v76
v_exp_f32 v169, v169
v_exp_f32 v77, v77
v_exp_f32 v170, v170
v_exp_f32 v78, v78
v_exp_f32 v171, v171
v_exp_f32 v79, v79
v_exp_f32 v172, v172
v_exp_f32 v80, v80
v_exp_f32 v173, v173
v_exp_f32 v81, v81
v_exp_f32 v174, v174
v_exp_f32 v82, v82
v_exp_f32 v175, v175
v_exp_f32 v83, v83
v_exp_f32 v176, v176
v_exp_f32 v84, v84
v_exp_f32 v177, v177
v_exp_f32 v85, v85
v_exp_f32 v178, v178
v_exp_f32 v86, v86
v_exp_f32 v179, v179
v_exp_f32 v87, v87
v_exp_f32 v180, v180
v_exp_f32 v88, v88
v_exp_f32 v181, v181
v_exp_f32_e64 v89, v89
v_pk_add_f32 v[24:25], v[164:165], v[166:167]
v_pk_add_f32 v[26:27], v[72:73], v[74:75]
v_pk_add_f32 v[24:25], v[24:25], v[168:169]
v_pk_add_f32 v[26:27], v[26:27], v[76:77]
v_pk_add_f32 v[24:25], v[24:25], v[170:171]
v_pk_add_f32 v[26:27], v[26:27], v[78:79]
v_pk_add_f32 v[24:25], v[24:25], v[172:173]
v_pk_add_f32 v[26:27], v[26:27], v[80:81]
v_pk_add_f32 v[24:25], v[24:25], v[174:175]
v_pk_add_f32 v[26:27], v[26:27], v[82:83]
v_pk_add_f32 v[24:25], v[24:25], v[176:177]
v_pk_add_f32 v[26:27], v[26:27], v[84:85]
v_pk_add_f32 v[24:25], v[24:25], v[178:179]
v_pk_add_f32 v[26:27], v[26:27], v[86:87]
v_pk_add_f32 v[24:25], v[24:25], v[180:181]
v_pk_add_f32 v[26:27], v[26:27], v[88:89]
s_nop 0
v_add_f32 v24, v24, v25
v_add_f32 v25, v26, v27
v_rcp_f32 v24, v24
v_rcp_f32 v25, v25
s_nop 0
v_pk_mul_f32 v[164:165], v[164:165], v[24:25] op_sel:[0,0] op_sel_hi:[1,0]
v_pk_mul_f32 v[72:73], v[72:73], v[24:25] op_sel:[0,1] op_sel_hi:[1,1]
v_pk_mul_f32 v[166:167], v[166:167], v[24:25] op_sel:[0,0] op_sel_hi:[1,0]
v_pk_mul_f32 v[74:75], v[74:75], v[24:25] op_sel:[0,1] op_sel_hi:[1,1]
v_pk_mul_f32 v[168:169], v[168:169], v[24:25] op_sel:[0,0] op_sel_hi:[1,0]
v_pk_mul_f32 v[76:77], v[76:77], v[24:25] op_sel:[0,1] op_sel_hi:[1,1]
v_pk_mul_f32 v[170:171], v[170:171], v[24:25] op_sel:[0,0] op_sel_hi:[1,0]
v_pk_mul_f32 v[78:79], v[78:79], v[24:25] op_sel:[0,1] op_sel_hi:[1,1]
v_pk_mul_f32 v[172:173], v[172:173], v[24:25] op_sel:[0,0] op_sel_hi:[1,0]
v_pk_mul_f32 v[80:81], v[80:81], v[24:25] op_sel:[0,1] op_sel_hi:[1,1]
v_pk_mul_f32 v[174:175], v[174:175], v[24:25] op_sel:[0,0] op_sel_hi:[1,0]
v_pk_mul_f32 v[82:83], v[82:83], v[24:25] op_sel:[0,1] op_sel_hi:[1,1]
v_pk_mul_f32 v[176:177], v[176:177], v[24:25] op_sel:[0,0] op_sel_hi:[1,0]
v_pk_mul_f32 v[84:85], v[84:85], v[24:25] op_sel:[0,1] op_sel_hi:[1,1]
v_pk_mul_f32 v[178:179], v[178:179], v[24:25] op_sel:[0,0] op_sel_hi:[1,0]
v_pk_mul_f32 v[86:87], v[86:87], v[24:25] op_sel:[0,1] op_sel_hi:[1,1]
v_pk_mul_f32 v[180:181], v[180:181], v[24:25] op_sel:[0,0] op_sel_hi:[1,0]
v_pk_mul_f32 v[88:89], v[88:89], v[24:25] op_sel:[0,1] op_sel_hi:[1,1]
s_nop 0
s_nop 0
CV 89,88,89
CV 88,86,87
CV 87,84,85
CV 86,82,83
CV 85,80,81
CV 84,78,79
CV 83,76,77
CV 82,74,75
CV 81,72,73
CV 72,164,165
CV 73,166,167
CV 74,168,169
CV 75,170,171
CV 76,172,173
CV 77,174,175
CV 78,176,177
CV 79,178,179
CV 80,180,181
s_cmp_lg_u32 s32, 0
s_cbranch_scc1 L_polld_26
s_mov_b32 s89, 0x20000
s_waitcnt vmcnt(0)
s_branch L_pollc_27
L_poll_25:
buffer_load_dword v251, v250, s[20:23], s46 offen sc1
s_waitcnt vmcnt(0)
L_pollc_27:
v_cmp_eq_u32 s[98:99], s97, v251
s_sub_u32 s89, s89, 1
s_and_b32 s98, s98, 0xffff
s_cmp_eq_u32 s98, 0xffff
s_cbranch_scc1 L_polld_26
s_sleep 4
s_cmp_lg_u32 s89, 0
s_cbranch_scc1 L_poll_25
L_polld_26:
s_barrier
s_nop 0
buffer_load_dwordx4 v[232:235], v224, s[20:23], s41 offen sc1
s_add_u32 s41, s41, 4096
buffer_load_dwordx4 v[236:239], v224, s[20:23], s41 offen sc1
s_add_u32 s41, s41, 4096
buffer_load_dwordx4 v[240:243], v224, s[20:23], s41 offen sc1
s_add_u32 s41, s41, 4096
buffer_load_dwordx4 v[244:247], v230, s[20:23], s41 offen sc1
v_max3_f32 v24, v92, v93, v94
v_min3_f32 v25, v92, v93, v94
v_max3_f32 v24, v24, v95, v96
v_min3_f32 v25, v25, v95, v96
v_max3_f32 v24, v24, v97, v98
v_min3_f32 v25, v25, v97, v98
v_max3_f32 v24, v24, v99, v100
v_min3_f32 v25, v25, v99, v100
v_max3_f32 v24, v24, v101, v102
v_min3_f32 v25, v25, v101, v102
v_max3_f32 v24, v24, v103, v104
v_min3_f32 v25, v25, v103, v104
v_max3_f32 v24, v24, v105, v106
v_min3_f32 v25, v25, v105, v106
v_max3_f32 v24, v24, v107, v108
v_min3_f32 v25, v25, v107, v108
v_max_f32 v24, v24, v109
v_min_f32 v25, v25, v109
v_pk_mul_f32 v[24:25], v[24:25], v[14:15] op_sel:[0,1] op_sel_hi:[1,1]
v_pk_fma_f32 v[164:165], v[92:93], v[14:15], v[24:25] op_sel:[0,1,0] op_sel_hi:[1,1,0] neg_lo:[0,0,1] neg_hi:[0,0,1]
v_pk_fma_f32 v[92:93], v[92:93], v[14:15], v[24:25] op_sel:[0,1,1] op_sel_hi:[1,1,1] neg_lo:[0,1,0] neg_hi:[0,1,0]
v_pk_fma_f32 v[166:167], v[94:95], v[14:15], v[24:25] op_sel:[0,1,0] op_sel_hi:[1,1,0] neg_lo:[0,0,1] neg_hi:[0,0,1]
v_pk_fma_f32 v[94:95], v[94:95], v[14:15], v[24:25] op_sel:[0,1,1] op_sel_hi:[1,1,1] neg_lo:[0,1,0] neg_hi:[0,1,0]
v_pk_fma_f32 v[168:169], v[96:97], v[14:15], v[24:25] op_sel:[0,1,0] op_sel_hi:[1,1,0] neg_lo:[0,0,1] neg_hi:[0,0,1]
v_pk_fma_f32 v[96:97], v[96:97], v[14:15], v[24:25] op_sel:[0,1,1] op_sel_hi:[1,1,1] neg_lo:[0,1,0] neg_hi:[0,1,0]
v_pk_fma_f32 v[170:171], v[98:99], v[14:15], v[24:25] op_sel:[0,1,0] op_sel_hi:[1,1,0] neg_lo:[0,0,1] neg_hi:[0,0,1]
v_pk_fma_f32 v[98:99], v[98:99], v[14:15], v[24:25] op_sel:[0,1,1] op_sel_hi:[1,1,1] neg_lo:[0,1,0] neg_hi:[0,1,0]
v_pk_fma_f32 v[172:173], v[100:101], v[14:15], v[24:25] op_sel:[0,1,0] op_sel_hi:[1,1,0] neg_lo:[0,0,1] neg_hi:[0,0,1]
v_pk_fma_f32 v[100:101], v[100:101], v[14:15], v[24:25] op_sel:[0,1,1] op_sel_hi:[1,1,1] neg_lo:[0,1,0] neg_hi:[0,1,0]
v_pk_fma_f32 v[174:175], v[102:103], v[14:15], v[24:25] op_sel:[0,1,0] op_sel_hi:[1,1,0] neg_lo:[0,0,1] neg_hi:[0,0,1]
v_pk_fma_f32 v[102:103], v[102:103], v[14:15], v[24:25] op_sel:[0,1,1] op_sel_hi:[1,1,1] neg_lo:[0,1,0] neg_hi:[0,1,0]
v_pk_fma_f32 v[176:177], v[104:105], v[14:15], v[24:25] op_sel:[0,1,0] op_sel_hi:[1,1,0] neg_lo:[0,0,1] neg_hi:[0,0,1]
v_pk_fma_f32 v[104:105], v[104:105], v[14:15], v[24:25] op_sel:[0,1,1] op_sel_hi:[1,1,1] neg_lo:[0,1,0] neg_hi:[0,1,0]
v_pk_fma_f32 v[178:179], v[106:107], v[14:15], v[24:25] op_sel:[0,1,0] op_sel_hi:[1,1,0] neg_lo:[0,0,1] neg_hi:[0,0,1]
v_pk_fma_f32 v[106:107], v[106:107], v[14:15], v[24:25] op_sel:[0,1,1] op_sel_hi:[1,1,1] neg_lo:[0,1,0] neg_hi:[0,1,0]
v_pk_fma_f32 v[180:181], v[108:109], v[14:15], v[24:25] op_sel:[0,1,0] op_sel_hi:[1,1,0] neg_lo:[0,0,1] neg_hi:[0,0,1]
v_pk_fma_f32 v[108:109], v[108:109], v[14:15], v[24:25] op_sel:[0,1,1] op_sel_hi:[1,1,1] neg_lo:[0,1,0] neg_hi:[0,1,0]
s_nop 0
v_exp_f32 v164, v164
v_exp_f32 v92, v92
v_exp_f32 v165, v165
v_exp_f32 v93, v93
v_exp_f32 v166, v166
v_exp_f32 v94, v94
v_exp_f32 v167, v167
v_exp_f32 v95, v95
v_exp_f32 v168, v168
v_exp_f32 v96, v96
v_exp_f32 v169, v169
v_exp_f32 v97, v97
v_exp_f32 v170, v170
v_exp_f32 v98, v98
v_exp_f32 v171, v171
v_exp_f32 v99, v99
v_exp_f32 v172, v172
v_exp_f32 v100, v100
v_exp_f32 v173, v173
v_exp_f32 v101, v101
v_exp_f32 v174, v174
v_exp_f32 v102, v102
v_exp_f32 v175, v175
v_exp_f32 v103, v103
v_exp_f32 v176, v176
v_exp_f32 v104, v104
v_exp_f32 v177, v177
v_exp_f32 v105, v105
v_exp_f32 v178, v178
v_exp_f32 v106, v106
v_exp_f32 v179, v179
v_exp_f32 v107, v107
v_exp_f32 v180, v180
v_exp_f32 v108, v108
v_exp_f32 v181, v181
v_exp_f32_e64 v109, v109
v_pk_add_f32 v[24:25], v[164:165], v[166:167]
v_pk_add_f32 v[26:27], v[92:93], v[94:95]
v_pk_add_f32 v[24:25], v[24:25], v[168:169]
v_pk_add_f32 v[26:27], v[26:27], v[96:97]
v_pk_add_f32 v[24:25], v[24:25], v[170:171]
v_pk_add_f32 v[26:27], v[26:27], v[98:99]
v_pk_add_f32 v[24:25], v[24:25], v[172:173]
v_pk_add_f32 v[26:27], v[26:27], v[100:101]
v_pk_add_f32 v[24:25], v[24:25], v[174:175]
v_pk_add_f32 v[26:27], v[26:27], v[102:103]
v_pk_add_f32 v[24:25], v[24:25], v[176:177]
v_pk_add_f32 v[26:27], v[26:27], v[104:105]
v_pk_add_f32 v[24:25], v[24:25], v[178:179]
v_pk_add_f32 v[26:27], v[26:27], v[106:107]
v_pk_add_f32 v[24:25], v[24:25], v[180:181]
v_pk_add_f32 v[26:27], v[26:27], v[108:109]
s_nop 0
v_add_f32 v24, v24, v25
v_add_f32 v25, v26, v27
v_rcp_f32 v24, v24
v_rcp_f32 v25, v25
s_nop 0
v_pk_mul_f32 v[164:165], v[164:165], v[24:25] op_sel:[0,0] op_sel_hi:[1,0]
v_pk_mul_f32 v[92:93], v[92:93], v[24:25] op_sel:[0,1] op_sel_hi:[1,1]
v_pk_mul_f32 v[166:167], v[166:167], v[24:25] op_sel:[0,0] op_sel_hi:[1,0]
v_pk_mul_f32 v[94:95], v[94:95], v[24:25] op_sel:[0,1] op_sel_hi:[1,1]
v_pk_mul_f32 v[168:169], v[168:169], v[24:25] op_sel:[0,0] op_sel_hi:[1,0]
v_pk_mul_f32 v[96:97], v[96:97], v[24:25] op_sel:[0,1] op_sel_hi:[1,1]
v_pk_mul_f32 v[170:171], v[170:171], v[24:25] op_sel:[0,0] op_sel_hi:[1,0]
v_pk_mul_f32 v[98:99], v[98:99], v[24:25] op_sel:[0,1] op_sel_hi:[1,1]
v_pk_mul_f32 v[172:173], v[172:173], v[24:25] op_sel:[0,0] op_sel_hi:[1,0]
v_pk_mul_f32 v[100:101], v[100:101], v[24:25] op_sel:[0,1] op_sel_hi:[1,1]
v_pk_mul_f32 v[174:175], v[174:175], v[24:25] op_sel:[0,0] op_sel_hi:[1,0]
v_pk_mul_f32 v[102:103], v[102:103], v[24:25] op_sel:[0,1] op_sel_hi:[1,1]
v_pk_mul_f32 v[176:177], v[176:177], v[24:25] op_sel:[0,0] op_sel_hi:[1,0]
v_pk_mul_f32 v[104:105], v[104:105], v[24:25] op_sel:[0,1] op_sel_hi:[1,1]
v_pk_mul_f32 v[178:179], v[178:179], v[24:25] op_sel:[0,0] op_sel_hi:[1,0]
v_pk_mul_f32 v[106:107], v[106:107], v[24:25] op_sel:[0,1] op_sel_hi:[1,1]
v_pk_mul_f32 v[180:181], v[180:181], v[24:25] op_sel:[0,0] op_sel_hi:[1,0]
v_pk_mul_f32 v[108:109], v[108:109], v[24:25] op_sel:[0,1] op_sel_hi:[1,1]
s_nop 0
s_nop 0
CV 109,108,109
CV 108,106,107
CV 107,104,105
CV 106,102,103
CV 105,100,101
CV 104,98,99
CV 103,96,97
CV 102,94,95
CV 101,92,93
CV 92,164,165
CV 93,166,167
CV 94,168,169
CV 95,170,171
CV 96,172,173
CV 97,174,175
CV 98,176,177
CV 99,178,179
CV 100,180,181
s_waitcnt vmcnt(3)
ds_write_b64 v252, v[232:233]
ds_write_b64 v252, v[234:235] offset:80
s_waitcnt vmcnt(2)
ds_write_b64 v253, v[236:237]
ds_write_b64 v253, v[238:239] offset:80
s_waitcnt vmcnt(1)
ds_write_b64 v254, v[240:241]
ds_write_b64 v254, v[242:243] offset:80
s_waitcnt vmcnt(0)
ds_write_b64 v255, v[244:245]
ds_write_b64 v255, v[246:247] offset:80
WL 0
s_barrier
ds_read_b128 a[0:3], v228 offset:0
ds_read_b128 a[4:7], v228 offset:16
ds_read_b128 a[8:11], v228 offset:32
ds_read_b128 a[12:15], v228 offset:48
ds_read_b128 a[16:19], v228 offset:64
ds_read_b128 a[20:23], v228 offset:320
ds_read_b128 a[24:27], v228 offset:336
ds_read_b128 a[28:31], v228 offset:352
ds_read_b128 a[32:35], v228 offset:368
ds_read_b128 a[36:39], v228 offset:384
v_accvgpr_read_b32 v26, a240
v_accvgpr_read_b32 v27, a241
WL 5
s_nop 0
v_mfma_f32_16x16x32_bf16 v[112:115], a[0:3], v[32:35], 0
ds_read_b128 a[40:43], v228 offset:640
ds_read_b128 a[44:47], v228 offset:656
v_mfma_f32_16x16x32_bf16 v[132:135], a[0:3], v[52:55], 0
ds_read_b128 a[48:51], v228 offset:672
ds_read_b128 a[52:55], v228 offset:688
MV 112,4,36
ds_read_b128 a[56:59], v228 offset:704
MV 132,4,56
MV 112,8,40
MV 132,8,60
MV 112,12,44
MV 132,12,64
MV 112,16,48
MV 132,16,68
WL 5
s_nop 0
v_mfma_f32_16x16x32_bf16 v[116:119], a[20:23], v[32:35], 0
ds_read_b128 a[60:63], v228 offset:960
ds_read_b128 a[64:67], v228 offset:976
v_mfma_f32_16x16x32_bf16 v[136:139], a[20:23], v[52:55], 0
ds_read_b128 a[68:71], v228 offset:992
ds_read_b128 a[72:75], v228 offset:1008
MV 116,24,36
ds_read_b128 a[76:79], v228 offset:1024
MV 136,24,56
MV 116,28,40
MV 136,28,60
MV 116,32,44
MV 136,32,64
MV 116,36,48
MV 136,36,68
WL 5
s_nop 0
v_mfma_f32_16x16x32_bf16 v[120:123], a[40:43], v[32:35], 0
ds_read_b128 a[80:83], v228 offset:1280
ds_read_b128 a[84:87], v228 offset:1296
v_mfma_f32_16x16x32_bf16 v[140:143], a[40:43], v[52:55], 0
ds_read_b128 a[88:91], v228 offset:1312
ds_read_b128 a[92:95], v228 offset:1328
MV 120,44,36
ds_read_b128 a[96:99], v228 offset:1344
MV 140,44,56
MV 120,48,40
MV 140,48,60
MV 120,52,44
MV 140,52,64
MV 120,56,48
MV 140,56,68
WL 5
s_nop 0
v_mfma_f32_16x16x32_bf16 v[124:127], a[60:63], v[32:35], 0
ds_read_b128 a[100:103], v229 offset:0
ds_read_b128 a[104:107], v229 offset:16
v_mfma_f32_16x16x32_bf16 v[144:147], a[60:63], v[52:55], 0
ds_read_b128 a[108:111], v229 offset:32
ds_read_b128 a[112:115], v229 offset:48
MV 124,64,36
ds_read_b128 a[116:119], v229 offset:64
MV 144,64,56
MV 124,68,40
MV 144,68,60
MV 124,72,44
MV 144,72,64
MV 124,76,48
MV 144,76,68
WL 5
s_nop 0
v_mfma_f32_16x16x32_bf16 v[128:131], a[80:83], v[32:35], 0
ds_read_b128 a[120:123], v229 offset:320
ds_read_b128 a[124:127], v229 offset:336
v_mfma_f32_16x16x32_bf16 v[148:151], a[80:83], v[52:55], 0
ds_read_b128 a[128:131], v229 offset:352
ds_read_b128 a[132:135], v229 offset:368
MV 128,84,36
ds_read_b128 a[136:139], v229 offset:384
MV 148,84,56
MV 128,88,40
MV 148,88,60
MV 128,92,44
MV 148,92,64
MV 128,96,48
MV 148,96,68
WL 5
s_nop 0
v_mfma_f32_16x16x32_bf16 v[152:155], a[100:103], v[72:75], 0
ds_read_b128 a[140:143], v229 offset:640
ds_read_b128 a[176:179], v229 offset:656
v_mfma_f32_16x16x32_bf16 v[172:175], a[100:103], v[92:95], 0
ds_read_b128 a[180:183], v229 offset:672
ds_read_b128 a[184:187], v229 offset:688
MV 152,104,76
ds_read_b128 a[188:191], v229 offset:704
MV 172,104,96
MV 152,108,80
MV 172,108,100
MV 152,112,84
MV 172,112,104
MV 152,116,88
MV 172,116,108
WL 5
s_nop 0
v_mfma_f32_16x16x32_bf16 v[156:159], a[120:123], v[72:75], 0
ds_read_b128 a[192:195], v229 offset:960
ds_read_b128 a[196:199], v229 offset:976
v_mfma_f32_16x16x32_bf16 v[176:179], a[120:123], v[92:95], 0
ds_read_b128 a[200:203], v229 offset:992
ds_read_b128 a[204:207], v229 offset:1008
MV 156,124,76
ds_read_b128 a[208:211], v229 offset:1024
v_cndmask_b32 v24, v130, v112, s[42:43]
MV 176,124,96
v_add_f32 v24, 0x358637bd, v24
v_rcp_f32_e64 v24, v24
MV 156,128,80
s_nop 0
v_mul_f32 v24, v24, v26
MV 176,128,100
v_mul_f32 v112, v112, v24
v_mul_f32 v113, v113, v24
MV 156,132,84
v_mul_f32 v114, v114, v24
v_mul_f32 v115, v115, v24
MV 176,132,104
v_mul_f32 v116, v116, v24
v_mul_f32 v117, v117, v24
MV 156,136,88
v_mul_f32 v118, v118, v24
v_mul_f32 v119, v119, v24
MV 176,136,108
v_mul_f32 v120, v120, v24
WL 5
v_mfma_f32_16x16x32_bf16 v[160:163], a[140:143], v[72:75], 0
ds_read_b128 a[212:215], v229 offset:1280
ds_read_b128 a[216:219], v229 offset:1296
v_mfma_f32_16x16x32_bf16 v[180:183], a[140:143], v[92:95], 0
ds_read_b128 a[220:223], v229 offset:1312
ds_read_b128 a[224:227], v229 offset:1328
MV 160,176,76
ds_read_b128 a[228:231], v229 offset:1344
v_mul_f32_e64 v121, v121, v24
MV 180,176,96
v_mul_f32 v122, v122, v24
v_mul_f32 v123, v123, v24
MV 160,180,80
v_mul_f32 v124, v124, v24
v_mul_f32 v125, v125, v24
MV 180,180,100
v_mul_f32 v126, v126, v24
v_mul_f32 v127, v127, v24
MV 160,184,84
v_mul_f32 v128, v128, v24
v_mul_f32 v129, v129, v24
MV 180,184,104
v_mul_f32 v130, v130, v24
v_mul_f32 v131, v131, v24
MV 160,188,88
CV 192,112,113
CV 193,114,115
MV 180,188,108
CV 194,116,117
WL 5
s_nop 0
v_mfma_f32_16x16x32_bf16 v[164:167], a[192:195], v[72:75], 0
CV 195,118,119
CV 196,120,121
v_mfma_f32_16x16x32_bf16 v[184:187], a[192:195], v[92:95], 0
CV 197,122,123
CV 198,124,125
MV 164,196,76
CV 199,126,127
CV 200,128,129
MV 184,196,96
CV 201,130,131
v_cndmask_b32 v192, v192, 0, s[42:43]
MV 164,200,80
v_cndmask_b32 v201, 0, v201, s[42:43]
v_cndmask_b32 v24, v150, v132, s[42:43]
MV 184,200,100
v_add_f32 v24, 0x358637bd, v24
v_rcp_f32_e64 v24, v24
MV 164,204,84
s_nop 0
v_mul_f32 v24, v24, v27
MV 184,204,104
v_mul_f32 v132, v132, v24
v_mul_f32 v133, v133, v24
MV 164,208,88
v_mul_f32 v134, v134, v24
v_mul_f32 v135, v135, v24
MV 184,208,108
v_mul_f32 v136, v136, v24
WL 0
v_mfma_f32_16x16x32_bf16 v[168:171], a[212:215], v[72:75], 0
v_mul_f32 v137, v137, v24
v_mul_f32 v138, v138, v24
v_mfma_f32_16x16x32_bf16 v[188:191], a[212:215], v[92:95], 0
v_mul_f32 v139, v139, v24
v_mul_f32 v140, v140, v24
MV 168,216,76
v_mul_f32 v141, v141, v24
v_mul_f32 v142, v142, v24
MV 188,216,96
v_mul_f32 v143, v143, v24
v_mul_f32 v144, v144, v24
MV 168,220,80
v_mul_f32 v145, v145, v24
v_mul_f32 v146, v146, v24
MV 188,220,100
v_mul_f32 v147, v147, v24
v_mul_f32 v148, v148, v24
MV 168,224,84
v_mul_f32 v149, v149, v24
v_mul_f32 v150, v150, v24
MV 188,224,104
v_mul_f32_e64 v151, v151, v24
CV 212,132,133
MV 168,228,88
CV 213,134,135
CV 214,136,137
MV 188,228,108
CV 215,138,139
CV 216,140,141
CV 217,142,143
CV 218,144,145
CV 219,146,147
CV 220,148,149
CV 221,150,151
v_cndmask_b32 v212, v212, 0, s[42:43]
v_cndmask_b32 v221, 0, v221, s[42:43]
s_nop 7
v_cndmask_b32 v24, v170, v152, s[42:43]
v_add_f32 v24, 0x358637bd, v24
v_rcp_f32 v24, v24
s_nop 0
v_mul_f32 v24, v24, v26
v_pk_mul_f32 v[152:153], v[152:153], v[24:25] op_sel_hi:[1,0]
v_pk_mul_f32 v[154:155], v[154:155], v[24:25] op_sel_hi:[1,0]
v_pk_mul_f32 v[156:157], v[156:157], v[24:25] op_sel_hi:[1,0]
v_pk_mul_f32 v[158:159], v[158:159], v[24:25] op_sel_hi:[1,0]
v_pk_mul_f32 v[160:161], v[160:161], v[24:25] op_sel_hi:[1,0]
v_pk_mul_f32 v[162:163], v[162:163], v[24:25] op_sel_hi:[1,0]
v_pk_mul_f32 v[164:165], v[164:165], v[24:25] op_sel_hi:[1,0]
v_pk_mul_f32 v[166:167], v[166:167], v[24:25] op_sel_hi:[1,0]
v_pk_mul_f32 v[168:169], v[168:169], v[24:25] op_sel_hi:[1,0]
v_pk_mul_f32 v[170:171], v[170:171], v[24:25] op_sel_hi:[1,0]
CV 202,152,153
CV 203,154,155
CV 204,156,157
CV 205,158,159
CV 206,160,161
CV 207,162,163
CV 208,164,165
CV 209,166,167
CV 210,168,169
CV 211,170,171
v_cndmask_b32 v202, v202, 0, s[42:43]
v_cndmask_b32 v211, 0, v211, s[42:43]
v_cndmask_b32 v24, v190, v172, s[42:43]
v_add_f32 v24, 0x358637bd, v24
v_rcp_f32 v24, v24
s_nop 0
v_mul_f32_e64 v24, v24, v27
v_pk_mul_f32 v[172:173], v[172:173], v[24:25] op_sel_hi:[1,0]
v_pk_mul_f32 v[174:175], v[174:175], v[24:25] op_sel_hi:[1,0]
v_pk_mul_f32 v[176:177], v[176:177], v[24:25] op_sel_hi:[1,0]
v_pk_mul_f32 v[178:179], v[178:179], v[24:25] op_sel_hi:[1,0]
v_pk_mul_f32 v[180:181], v[180:181], v[24:25] op_sel_hi:[1,0]
v_pk_mul_f32 v[182:183], v[182:183], v[24:25] op_sel_hi:[1,0]
v_pk_mul_f32 v[184:185], v[184:185], v[24:25] op_sel_hi:[1,0]
v_pk_mul_f32 v[186:187], v[186:187], v[24:25] op_sel_hi:[1,0]
v_pk_mul_f32 v[188:189], v[188:189], v[24:25] op_sel_hi:[1,0]
v_pk_mul_f32 v[190:191], v[190:191], v[24:25] op_sel_hi:[1,0]
CV 222,172,173
CV 223,174,175
CV 224,176,177
CV 225,178,179
CV 226,180,181
CV 227,182,183
CV 228,184,185
CV 229,186,187
CV 230,188,189
CV 231,190,191
v_cndmask_b32 v222, v222, 0, s[42:43]
v_cndmask_b32 v231, 0, v231, s[42:43]
v_rcp_f32 v26, v26
v_rcp_f32 v27, v27
s_lshl_b32 s35, s33, 2
s_add_u32 s35, s35, s34
s_lshl_b32 s35, s35, 2
s_add_u32 s35, s35, s32
s_lshl_b32 s35, s35, 7
s_add_u32 s35, s35, 0x2500000
v_cmp_gt_u32 vcc, 16, v0
v_lshlrev_b32 v28, 2, v0
v_mov_b32 v29, 0x40000000
v_cndmask_b32_e64 v28, v29, v28, vcc
buffer_store_dword v26, v28, s[20:23], s35 offen offset:0 sc1
buffer_store_dword v27, v28, s[20:23], s35 offen offset:64 sc1
s_add_u32 s35, s45, 0
s_nop 0
buffer_store_dwordx4 v[192:195], v21, s[20:23], s35 offen offset:0 sc1
buffer_store_dwordx4 v[212:215], v21, s[20:23], s35 offen offset:1024 sc1
buffer_store_dwordx4 v[196:199], v21, s[20:23], s35 offen offset:2048 sc1
buffer_store_dwordx4 v[216:219], v21, s[20:23], s35 offen offset:3072 sc1
s_add_u32 s35, s45, 4096
buffer_store_dwordx4 v[200:203], v21, s[20:23], s35 offen offset:0 sc1
buffer_store_dwordx4 v[220:223], v21, s[20:23], s35 offen offset:1024 sc1
buffer_store_dwordx4 v[204:207], v21, s[20:23], s35 offen offset:2048 sc1
buffer_store_dwordx4 v[224:227], v21, s[20:23], s35 offen offset:3072 sc1
s_add_u32 s35, s45, 8192
buffer_store_dwordx4 v[208:211], v21, s[20:23], s35 offen offset:0 sc1
buffer_store_dwordx4 v[228:231], v21, s[20:23], s35 offen offset:1024 sc1
s_waitcnt vmcnt(0)
s_barrier
v_mov_b32_e64 v28, s97
buffer_store_dword v28, v20, s[20:23], s44 offen offset:48 sc1
L_k1_end:
s_endpgm
.fill 4096, 4, 0xbf810000
.section .rodata,"a"
.p2align 6
.amdhsa_kernel parallel_sum__linear_kernel_hedgehog__glu_gated_reglu__prompt_kernel
  .amdhsa_next_free_vgpr 512
  .amdhsa_next_free_sgpr 102
  .amdhsa_accum_offset 256
  .amdhsa_group_segment_fixed_size 0
  .amdhsa_kernarg_size 88
  .amdhsa_user_sgpr_count 2
  .amdhsa_user_sgpr_kernarg_segment_ptr 1
  .amdhsa_system_sgpr_workgroup_id_x 1
.end_amdhsa_kernel
```
